```python
import torch

def _softmax(x, axis=-1):
    return torch.softmax(x, dim=axis)
def _gelu(x):
    return torch.nn.functional.gelu(x, approximate="tanh")
def _silu(x):
    return torch.nn.functional.silu(x)
def _sigmoid(x):
    return torch.sigmoid(x)
def _layernorm(x, axis=-1, eps=1e-5):
    m = x.mean(dim=axis, keepdim=True)
    v = x.var(dim=axis, keepdim=True, unbiased=False)
    return (x - m) / torch.sqrt(v + eps)
def _scatter_add(tgt, idx, src, axis=0):
    return tgt.clone().index_add_(axis, idx, src)
def _segment_sum(src, seg, n):
    out = torch.zeros((n,) + src.shape[1:], dtype=src.dtype)
    return out.index_add_(0, seg, src)
def _pad(x, pw):
    flat = tuple(v for pair in reversed(pw) for v in pair)
    return torch.nn.functional.pad(x, flat)

kernel_name = 'sequential_preLN__softmax_full_mha__dense_activation_gelu__prompt'

def setup_inputs():

    _w = (lambda a: (lambda t: t.to(torch.bfloat16) if t.is_floating_point() else t)(torch.as_tensor(a)))
    def _A_setup():
        B, S, D = 1, 2048, 448
        return {
            "x": _w((lambda *s: torch.randn(*s, dtype=torch.bfloat16) * 0.05)(B, S, D)),
            "wqkv": _w((lambda *s: torch.randn(*s, dtype=torch.bfloat16) * 0.05)(D, 3 * D)),
            "wo": _w((lambda *s: torch.randn(*s, dtype=torch.bfloat16) * 0.05)(D, D)),
        }
    _A_in = _A_setup()

    def _B_setup():
        B, S, D, F = 1, 2048, 448, 1792
        return {
            "x": _w((lambda *s: torch.randn(*s, dtype=torch.bfloat16) * 0.05)(B, S, D)),
            "w1": _w((lambda *s: torch.randn(*s, dtype=torch.bfloat16) * 0.8)(D, F) * (D ** -0.5)),
            "b1": _w((lambda *s: torch.randn(*s, dtype=torch.bfloat16) * 12.8)(F) * 0.01),
            "w2": _w((lambda *s: torch.randn(*s, dtype=torch.bfloat16) * 0.8)(F, D) * (F ** -0.5)),
            "b2": _w((lambda *s: torch.randn(*s, dtype=torch.bfloat16) * 12.8)(D) * 0.01),
        }
    _B_in = _B_setup()

    return {
        "A_x": _A_in["x"],
        "A_wqkv": _A_in["wqkv"],
        "A_wo": _A_in["wo"],
        "B_x": _B_in["x"],
        "B_w1": _B_in["w1"],
        "B_b1": _B_in["b1"],
        "B_w2": _B_in["w2"],
        "B_b2": _B_in["b2"],
    }

def reference(A_x, A_wqkv, A_wo, B_x, B_w1, B_b1, B_w2, B_b2):
    def _A_ref(x, wqkv, wo):
        B, S, D = x.shape
        H = 16; Dh = D // H
        qkv = (lambda x, *d: x.permute(*d))((x @ wqkv).reshape(B, S, 3, H, Dh), 2, 0, 3, 1, 4)
        q, k, v = qkv[0], qkv[1], qkv[2]
        scale = Dh ** -0.5
        scores = torch.einsum("bhqd,bhkd->bhqk", q, k) * scale
        p = _softmax(scores, axis=-1)
        o = torch.einsum("bhqk,bhkd->bhqd", p, v)
        return (lambda x, *d: x.permute(*d))(o, 0, 2, 1, 3).reshape(B, S, D) @ wo

    def _B_ref(x, w1, b1, w2, b2):
        h = torch.einsum("bsd,df->bsf", x, w1) + b1
        h = _gelu(h)
        return torch.einsum("bsf,fd->bsd", h, w2) + b2

    x = A_x
    h = x + _A_ref(_layernorm(x, axis=-1), A_wqkv, A_wo)
    h2 = h + _B_ref(_layernorm(h, axis=-1), B_w1, B_b1, B_w2, B_b2)
    return h2
```

```asm
; @launch grid=(256,1,1) block=(256,1,1) lds=163840
.amdgcn_target "amdgcn-amd-amdhsa--gfx950"
.text
.globl sequential_preLN__softmax_full_mha__dense_activation_gelu__prompt_kernel
.p2align 8
.type sequential_preLN__softmax_full_mha__dense_activation_gelu__prompt_kernel,@function
sequential_preLN__softmax_full_mha__dense_activation_gelu__prompt_kernel:
  s_cmp_ge_u32 s2, 256
  s_cbranch_scc1 L_exit
  s_getpc_b64 s[6:7]
  v_lshlrev_b32 v2, 7, v0
  s_lshl_b32 s4, s2, 12
  s_and_b32 s4, s4, 0x8000
  v_add_u32 v2, s4, v2
  v_min_u32 v2, L_end-sequential_preLN__softmax_full_mha__dense_activation_gelu__prompt_kernel-128, v2
  global_load_dword v144, v2, s[6:7]
  s_load_dwordx2 s[8:9], s[0:1], 0
  s_load_dwordx2 s[12:13], s[0:1], 8
  s_load_dwordx2 s[28:29], s[0:1], 80
  s_load_dwordx2 s[16:17], s[0:1], 16
  s_load_dwordx2 s[20:21], s[0:1], 32
  s_load_dwordx2 s[24:25], s[0:1], 48
  s_load_dwordx2 s[36:37], s[0:1], 40
  s_load_dwordx2 s[40:41], s[0:1], 56
  s_load_dwordx2 s[32:33], s[0:1], 64
  v_lshrrev_b32 v1, 6, v0
  v_and_b32 v0, 63, v0
  v_readfirstlane_b32 s3, v1
  s_mov_b32 s63, 60000
  s_mov_b32 s10, 1835008
  s_mov_b32 s11, 0x20000
  s_mov_b32 s14, 1204224
  s_mov_b32 s15, 0x20000
  s_mov_b32 s30, 268435456
  s_mov_b32 s31, 0x20000
  s_lshr_b32 s4, s2, 3
  s_min_u32 s4, s4, 27
  s_and_b32 s5, s2, 7
  s_mul_i32 s6, s4, 37
  s_lshr_b32 s6, s6, 8
  s_mul_i32 s7, s6, 7
  s_sub_u32 s54, s4, s7
  s_lshl_b32 s53, s5, 2
  s_add_u32 s53, s53, s6
  s_lshr_b32 s6, s6, 1
  s_mul_i32 s7, s6, 14
  s_sub_u32 s55, s4, s7
  s_lshl_b32 s5, s5, 1
  s_add_u32 s5, s5, s6
  s_lshl_b32 s56, s5, 2
  s_add_u32 s56, s56, s3
  s_mul_i32 s62, s3, 12288
  s_add_u32 s62, s62, 114688
  s_and_b32 s4, s2, 7
  s_lshr_b32 s5, s2, 3
  s_and_b32 s6, s5, 1
  s_lshl_b32 s7, s4, 1
  s_add_u32 s49, s7, s6
  s_lshr_b32 s50, s5, 1
  s_lshl_b32 s49, s49, 2
  s_mov_b32 s6, 0x768954cd
  s_mov_b32 s7, 0xab32fe10
  s_lshr_b64 s[6:7], s[6:7], s49
  s_and_b32 s49, s6, 15
  s_lshl_b32 s51, s50, 2
  s_add_u32 s51, s51, s3
  v_lshlrev_b32 v1, 4, v0
  v_lshrrev_b32 v64, 3, v0
  v_and_b32 v65, 7, v0
  v_lshrrev_b32 v66, 4, v0
  v_xor_b32 v67, v65, v66
  v_mul_u32_u24 v68, 896, v64
  v_lshl_add_u32 v32, v67, 4, v68
  v_xor_b32 v33, 64, v32
  v_add_u32 v33, 6144, v33
  v_add_u32 v34, 12288, v32
  v_add_u32 v35, 12288, v33
  s_mul_i32 s7, s49, 56
  s_and_b32 s7, s7, -16
  v_lshrrev_b32 v64, 2, v0
  v_and_b32 v65, 3, v0
  v_mul_u32_u24 v64, 2688, v64
  v_lshl_add_u32 v64, v65, 4, v64
  v_add_u32 v36, s7, v64
  s_mul_i32 s73, s51, 28672
  s_mul_i32 s67, s3, 43008
  s_lshl_b32 s68, s3, 12
  s_mul_i32 s45, s3, 3072
  s_add_u32 s45, s45, 16384
  s_add_u32 s4, s4, s50
  s_mul_i32 s5, s4, 37
  s_lshr_b32 s5, s5, 8
  s_mul_i32 s5, s5, 7
  s_sub_u32 s4, s4, s5
  s_lshl_b32 s72, s4, 7
  s_and_b32 s5, s2, 7
  s_lshl_b32 s5, s5, 9
  s_lshr_b32 s6, s2, 3
  s_lshl_b32 s6, s6, 2
  s_add_u32 s6, s6, s3
  s_lshl_b32 s6, s6, 2
  s_add_u32 s5, s5, s6
  s_add_u32 s70, s5, 262144
  s_getreg_b32 s71, hwreg(HW_REG_XCC_ID, 0, 4)
  s_waitcnt lgkmcnt(0)
  s_mul_i32 s66, s72, 1344
  s_add_u32 s66, s66, s67
  s_add_u32 m0, s45, 0
  s_nop 0
  buffer_load_dwordx4 v36, s[12:15], s66 offen lds
  s_add_u32 s66, s66, 896
  s_add_u32 m0, s45, 1024
  s_nop 0
  buffer_load_dwordx4 v36, s[12:15], s66 offen lds
  s_add_u32 s66, s66, 896
  s_add_u32 m0, s45, 2048
  s_nop 0
  buffer_load_dwordx4 v36, s[12:15], s66 offen lds
  s_add_u32 s65, s73, s72
  s_add_u32 m0, s68, 0
  s_nop 0
  buffer_load_dwordx4 v32, s[8:11], s65 offen offset:0 lds
  s_add_u32 s72, s72, 128
  s_cmp_eq_u32 s72, 896
  s_cselect_b32 s72, 0, s72
  buffer_load_dwordx4 v33, s[8:11], s65 offen offset:1024 lds
  buffer_load_dwordx4 v34, s[8:11], s65 offen offset:2048 lds
  buffer_load_dwordx4 v35, s[8:11], s65 offen offset:3072 lds
  s_load_dword s48, s[28:29], 0
  v_bfe_u32 v64, v0, 3, 2
  v_lshlrev_b32 v64, 10, v64
  v_and_b32 v65, 7, v0
  v_lshl_add_u32 v64, v65, 7, v64
  v_add_u32 v64, s68, v64
  s_lshl_b32 s6, s3, 1
  v_lshrrev_b32 v65, 5, v0
  v_bfe_u32 v66, v0, 1, 3
  v_xor_b32 v66, v66, v65
  v_xor_b32 v66, s6, v66
  v_xor_b32 v67, 0, v66
  v_lshl_add_u32 v40, v67, 4, v64
  v_xor_b32 v67, 2, v66
  v_lshl_add_u32 v41, v67, 4, v64
  v_xor_b32 v67, 4, v66
  v_lshl_add_u32 v42, v67, 4, v64
  v_xor_b32 v67, 6, v66
  v_lshl_add_u32 v43, v67, 4, v64
  v_bfe_u32 v66, v0, 2, 2
  v_lshl_add_u32 v66, v65, 3, v66
  v_bfe_u32 v67, v0, 4, 1
  v_and_b32 v68, 3, v0
  v_lshl_add_u32 v67, v67, 2, v68
  s_and_b32 s4, s49, 1
  v_add_u32 v67, s4, v67
  v_min_u32 v67, 7, v67
  v_lshlrev_b32 v67, 3, v67
  v_lshl_add_u32 v66, v66, 6, v67
  s_xor_b32 s4, s3, 0
  s_mul_i32 s4, s4, 3072
  s_add_u32 s4, s4, 16384
  v_add_u32 v52, s4, v66
  s_xor_b32 s4, s3, 1
  s_mul_i32 s4, s4, 3072
  s_add_u32 s4, s4, 16384
  v_add_u32 v53, s4, v66
  s_xor_b32 s4, s3, 2
  s_mul_i32 s4, s4, 3072
  s_add_u32 s4, s4, 16384
  v_add_u32 v54, s4, v66
  s_xor_b32 s4, s3, 3
  s_mul_i32 s4, s4, 3072
  s_add_u32 s4, s4, 16384
  v_add_u32 v55, s4, v66
  v_add_u32 v44, 57344, v40
  v_add_u32 v56, 57344, v52
  v_add_u32 v45, 57344, v41
  v_add_u32 v57, 57344, v53
  v_add_u32 v46, 57344, v42
  v_add_u32 v58, 57344, v54
  v_add_u32 v47, 57344, v43
  v_add_u32 v59, 57344, v55
  v_add_u32 v48, 114688, v40
  v_add_u32 v60, 114688, v52
  v_add_u32 v49, 114688, v41
  v_add_u32 v61, 114688, v53
  v_add_u32 v50, 114688, v42
  v_add_u32 v62, 114688, v54
  v_add_u32 v51, 114688, v43
  v_add_u32 v63, 114688, v55
  v_mov_b32 v37, 0x3f803f80
  v_lshlrev_b32 v27, 3, v0
  v_mov_b32 v38, 0
  v_mov_b32 v39, 0
  v_mov_b32 v208, 0
  v_mov_b32 v209, 0
  v_mov_b32 v210, 0
  v_mov_b32 v234, 0
  v_mov_b32 v235, 0
  v_mov_b32 v238, 0
  v_mov_b32 v239, 0
  v_mov_b32 v242, 0
  v_mov_b32 v243, 0
  v_mov_b32 v246, 0
  v_mov_b32 v247, 0
  v_and_b32 v76, 31, v0
  v_lshl_add_u32 v76, v76, 2, s62
  v_lshrrev_b32 v77, 5, v0
  v_lshl_add_u32 v77, v77, 4, s62
  s_cmp_lt_u32 s2, 224
  s_cselect_b32 s34, 1835008, 0
  s_mov_b32 s35, 0x20000
  s_mul_i32 s66, s72, 1344
  s_add_u32 s66, s66, s67
  s_add_u32 m0, s45, 28672
  s_nop 0
  buffer_load_dwordx4 v36, s[12:15], s66 offen lds
  s_add_u32 s66, s66, 896
  s_add_u32 m0, s45, 29696
  s_nop 0
  buffer_load_dwordx4 v36, s[12:15], s66 offen lds
  s_add_u32 s66, s66, 896
  s_add_u32 m0, s45, 30720
  s_nop 0
  buffer_load_dwordx4 v36, s[12:15], s66 offen lds
  s_add_u32 s65, s73, s72
  s_add_u32 m0, s68, 28672
  s_nop 0
  buffer_load_dwordx4 v32, s[8:11], s65 offen offset:0 lds
  s_add_u32 s72, s72, 128
  s_cmp_eq_u32 s72, 896
  s_cselect_b32 s72, 0, s72
  buffer_load_dwordx4 v33, s[8:11], s65 offen offset:1024 lds
  buffer_load_dwordx4 v34, s[8:11], s65 offen offset:2048 lds
  buffer_load_dwordx4 v35, s[8:11], s65 offen offset:3072 lds
  s_mul_i32 s57, s3, 100352
  s_lshl_b32 s4, s54, 7
  s_add_u32 s57, s57, s4
  s_mul_i32 s5, s3, 7
  s_lshr_b32 s6, s5, 1
  s_lshl_b32 s6, s6, 7
  s_and_b32 s5, s3, 1
  s_lshl_b32 s7, s5, 4
  s_add_u32 s6, s6, s7
  s_mul_i32 s59, s6, 896
  s_add_u32 s59, s59, s4
  s_mul_i32 s60, s5, 86016
  s_add_u32 s60, s60, 14336
  s_sub_u32 s61, 114688, s60
  s_lshl_b32 s6, s5, 6
  s_add_u32 s46, s4, s6
  s_mul_i32 s58, s5, 802816
  s_lshl_b32 s6, s55, 8
  s_add_u32 s58, s58, s6
  s_lshr_b32 s7, s3, 1
  s_lshl_b32 s6, s7, 7
  s_add_u32 s58, s58, s6
  s_lshl_b32 s53, s53, 1
  s_add_u32 s6, s53, s7
  s_mul_i32 s44, s6, 28672
  s_add_u32 s44, s44, s46
  s_and_b32 s5, s3, 1
  v_lshrrev_b32 v23, 3, v0
  v_and_b32 v29, 7, v0
  v_bfe_u32 v30, v0, 4, 1
  v_lshlrev_b32 v30, 2, v30
  v_xor_b32 v29, v29, v30
  v_lshlrev_b32 v29, 4, v29
  v_mul_u32_u24 v3, 896, v23
  v_add_u32 v3, v3, v29
  v_add_u32 v4, 6144, v3
  v_add_u32 v5, 12288, v3
  v_add_u32 v6, 18432, v3
  v_mul_u32_u24 v7, 3584, v23
  v_add_u32 v7, v7, v29
  v_add_u32 v8, 27648, v7
  v_add_u32 v9, 55296, v7
  v_add_u32 v10, 82944, v7
  v_lshrrev_b32 v23, 5, v0
  v_bfe_u32 v29, v0, 2, 2
  v_lshl_add_u32 v29, v23, 2, v29
  v_lshlrev_b32 v29, 7, v29
  v_bfe_u32 v30, v0, 3, 1
  v_xor_b32 v30, s5, v30
  v_lshl_add_u32 v29, v30, 6, v29
  v_bfe_u32 v30, v0, 4, 1
  v_lshl_add_u32 v29, v30, 5, v29
  v_and_b32 v30, 3, v0
  v_lshl_add_u32 v29, v30, 3, v29
  v_add_u32 v11, s62, v29
  v_xor_b32 v12, 64, v11
  v_lshlrev_b32 v14, 3, v23
  v_and_b32 v29, 31, v0
  v_mul_u32_u24 v29, 896, v29
  v_add_u32 v13, v29, v14
  v_add_u32 v25, s62, v1
  s_mul_i32 s47, s3, 28672
  s_sub_u32 s4, s3, 1
  s_and_b32 s4, s4, 3
  s_mul_i32 s4, s4, 12288
  s_add_u32 s4, s4, 114688
  v_add_u32 v29, s4, v1
  s_sub_u32 s4, s3, 2
  s_and_b32 s4, s4, 3
  s_mul_i32 s4, s4, 12288
  s_add_u32 s4, s4, 118784
  v_add_u32 v30, s4, v1
  s_sub_u32 s4, s3, 3
  s_and_b32 s4, s4, 3
  s_mul_i32 s4, s4, 12288
  s_add_u32 s4, s4, 122880
  v_add_u32 v31, s4, v1
  s_mul_i32 s66, s72, 1344
  s_add_u32 s66, s66, s67
  s_add_u32 m0, s45, 57344
  s_nop 0
  buffer_load_dwordx4 v36, s[12:15], s66 offen lds
  s_add_u32 s66, s66, 896
  s_add_u32 m0, s45, 58368
  s_nop 0
  buffer_load_dwordx4 v36, s[12:15], s66 offen lds
  s_add_u32 s66, s66, 896
  s_add_u32 m0, s45, 59392
  s_nop 0
  buffer_load_dwordx4 v36, s[12:15], s66 offen lds
  s_add_u32 s65, s73, s72
  s_add_u32 m0, s68, 57344
  s_nop 0
  buffer_load_dwordx4 v32, s[8:11], s65 offen offset:0 lds
  s_add_u32 s72, s72, 128
  s_cmp_eq_u32 s72, 896
  s_cselect_b32 s72, 0, s72
  buffer_load_dwordx4 v33, s[8:11], s65 offen offset:1024 lds
  buffer_load_dwordx4 v34, s[8:11], s65 offen offset:2048 lds
  buffer_load_dwordx4 v35, s[8:11], s65 offen offset:3072 lds
  s_waitcnt lgkmcnt(0)
  s_add_u32 s48, s48, 2654435760
  s_add_u32 s71, s71, s48
  s_add_u32 s71, s71, 16
  v_mov_b32 v18, s71
  s_mov_b64 exec, 1
  buffer_store_dword v18, off, s[28:31], s70 sc1
  s_mov_b64 exec, -1
  s_and_b32 s70, s70, 0xfffffe00
  s_waitcnt vmcnt(15)
  s_barrier
  ds_read_b128 v[80:83], v40 offset:0
  ds_read_b64_tr_b16 v[96:97], v52 offset:1024
  ds_read_b64_tr_b16 v[98:99], v52 offset:1280
  ds_read_b64_tr_b16 v[100:101], v52 offset:2048
  ds_read_b64_tr_b16 v[102:103], v52 offset:2304
  ds_read_b64_tr_b16 v[104:105], v52 offset:0
  ds_read_b64_tr_b16 v[106:107], v52 offset:256
  ds_read_b128 v[84:87], v41 offset:0
  ds_read_b64_tr_b16 v[108:109], v53 offset:1024
  ds_read_b64_tr_b16 v[110:111], v53 offset:1280
  ds_read_b64_tr_b16 v[112:113], v53 offset:2048
  ds_read_b64_tr_b16 v[114:115], v53 offset:2304
  ds_read_b64_tr_b16 v[116:117], v53 offset:0
  ds_read_b64_tr_b16 v[118:119], v53 offset:256
  s_waitcnt lgkmcnt(7)
  v_dot2c_f32_bf16 v39, v80, v80
  v_dot2c_f32_bf16 v208, v96, v37
  v_dot2c_f32_bf16 v38, v80, v37
  v_dot2c_f32_bf16 v209, v100, v37
  v_dot2c_f32_bf16 v210, v104, v37
  v_dot2c_f32_bf16 v39, v81, v81
  v_dot2c_f32_bf16 v208, v97, v37
  v_dot2c_f32_bf16 v38, v81, v37
  v_dot2c_f32_bf16 v209, v101, v37
  v_dot2c_f32_bf16 v210, v105, v37
  v_dot2c_f32_bf16 v39, v82, v82
  v_dot2c_f32_bf16 v208, v98, v37
  v_dot2c_f32_bf16 v38, v82, v37
  v_dot2c_f32_bf16 v209, v102, v37
  v_dot2c_f32_bf16 v210, v106, v37
  v_dot2c_f32_bf16 v39, v83, v83
  v_dot2c_f32_bf16 v208, v99, v37
  v_dot2c_f32_bf16 v38, v83, v37
  v_dot2c_f32_bf16 v209, v103, v37
  v_dot2c_f32_bf16 v210, v107, v37
  v_mfma_f32_32x32x16_bf16 v[144:159], v[96:99], v[80:83], 0
  ds_read_b128 v[88:91], v42 offset:0
  ds_read_b64_tr_b16 v[120:121], v54 offset:1024
  ds_read_b64_tr_b16 v[122:123], v54 offset:1280
  s_mul_i32 s66, s72, 1344
  s_add_u32 s66, s66, s67
  s_add_u32 m0, s45, 86016
  v_mfma_f32_32x32x16_bf16 v[160:175], v[80:83], v[100:103], 0
  buffer_load_dwordx4 v36, s[12:15], s66 offen lds
  ds_read_b64_tr_b16 v[124:125], v54 offset:2048
  ds_read_b64_tr_b16 v[126:127], v54 offset:2304
  s_add_u32 s66, s66, 896
  s_add_u32 m0, s45, 87040
  v_mfma_f32_32x32x16_bf16 v[176:191], v[104:107], v[80:83], 0
  buffer_load_dwordx4 v36, s[12:15], s66 offen lds
  ds_read_b64_tr_b16 v[128:129], v54 offset:0
  ds_read_b64_tr_b16 v[130:131], v54 offset:256
  s_waitcnt lgkmcnt(7)
  v_dot2c_f32_bf16 v39, v84, v84
  v_dot2c_f32_bf16 v38, v84, v37
  v_dot2c_f32_bf16 v39, v85, v85
  v_dot2c_f32_bf16 v38, v85, v37
  v_dot2c_f32_bf16 v39, v86, v86
  v_dot2c_f32_bf16 v38, v86, v37
  v_dot2c_f32_bf16 v39, v87, v87
  v_dot2c_f32_bf16 v38, v87, v37
  v_mfma_f32_32x32x16_bf16 v[144:159], v[108:111], v[84:87], v[144:159]
  ds_read_b128 v[92:95], v43 offset:0
  ds_read_b64_tr_b16 v[132:133], v55 offset:1024
  ds_read_b64_tr_b16 v[134:135], v55 offset:1280
  s_add_u32 s66, s66, 896
  s_add_u32 m0, s45, 88064
  v_mfma_f32_32x32x16_bf16 v[160:175], v[84:87], v[112:115], v[160:175]
  buffer_load_dwordx4 v36, s[12:15], s66 offen lds
  ds_read_b64_tr_b16 v[136:137], v55 offset:2048
  ds_read_b64_tr_b16 v[138:139], v55 offset:2304
  s_add_u32 s65, s73, s72
  s_add_u32 m0, s68, 86016
  v_mfma_f32_32x32x16_bf16 v[176:191], v[116:119], v[84:87], v[176:191]
  buffer_load_dwordx4 v32, s[8:11], s65 offen offset:0 lds
  ds_read_b64_tr_b16 v[140:141], v55 offset:0
  ds_read_b64_tr_b16 v[142:143], v55 offset:256
  s_waitcnt lgkmcnt(7)
  v_dot2c_f32_bf16 v39, v88, v88
  v_dot2c_f32_bf16 v38, v88, v37
  v_dot2c_f32_bf16 v39, v89, v89
  v_dot2c_f32_bf16 v38, v89, v37
  v_dot2c_f32_bf16 v39, v90, v90
  v_dot2c_f32_bf16 v38, v90, v37
  v_dot2c_f32_bf16 v39, v91, v91
  v_dot2c_f32_bf16 v38, v91, v37
  v_mfma_f32_32x32x16_bf16 v[144:159], v[120:123], v[88:91], v[144:159]
  s_waitcnt vmcnt(12)
  s_barrier
  ds_read_b128 v[80:83], v40 offset:28672
  ds_read_b64_tr_b16 v[96:97], v52 offset:29696
  ds_read_b64_tr_b16 v[98:99], v52 offset:29952
  s_add_u32 s72, s72, 128
  s_cmp_eq_u32 s72, 896
  s_cselect_b32 s72, 0, s72
  v_mfma_f32_32x32x16_bf16 v[160:175], v[88:91], v[124:127], v[160:175]
  buffer_load_dwordx4 v33, s[8:11], s65 offen offset:1024 lds
  ds_read_b64_tr_b16 v[100:101], v52 offset:30720
  ds_read_b64_tr_b16 v[102:103], v52 offset:30976
  v_mfma_f32_32x32x16_bf16 v[176:191], v[128:131], v[88:91], v[176:191]
  buffer_load_dwordx4 v34, s[8:11], s65 offen offset:2048 lds
  ds_read_b64_tr_b16 v[104:105], v52 offset:28672
  ds_read_b64_tr_b16 v[106:107], v52 offset:28928
  s_waitcnt lgkmcnt(7)
  v_dot2c_f32_bf16 v39, v92, v92
  v_dot2c_f32_bf16 v38, v92, v37
  v_dot2c_f32_bf16 v39, v93, v93
  v_dot2c_f32_bf16 v38, v93, v37
  v_dot2c_f32_bf16 v39, v94, v94
  v_dot2c_f32_bf16 v38, v94, v37
  v_dot2c_f32_bf16 v39, v95, v95
  v_dot2c_f32_bf16 v38, v95, v37
  v_mfma_f32_32x32x16_bf16 v[144:159], v[132:135], v[92:95], v[144:159]
  ds_read_b128 v[84:87], v41 offset:28672
  ds_read_b64_tr_b16 v[108:109], v53 offset:29696
  ds_read_b64_tr_b16 v[110:111], v53 offset:29952
  v_mfma_f32_32x32x16_bf16 v[160:175], v[92:95], v[136:139], v[160:175]
  buffer_load_dwordx4 v35, s[8:11], s65 offen offset:3072 lds
  ds_read_b64_tr_b16 v[112:113], v53 offset:30720
  ds_read_b64_tr_b16 v[114:115], v53 offset:30976
  s_mul_i32 s66, s72, 1344
  s_add_u32 s66, s66, s67
  s_add_u32 m0, s45, 114688
  v_mfma_f32_32x32x16_bf16 v[176:191], v[140:143], v[92:95], v[176:191]
  buffer_load_dwordx4 v36, s[12:15], s66 offen lds
  ds_read_b64_tr_b16 v[116:117], v53 offset:28672
  ds_read_b64_tr_b16 v[118:119], v53 offset:28928
  s_waitcnt lgkmcnt(7)
  v_dot2c_f32_bf16 v39, v80, v80
  v_dot2c_f32_bf16 v208, v96, v37
  v_dot2c_f32_bf16 v38, v80, v37
  v_dot2c_f32_bf16 v209, v100, v37
  v_dot2c_f32_bf16 v210, v104, v37
  v_dot2c_f32_bf16 v39, v81, v81
  v_dot2c_f32_bf16 v208, v97, v37
  v_dot2c_f32_bf16 v38, v81, v37
  v_dot2c_f32_bf16 v209, v101, v37
  v_dot2c_f32_bf16 v210, v105, v37
  v_dot2c_f32_bf16 v39, v82, v82
  v_dot2c_f32_bf16 v208, v98, v37
  v_dot2c_f32_bf16 v38, v82, v37
  v_dot2c_f32_bf16 v209, v102, v37
  v_dot2c_f32_bf16 v210, v106, v37
  v_dot2c_f32_bf16 v39, v83, v83
  v_dot2c_f32_bf16 v208, v99, v37
  v_dot2c_f32_bf16 v38, v83, v37
  v_dot2c_f32_bf16 v209, v103, v37
  v_dot2c_f32_bf16 v210, v107, v37
  v_mfma_f32_32x32x16_bf16 v[144:159], v[96:99], v[80:83], v[144:159]
  ds_read_b128 v[88:91], v42 offset:28672
  ds_read_b64_tr_b16 v[120:121], v54 offset:29696
  ds_read_b64_tr_b16 v[122:123], v54 offset:29952
  s_add_u32 s66, s66, 896
  s_add_u32 m0, s45, 115712
  v_mfma_f32_32x32x16_bf16 v[160:175], v[80:83], v[100:103], v[160:175]
  buffer_load_dwordx4 v36, s[12:15], s66 offen lds
  ds_read_b64_tr_b16 v[124:125], v54 offset:30720
  ds_read_b64_tr_b16 v[126:127], v54 offset:30976
  s_add_u32 s66, s66, 896
  s_add_u32 m0, s45, 116736
  v_mfma_f32_32x32x16_bf16 v[176:191], v[104:107], v[80:83], v[176:191]
  buffer_load_dwordx4 v36, s[12:15], s66 offen lds
  ds_read_b64_tr_b16 v[128:129], v54 offset:28672
  ds_read_b64_tr_b16 v[130:131], v54 offset:28928
  s_waitcnt lgkmcnt(7)
  v_dot2c_f32_bf16 v39, v84, v84
  v_dot2c_f32_bf16 v38, v84, v37
  v_dot2c_f32_bf16 v39, v85, v85
  v_dot2c_f32_bf16 v38, v85, v37
  v_dot2c_f32_bf16 v39, v86, v86
  v_dot2c_f32_bf16 v38, v86, v37
  v_dot2c_f32_bf16 v39, v87, v87
  v_dot2c_f32_bf16 v38, v87, v37
  v_mfma_f32_32x32x16_bf16 v[144:159], v[108:111], v[84:87], v[144:159]
  ds_read_b128 v[92:95], v43 offset:28672
  ds_read_b64_tr_b16 v[132:133], v55 offset:29696
  ds_read_b64_tr_b16 v[134:135], v55 offset:29952
  s_add_u32 s65, s73, s72
  s_add_u32 m0, s68, 114688
  v_mfma_f32_32x32x16_bf16 v[160:175], v[84:87], v[112:115], v[160:175]
  buffer_load_dwordx4 v32, s[8:11], s65 offen offset:0 lds
  ds_read_b64_tr_b16 v[136:137], v55 offset:30720
  ds_read_b64_tr_b16 v[138:139], v55 offset:30976
  s_add_u32 s72, s72, 128
  s_cmp_eq_u32 s72, 896
  s_cselect_b32 s72, 0, s72
  v_mfma_f32_32x32x16_bf16 v[176:191], v[116:119], v[84:87], v[176:191]
  buffer_load_dwordx4 v33, s[8:11], s65 offen offset:1024 lds
  ds_read_b64_tr_b16 v[140:141], v55 offset:28672
  ds_read_b64_tr_b16 v[142:143], v55 offset:28928
  s_waitcnt lgkmcnt(7)
  v_dot2c_f32_bf16 v39, v88, v88
  v_dot2c_f32_bf16 v38, v88, v37
  v_dot2c_f32_bf16 v39, v89, v89
  v_dot2c_f32_bf16 v38, v89, v37
  v_dot2c_f32_bf16 v39, v90, v90
  v_dot2c_f32_bf16 v38, v90, v37
  v_dot2c_f32_bf16 v39, v91, v91
  v_dot2c_f32_bf16 v38, v91, v37
  v_mfma_f32_32x32x16_bf16 v[144:159], v[120:123], v[88:91], v[144:159]
  s_waitcnt vmcnt(13)
  s_barrier
  ds_read_b128 v[80:83], v44 offset:0
  ds_read_b64_tr_b16 v[96:97], v56 offset:1024
  ds_read_b64_tr_b16 v[98:99], v56 offset:1280
  v_mfma_f32_32x32x16_bf16 v[160:175], v[88:91], v[124:127], v[160:175]
  buffer_load_dwordx4 v34, s[8:11], s65 offen offset:2048 lds
  ds_read_b64_tr_b16 v[100:101], v56 offset:2048
  ds_read_b64_tr_b16 v[102:103], v56 offset:2304
  v_mfma_f32_32x32x16_bf16 v[176:191], v[128:131], v[88:91], v[176:191]
  buffer_load_dwordx4 v35, s[8:11], s65 offen offset:3072 lds
  ds_read_b64_tr_b16 v[104:105], v56 offset:0
  ds_read_b64_tr_b16 v[106:107], v56 offset:256
  s_waitcnt lgkmcnt(7)
  v_dot2c_f32_bf16 v39, v92, v92
  v_dot2c_f32_bf16 v38, v92, v37
  v_dot2c_f32_bf16 v39, v93, v93
  v_dot2c_f32_bf16 v38, v93, v37
  v_dot2c_f32_bf16 v39, v94, v94
  v_dot2c_f32_bf16 v38, v94, v37
  v_dot2c_f32_bf16 v39, v95, v95
  v_dot2c_f32_bf16 v38, v95, v37
  v_mfma_f32_32x32x16_bf16 v[144:159], v[132:135], v[92:95], v[144:159]
  ds_read_b128 v[84:87], v45 offset:0
  ds_read_b64_tr_b16 v[108:109], v57 offset:1024
  ds_read_b64_tr_b16 v[110:111], v57 offset:1280
  s_mul_i32 s66, s72, 1344
  s_add_u32 s66, s66, s67
  s_add_u32 m0, s45, 0
  v_mfma_f32_32x32x16_bf16 v[160:175], v[92:95], v[136:139], v[160:175]
  buffer_load_dwordx4 v36, s[12:15], s66 offen lds
  ds_read_b64_tr_b16 v[112:113], v57 offset:2048
  ds_read_b64_tr_b16 v[114:115], v57 offset:2304
  s_add_u32 s66, s66, 896
  s_add_u32 m0, s45, 1024
  v_mfma_f32_32x32x16_bf16 v[176:191], v[140:143], v[92:95], v[176:191]
  buffer_load_dwordx4 v36, s[12:15], s66 offen lds
  ds_read_b64_tr_b16 v[116:117], v57 offset:0
  ds_read_b64_tr_b16 v[118:119], v57 offset:256
  s_waitcnt lgkmcnt(7)
  v_dot2c_f32_bf16 v39, v80, v80
  v_dot2c_f32_bf16 v208, v96, v37
  v_dot2c_f32_bf16 v38, v80, v37
  v_dot2c_f32_bf16 v209, v100, v37
  v_dot2c_f32_bf16 v210, v104, v37
  v_dot2c_f32_bf16 v39, v81, v81
  v_dot2c_f32_bf16 v208, v97, v37
  v_dot2c_f32_bf16 v38, v81, v37
  v_dot2c_f32_bf16 v209, v101, v37
  v_dot2c_f32_bf16 v210, v105, v37
  v_dot2c_f32_bf16 v39, v82, v82
  v_dot2c_f32_bf16 v208, v98, v37
  v_dot2c_f32_bf16 v38, v82, v37
  v_dot2c_f32_bf16 v209, v102, v37
  v_dot2c_f32_bf16 v210, v106, v37
  v_dot2c_f32_bf16 v39, v83, v83
  v_dot2c_f32_bf16 v208, v99, v37
  v_dot2c_f32_bf16 v38, v83, v37
  v_dot2c_f32_bf16 v209, v103, v37
  v_dot2c_f32_bf16 v210, v107, v37
  v_mfma_f32_32x32x16_bf16 v[144:159], v[96:99], v[80:83], v[144:159]
  ds_read_b128 v[88:91], v46 offset:0
  ds_read_b64_tr_b16 v[120:121], v58 offset:1024
  ds_read_b64_tr_b16 v[122:123], v58 offset:1280
  s_add_u32 s66, s66, 896
  s_add_u32 m0, s45, 2048
  v_mfma_f32_32x32x16_bf16 v[160:175], v[80:83], v[100:103], v[160:175]
  buffer_load_dwordx4 v36, s[12:15], s66 offen lds
  ds_read_b64_tr_b16 v[124:125], v58 offset:2048
  ds_read_b64_tr_b16 v[126:127], v58 offset:2304
  s_add_u32 s65, s73, s72
  s_add_u32 m0, s68, 0
  v_mfma_f32_32x32x16_bf16 v[176:191], v[104:107], v[80:83], v[176:191]
  buffer_load_dwordx4 v32, s[8:11], s65 offen offset:0 lds
  ds_read_b64_tr_b16 v[128:129], v58 offset:0
  ds_read_b64_tr_b16 v[130:131], v58 offset:256
  s_waitcnt lgkmcnt(7)
  v_dot2c_f32_bf16 v39, v84, v84
  v_dot2c_f32_bf16 v38, v84, v37
  v_dot2c_f32_bf16 v39, v85, v85
  v_dot2c_f32_bf16 v38, v85, v37
  v_dot2c_f32_bf16 v39, v86, v86
  v_dot2c_f32_bf16 v38, v86, v37
  v_dot2c_f32_bf16 v39, v87, v87
  v_dot2c_f32_bf16 v38, v87, v37
  v_mfma_f32_32x32x16_bf16 v[144:159], v[108:111], v[84:87], v[144:159]
  ds_read_b128 v[92:95], v47 offset:0
  ds_read_b64_tr_b16 v[132:133], v59 offset:1024
  ds_read_b64_tr_b16 v[134:135], v59 offset:1280
  s_add_u32 s72, s72, 128
  s_cmp_eq_u32 s72, 896
  s_cselect_b32 s72, 0, s72
  v_mfma_f32_32x32x16_bf16 v[160:175], v[84:87], v[112:115], v[160:175]
  buffer_load_dwordx4 v33, s[8:11], s65 offen offset:1024 lds
  ds_read_b64_tr_b16 v[136:137], v59 offset:2048
  ds_read_b64_tr_b16 v[138:139], v59 offset:2304
  v_mfma_f32_32x32x16_bf16 v[176:191], v[116:119], v[84:87], v[176:191]
  buffer_load_dwordx4 v34, s[8:11], s65 offen offset:2048 lds
  ds_read_b64_tr_b16 v[140:141], v59 offset:0
  ds_read_b64_tr_b16 v[142:143], v59 offset:256
  s_waitcnt lgkmcnt(7)
  v_dot2c_f32_bf16 v39, v88, v88
  v_dot2c_f32_bf16 v38, v88, v37
  v_dot2c_f32_bf16 v39, v89, v89
  v_dot2c_f32_bf16 v38, v89, v37
  v_dot2c_f32_bf16 v39, v90, v90
  v_dot2c_f32_bf16 v38, v90, v37
  v_dot2c_f32_bf16 v39, v91, v91
  v_dot2c_f32_bf16 v38, v91, v37
  v_mfma_f32_32x32x16_bf16 v[144:159], v[120:123], v[88:91], v[144:159]
  s_waitcnt vmcnt(13)
  s_barrier
  ds_read_b128 v[80:83], v44 offset:28672
  ds_read_b64_tr_b16 v[96:97], v56 offset:29696
  ds_read_b64_tr_b16 v[98:99], v56 offset:29952
  v_mfma_f32_32x32x16_bf16 v[160:175], v[88:91], v[124:127], v[160:175]
  buffer_load_dwordx4 v35, s[8:11], s65 offen offset:3072 lds
  ds_read_b64_tr_b16 v[100:101], v56 offset:30720
  ds_read_b64_tr_b16 v[102:103], v56 offset:30976
  s_mul_i32 s66, s72, 1344
  s_add_u32 s66, s66, s67
  s_add_u32 m0, s45, 28672
  v_mfma_f32_32x32x16_bf16 v[176:191], v[128:131], v[88:91], v[176:191]
  buffer_load_dwordx4 v36, s[12:15], s66 offen lds
  ds_read_b64_tr_b16 v[104:105], v56 offset:28672
  ds_read_b64_tr_b16 v[106:107], v56 offset:28928
  s_waitcnt lgkmcnt(7)
  v_dot2c_f32_bf16 v39, v92, v92
  v_dot2c_f32_bf16 v38, v92, v37
  v_dot2c_f32_bf16 v39, v93, v93
  v_dot2c_f32_bf16 v38, v93, v37
  v_dot2c_f32_bf16 v39, v94, v94
  v_dot2c_f32_bf16 v38, v94, v37
  v_dot2c_f32_bf16 v39, v95, v95
  v_dot2c_f32_bf16 v38, v95, v37
  v_mfma_f32_32x32x16_bf16 v[144:159], v[132:135], v[92:95], v[144:159]
  ds_read_b128 v[84:87], v45 offset:28672
  ds_read_b64_tr_b16 v[108:109], v57 offset:29696
  ds_read_b64_tr_b16 v[110:111], v57 offset:29952
  s_add_u32 s66, s66, 896
  s_add_u32 m0, s45, 29696
  v_mfma_f32_32x32x16_bf16 v[160:175], v[92:95], v[136:139], v[160:175]
  buffer_load_dwordx4 v36, s[12:15], s66 offen lds
  ds_read_b64_tr_b16 v[112:113], v57 offset:30720
  ds_read_b64_tr_b16 v[114:115], v57 offset:30976
  s_add_u32 s66, s66, 896
  s_add_u32 m0, s45, 30720
  v_mfma_f32_32x32x16_bf16 v[176:191], v[140:143], v[92:95], v[176:191]
  buffer_load_dwordx4 v36, s[12:15], s66 offen lds
  ds_read_b64_tr_b16 v[116:117], v57 offset:28672
  ds_read_b64_tr_b16 v[118:119], v57 offset:28928
  s_waitcnt lgkmcnt(7)
  v_dot2c_f32_bf16 v39, v80, v80
  v_dot2c_f32_bf16 v208, v96, v37
  v_dot2c_f32_bf16 v38, v80, v37
  v_dot2c_f32_bf16 v209, v100, v37
  v_dot2c_f32_bf16 v210, v104, v37
  v_dot2c_f32_bf16 v39, v81, v81
  v_dot2c_f32_bf16 v208, v97, v37
  v_dot2c_f32_bf16 v38, v81, v37
  v_dot2c_f32_bf16 v209, v101, v37
  v_dot2c_f32_bf16 v210, v105, v37
  v_dot2c_f32_bf16 v39, v82, v82
  v_dot2c_f32_bf16 v208, v98, v37
  v_dot2c_f32_bf16 v38, v82, v37
  v_dot2c_f32_bf16 v209, v102, v37
  v_dot2c_f32_bf16 v210, v106, v37
  v_dot2c_f32_bf16 v39, v83, v83
  v_dot2c_f32_bf16 v208, v99, v37
  v_dot2c_f32_bf16 v38, v83, v37
  v_dot2c_f32_bf16 v209, v103, v37
  v_dot2c_f32_bf16 v210, v107, v37
  v_mfma_f32_32x32x16_bf16 v[144:159], v[96:99], v[80:83], v[144:159]
  ds_read_b128 v[88:91], v46 offset:28672
  ds_read_b64_tr_b16 v[120:121], v58 offset:29696
  ds_read_b64_tr_b16 v[122:123], v58 offset:29952
  s_add_u32 s65, s73, s72
  s_add_u32 m0, s68, 28672
  v_mfma_f32_32x32x16_bf16 v[160:175], v[80:83], v[100:103], v[160:175]
  buffer_load_dwordx4 v32, s[8:11], s65 offen offset:0 lds
  ds_read_b64_tr_b16 v[124:125], v58 offset:30720
  ds_read_b64_tr_b16 v[126:127], v58 offset:30976
  s_add_u32 s72, s72, 128
  s_cmp_eq_u32 s72, 896
  s_cselect_b32 s72, 0, s72
  v_mfma_f32_32x32x16_bf16 v[176:191], v[104:107], v[80:83], v[176:191]
  buffer_load_dwordx4 v33, s[8:11], s65 offen offset:1024 lds
  ds_read_b64_tr_b16 v[128:129], v58 offset:28672
  ds_read_b64_tr_b16 v[130:131], v58 offset:28928
  s_waitcnt lgkmcnt(7)
  v_dot2c_f32_bf16 v39, v84, v84
  v_dot2c_f32_bf16 v38, v84, v37
  v_dot2c_f32_bf16 v39, v85, v85
  v_dot2c_f32_bf16 v38, v85, v37
  v_dot2c_f32_bf16 v39, v86, v86
  v_dot2c_f32_bf16 v38, v86, v37
  v_dot2c_f32_bf16 v39, v87, v87
  v_dot2c_f32_bf16 v38, v87, v37
  v_mfma_f32_32x32x16_bf16 v[144:159], v[108:111], v[84:87], v[144:159]
  ds_read_b128 v[92:95], v47 offset:28672
  ds_read_b64_tr_b16 v[132:133], v59 offset:29696
  ds_read_b64_tr_b16 v[134:135], v59 offset:29952
  v_mfma_f32_32x32x16_bf16 v[160:175], v[84:87], v[112:115], v[160:175]
  buffer_load_dwordx4 v34, s[8:11], s65 offen offset:2048 lds
  ds_read_b64_tr_b16 v[136:137], v59 offset:30720
  ds_read_b64_tr_b16 v[138:139], v59 offset:30976
  v_mfma_f32_32x32x16_bf16 v[176:191], v[116:119], v[84:87], v[176:191]
  buffer_load_dwordx4 v35, s[8:11], s65 offen offset:3072 lds
  ds_read_b64_tr_b16 v[140:141], v59 offset:28672
  ds_read_b64_tr_b16 v[142:143], v59 offset:28928
  s_waitcnt lgkmcnt(7)
  v_dot2c_f32_bf16 v39, v88, v88
  v_dot2c_f32_bf16 v38, v88, v37
  v_dot2c_f32_bf16 v39, v89, v89
  v_dot2c_f32_bf16 v38, v89, v37
  v_dot2c_f32_bf16 v39, v90, v90
  v_dot2c_f32_bf16 v38, v90, v37
  v_dot2c_f32_bf16 v39, v91, v91
  v_dot2c_f32_bf16 v38, v91, v37
  v_mfma_f32_32x32x16_bf16 v[144:159], v[120:123], v[88:91], v[144:159]
  s_waitcnt vmcnt(14)
  s_barrier
  ds_read_b128 v[80:83], v48 offset:0
  ds_read_b64_tr_b16 v[96:97], v60 offset:1024
  ds_read_b64_tr_b16 v[98:99], v60 offset:1280
  buffer_load_dwordx2 v[224:225], v27, s[28:31], s70 offen sc1
  v_mfma_f32_32x32x16_bf16 v[160:175], v[88:91], v[124:127], v[160:175]
  ds_read_b64_tr_b16 v[100:101], v60 offset:2048
  ds_read_b64_tr_b16 v[102:103], v60 offset:2304
  v_mfma_f32_32x32x16_bf16 v[176:191], v[128:131], v[88:91], v[176:191]
  ds_read_b64_tr_b16 v[104:105], v60 offset:0
  ds_read_b64_tr_b16 v[106:107], v60 offset:256
  s_waitcnt lgkmcnt(7)
  v_dot2c_f32_bf16 v39, v92, v92
  v_dot2c_f32_bf16 v38, v92, v37
  v_dot2c_f32_bf16 v39, v93, v93
  v_dot2c_f32_bf16 v38, v93, v37
  v_dot2c_f32_bf16 v39, v94, v94
  v_dot2c_f32_bf16 v38, v94, v37
  v_dot2c_f32_bf16 v39, v95, v95
  v_dot2c_f32_bf16 v38, v95, v37
  v_mfma_f32_32x32x16_bf16 v[144:159], v[132:135], v[92:95], v[144:159]
  ds_read_b128 v[84:87], v49 offset:0
  ds_read_b64_tr_b16 v[108:109], v61 offset:1024
  ds_read_b64_tr_b16 v[110:111], v61 offset:1280
  v_mfma_f32_32x32x16_bf16 v[160:175], v[92:95], v[136:139], v[160:175]
  ds_read_b64_tr_b16 v[112:113], v61 offset:2048
  ds_read_b64_tr_b16 v[114:115], v61 offset:2304
  s_lshl_b32 s4, s49, 18
  s_lshl_b32 s5, s51, 12
  s_add_u32 s4, s4, s5
  s_add_u32 s4, s4, 16777216
  s_mul_i32 s5, s49, 512
  s_add_u32 s5, s5, 131072
  v_lshlrev_b32 v253, 7, v0
  v_and_b32 v252, 511, v253
  v_add_u32 v252, s5, v252
  v_add_u32 v253, s4, v253
  v_cmp_gt_u32 vcc, 32, v0
  s_nop 1
  v_cndmask_b32 v253, v252, v253, vcc
  global_load_dword v252, v253, s[28:29]
  v_mfma_f32_32x32x16_bf16 v[176:191], v[140:143], v[92:95], v[176:191]
  ds_read_b64_tr_b16 v[116:117], v61 offset:0
  ds_read_b64_tr_b16 v[118:119], v61 offset:256
  s_waitcnt lgkmcnt(7)
  v_dot2c_f32_bf16 v39, v80, v80
  v_dot2c_f32_bf16 v208, v96, v37
  v_dot2c_f32_bf16 v38, v80, v37
  v_dot2c_f32_bf16 v209, v100, v37
  v_dot2c_f32_bf16 v210, v104, v37
  v_dot2c_f32_bf16 v39, v81, v81
  v_dot2c_f32_bf16 v208, v97, v37
  v_dot2c_f32_bf16 v38, v81, v37
  v_dot2c_f32_bf16 v209, v101, v37
  v_dot2c_f32_bf16 v210, v105, v37
  v_dot2c_f32_bf16 v39, v82, v82
  v_dot2c_f32_bf16 v208, v98, v37
  v_dot2c_f32_bf16 v38, v82, v37
  v_dot2c_f32_bf16 v209, v102, v37
  v_dot2c_f32_bf16 v210, v106, v37
  v_dot2c_f32_bf16 v39, v83, v83
  v_dot2c_f32_bf16 v208, v99, v37
  v_dot2c_f32_bf16 v38, v83, v37
  v_dot2c_f32_bf16 v209, v103, v37
  v_dot2c_f32_bf16 v210, v107, v37
  v_mfma_f32_32x32x16_bf16 v[144:159], v[96:99], v[80:83], v[144:159]
  ds_read_b128 v[88:91], v50 offset:0
  ds_read_b64_tr_b16 v[120:121], v62 offset:1024
  ds_read_b64_tr_b16 v[122:123], v62 offset:1280
  v_mfma_f32_32x32x16_bf16 v[160:175], v[80:83], v[100:103], v[160:175]
  ds_read_b64_tr_b16 v[124:125], v62 offset:2048
  ds_read_b64_tr_b16 v[126:127], v62 offset:2304
  v_mfma_f32_32x32x16_bf16 v[176:191], v[104:107], v[80:83], v[176:191]
  ds_read_b64_tr_b16 v[128:129], v62 offset:0
  ds_read_b64_tr_b16 v[130:131], v62 offset:256
  s_waitcnt lgkmcnt(7)
  v_dot2c_f32_bf16 v39, v84, v84
  v_dot2c_f32_bf16 v38, v84, v37
  v_dot2c_f32_bf16 v39, v85, v85
  v_dot2c_f32_bf16 v38, v85, v37
  v_dot2c_f32_bf16 v39, v86, v86
  v_dot2c_f32_bf16 v38, v86, v37
  v_dot2c_f32_bf16 v39, v87, v87
  v_dot2c_f32_bf16 v38, v87, v37
  v_mfma_f32_32x32x16_bf16 v[144:159], v[108:111], v[84:87], v[144:159]
  ds_read_b128 v[92:95], v51 offset:0
  ds_read_b64_tr_b16 v[132:133], v63 offset:1024
  ds_read_b64_tr_b16 v[134:135], v63 offset:1280
  v_lshlrev_b32 v248, 7, v0
  v_mov_b32 v251, s2
  v_min_u32 v249, 1664, v248
  v_lshl_add_u32 v251, v251, 2, s3
  v_mfma_f32_32x32x16_bf16 v[160:175], v[84:87], v[112:115], v[160:175]
  ds_read_b64_tr_b16 v[136:137], v63 offset:2048
  ds_read_b64_tr_b16 v[138:139], v63 offset:2304
  v_min_u32 v250, 3072, v248
  v_lshrrev_b32 v248, 5, v251
  v_lshl_add_u32 v248, v248, 2, s3
  v_mul_u32_u24 v248, 3200, v248
  v_add_u32 v250, v248, v250
  v_mul_u32_u24 v251, 1792, v251
  v_mfma_f32_32x32x16_bf16 v[176:191], v[116:119], v[84:87], v[176:191]
  ds_read_b64_tr_b16 v[140:141], v63 offset:0
  ds_read_b64_tr_b16 v[142:143], v63 offset:256
  v_min_u32 v250, 401280, v250
  v_add_u32 v249, v251, v249
  v_min_u32 v249, 1605504, v249
  s_waitcnt lgkmcnt(7)
  v_dot2c_f32_bf16 v39, v88, v88
  v_dot2c_f32_bf16 v38, v88, v37
  v_dot2c_f32_bf16 v39, v89, v89
  v_dot2c_f32_bf16 v38, v89, v37
  v_dot2c_f32_bf16 v39, v90, v90
  v_dot2c_f32_bf16 v38, v90, v37
  v_dot2c_f32_bf16 v39, v91, v91
  v_dot2c_f32_bf16 v38, v91, v37
  v_mfma_f32_32x32x16_bf16 v[144:159], v[120:123], v[88:91], v[144:159]
  s_waitcnt vmcnt(9)
  s_barrier
  ds_read_b128 v[80:83], v40 offset:0
  ds_read_b64_tr_b16 v[96:97], v52 offset:1024
  ds_read_b64_tr_b16 v[98:99], v52 offset:1280
  global_load_dword v248, v250, s[16:17]
  v_mfma_f32_32x32x16_bf16 v[160:175], v[88:91], v[124:127], v[160:175]
  ds_read_b64_tr_b16 v[100:101], v52 offset:2048
  ds_read_b64_tr_b16 v[102:103], v52 offset:2304
  global_load_dword v248, v249, s[20:21]
  v_mfma_f32_32x32x16_bf16 v[176:191], v[128:131], v[88:91], v[176:191]
  ds_read_b64_tr_b16 v[104:105], v52 offset:0
  ds_read_b64_tr_b16 v[106:107], v52 offset:256
  global_load_dword v248, v249, s[24:25]
  s_waitcnt lgkmcnt(7)
  v_dot2c_f32_bf16 v39, v92, v92
  v_dot2c_f32_bf16 v38, v92, v37
  v_dot2c_f32_bf16 v39, v93, v93
  v_dot2c_f32_bf16 v38, v93, v37
  v_dot2c_f32_bf16 v39, v94, v94
  v_dot2c_f32_bf16 v38, v94, v37
  v_dot2c_f32_bf16 v39, v95, v95
  v_dot2c_f32_bf16 v38, v95, v37
  v_mfma_f32_32x32x16_bf16 v[144:159], v[132:135], v[92:95], v[144:159]
  ds_read_b128 v[84:87], v41 offset:0
  ds_read_b64_tr_b16 v[108:109], v53 offset:1024
  ds_read_b64_tr_b16 v[110:111], v53 offset:1280
  s_lshl_b32 s6, s51, 4
  s_add_u32 s6, s6, s49
  s_lshl_b32 s6, s6, 11
  s_add_u32 s64, s6, 5242880
  s_lshr_b32 s7, s3, 1
  s_add_u32 s7, s53, s7
  s_lshr_b32 s4, s46, 6
  v_mfma_f32_32x32x16_bf16 v[160:175], v[92:95], v[136:139], v[160:175]
  ds_read_b64_tr_b16 v[112:113], v53 offset:2048
  ds_read_b64_tr_b16 v[114:115], v53 offset:2304
  s_mul_i32 s5, s7, 14
  s_add_u32 s5, s5, s4
  s_cmp_lt_u32 s2, 224
  s_cselect_b32 s4, 0, 33554432
  s_lshl_b32 s65, s5, 11
  s_add_u32 s65, s65, s4
  s_add_u32 s65, s65, 7340032
  v_mfma_f32_32x32x16_bf16 v[176:191], v[140:143], v[92:95], v[176:191]
  ds_read_b64_tr_b16 v[116:117], v53 offset:0
  ds_read_b64_tr_b16 v[118:119], v53 offset:256
  s_lshl_b32 s66, s5, 8
  s_add_u32 s66, s66, s4
  s_add_u32 s66, s66, 655360
  s_mul_i32 s6, s56, 112
  s_lshl_b32 s7, s55, 3
  s_add_u32 s6, s6, s7
  s_lshl_b32 s6, s6, 10
  s_waitcnt lgkmcnt(7)
  v_dot2c_f32_bf16 v39, v80, v80
  v_dot2c_f32_bf16 v208, v96, v37
  v_dot2c_f32_bf16 v38, v80, v37
  v_dot2c_f32_bf16 v209, v100, v37
  v_dot2c_f32_bf16 v210, v104, v37
  v_dot2c_f32_bf16 v39, v81, v81
  v_dot2c_f32_bf16 v208, v97, v37
  v_dot2c_f32_bf16 v38, v81, v37
  v_dot2c_f32_bf16 v209, v101, v37
  v_dot2c_f32_bf16 v210, v105, v37
  v_dot2c_f32_bf16 v39, v82, v82
  v_dot2c_f32_bf16 v208, v98, v37
  v_dot2c_f32_bf16 v38, v82, v37
  v_dot2c_f32_bf16 v209, v102, v37
  v_dot2c_f32_bf16 v210, v106, v37
  v_dot2c_f32_bf16 v39, v83, v83
  v_dot2c_f32_bf16 v208, v99, v37
  v_dot2c_f32_bf16 v38, v83, v37
  v_dot2c_f32_bf16 v209, v103, v37
  v_dot2c_f32_bf16 v210, v107, v37
  v_mfma_f32_32x32x16_bf16 v[144:159], v[96:99], v[80:83], v[144:159]
  ds_read_b128 v[88:91], v42 offset:0
  ds_read_b64_tr_b16 v[120:121], v54 offset:1024
  ds_read_b64_tr_b16 v[122:123], v54 offset:1280
  s_add_u32 s6, s6, s4
  s_add_u32 s67, s6, 9437184
  s_add_u32 s68, s67, 4096
  s_mul_i32 s72, s56, 28672
  s_add_u32 s72, s72, 7340032
  s_mul_i32 s73, s56, 3584
  s_add_u32 s73, s73, 655360
  v_mfma_f32_32x32x16_bf16 v[160:175], v[80:83], v[100:103], v[160:175]
  ds_read_b64_tr_b16 v[124:125], v54 offset:2048
  ds_read_b64_tr_b16 v[126:127], v54 offset:2304
  s_lshl_b32 s4, s49, 6
  s_mul_i32 s4, s4, 8
  s_add_u32 s4, s4, 131072
  v_add_u32 v15, s50, v0
  v_and_b32 v15, 15, v15
  s_lshl_b32 s5, s3, 4
  v_add_u32 v15, s5, v15
  v_mfma_f32_32x32x16_bf16 v[176:191], v[104:107], v[80:83], v[176:191]
  ds_read_b64_tr_b16 v[128:129], v54 offset:0
  ds_read_b64_tr_b16 v[130:131], v54 offset:256
  v_and_b32 v18, 3, v0
  v_lshl_add_u32 v18, v18, 4, s50
  v_cmp_gt_u32 vcc, 16, v0
  s_nop 1
  v_cndmask_b32 v15, v18, v15, vcc
  v_mul_u32_u24 v15, 8, v15
  v_add_u32 v15, s4, v15
  v_bfrev_b32 v18, 1
  s_waitcnt lgkmcnt(7)
  v_dot2c_f32_bf16 v39, v84, v84
  v_dot2c_f32_bf16 v38, v84, v37
  v_dot2c_f32_bf16 v39, v85, v85
  v_dot2c_f32_bf16 v38, v85, v37
  v_dot2c_f32_bf16 v39, v86, v86
  v_dot2c_f32_bf16 v38, v86, v37
  v_dot2c_f32_bf16 v39, v87, v87
  v_dot2c_f32_bf16 v38, v87, v37
  v_mfma_f32_32x32x16_bf16 v[144:159], v[108:111], v[84:87], v[144:159]
  ds_read_b128 v[92:95], v43 offset:0
  ds_read_b64_tr_b16 v[132:133], v55 offset:1024
  ds_read_b64_tr_b16 v[134:135], v55 offset:1280
  v_cmp_gt_u32 vcc, 20, v0
  s_nop 1
  v_cndmask_b32 v15, v18, v15, vcc
  s_lshl_b32 s6, s3, 12
  v_add_u32 v2, s6, v1
  s_lshl_b32 s6, s49, 18
  s_add_u32 s49, s6, 16777216
  s_lshl_b32 s52, s50, 14
  v_mfma_f32_32x32x16_bf16 v[160:175], v[84:87], v[112:115], v[160:175]
  ds_read_b64_tr_b16 v[136:137], v55 offset:2048
  ds_read_b64_tr_b16 v[138:139], v55 offset:2304
  s_add_u32 s14, s28, s49
  s_addc_u32 s15, s29, 0
  s_add_u32 s12, s14, s52
  s_addc_u32 s13, s15, 0
  s_add_u32 s5, s5, s50
  s_mul_i32 s5, s5, 8
  s_add_u32 s50, s4, s5
  v_mfma_f32_32x32x16_bf16 v[176:191], v[116:119], v[84:87], v[176:191]
  ds_read_b64_tr_b16 v[140:141], v55 offset:0
  ds_read_b64_tr_b16 v[142:143], v55 offset:256
  s_mov_b32 s0, 0x0fffffff
  s_mov_b32 s1, 0x0fffffff
  v_mov_b32 v26, s53
  v_mov_b32 v18, s51
  v_cmp_gt_u32 vcc, 16, v0
  s_nop 1
  v_cndmask_b32 v26, v26, v18, vcc
  v_mov_b32 v18, s56
  s_waitcnt lgkmcnt(7)
  v_dot2c_f32_bf16 v39, v88, v88
  v_dot2c_f32_bf16 v38, v88, v37
  v_dot2c_f32_bf16 v39, v89, v89
  v_dot2c_f32_bf16 v38, v89, v37
  v_dot2c_f32_bf16 v39, v90, v90
  v_dot2c_f32_bf16 v38, v90, v37
  v_dot2c_f32_bf16 v39, v91, v91
  v_dot2c_f32_bf16 v38, v91, v37
  v_mfma_f32_32x32x16_bf16 v[144:159], v[120:123], v[88:91], v[144:159]
  s_waitcnt vmcnt(5)
  s_barrier
  ds_read_b128 v[80:83], v40 offset:28672
  ds_read_b64_tr_b16 v[96:97], v52 offset:29696
  ds_read_b64_tr_b16 v[98:99], v52 offset:29952
  v_cmp_lt_u32 vcc, 47, v0
  s_nop 1
  v_cndmask_b32 v26, v26, v18, vcc
  v_lshrrev_b32 v18, 4, v0
  v_cmp_eq_u32 vcc, 2, v18
  s_nop 1
  v_addc_co_u32 v26, vcc, 0, v26, vcc
  v_and_b32 v18, 15, v0
  v_lshlrev_b32 v18, 2, v18
  v_mfma_f32_32x32x16_bf16 v[160:175], v[88:91], v[124:127], v[160:175]
  ds_read_b64_tr_b16 v[100:101], v52 offset:30720
  ds_read_b64_tr_b16 v[102:103], v52 offset:30976
  v_lshl_add_u32 v26, v26, 7, v18
  v_add_u32 v26, 393216, v26
  s_and_b32 s4, s2, 7
  s_lshl_b32 s4, s4, 3
  s_lshr_b32 s5, s2, 5
  s_add_u32 s4, s4, s5
  s_bfe_u32 s5, s2, 0x20003
  v_mfma_f32_32x32x16_bf16 v[176:191], v[128:131], v[88:91], v[176:191]
  ds_read_b64_tr_b16 v[104:105], v52 offset:28672
  ds_read_b64_tr_b16 v[106:107], v52 offset:28928
  s_lshl_b32 s5, s5, 2
  s_add_u32 s5, s5, s3
  s_lshl_b32 s6, s4, 4
  s_add_u32 s6, s6, s5
  s_lshl_b32 s7, s6, 11
  s_add_u32 s7, s7, 5242880
  s_add_u32 s18, s28, s7
  s_waitcnt lgkmcnt(7)
  v_dot2c_f32_bf16 v39, v92, v92
  v_dot2c_f32_bf16 v38, v92, v37
  v_dot2c_f32_bf16 v39, v93, v93
  v_dot2c_f32_bf16 v38, v93, v37
  v_dot2c_f32_bf16 v39, v94, v94
  v_dot2c_f32_bf16 v38, v94, v37
  v_dot2c_f32_bf16 v39, v95, v95
  v_dot2c_f32_bf16 v38, v95, v37
  v_mfma_f32_32x32x16_bf16 v[144:159], v[132:135], v[92:95], v[144:159]
  ds_read_b128 v[84:87], v41 offset:28672
  ds_read_b64_tr_b16 v[108:109], v53 offset:29696
  ds_read_b64_tr_b16 v[110:111], v53 offset:29952
  s_addc_u32 s19, s29, 0
  s_mul_i32 s7, s6, 7168
  s_add_u32 s7, s7, 9440256
  s_add_u32 s22, s28, s7
  s_addc_u32 s23, s29, 0
  s_mul_i32 s6, s4, 14
  s_add_u32 s6, s6, s5
  v_mfma_f32_32x32x16_bf16 v[160:175], v[92:95], v[136:139], v[160:175]
  ds_read_b64_tr_b16 v[112:113], v53 offset:30720
  ds_read_b64_tr_b16 v[114:115], v53 offset:30976
  s_lshl_b32 s6, s6, 11
  s_add_u32 s6, s6, 7340032
  s_mul_i32 s7, s4, 3584
  s_add_u32 s7, s7, 633856
  s_mul_i32 s51, s5, 1536
  s_add_u32 s7, s7, s51
  s_cmp_lt_u32 s5, 14
  v_mfma_f32_32x32x16_bf16 v[176:191], v[140:143], v[92:95], v[176:191]
  ds_read_b64_tr_b16 v[116:117], v53 offset:28672
  ds_read_b64_tr_b16 v[118:119], v53 offset:28928
  s_cselect_b32 s6, s6, s7
  s_add_u32 s26, s28, s6
  s_addc_u32 s27, s29, 0
  s_lshl_b32 s4, s4, 5
  s_add_u32 s4, s4, s5
  s_lshl_b32 s4, s4, 2
  s_add_u32 s51, s4, 393216
  s_waitcnt lgkmcnt(7)
  v_dot2c_f32_bf16 v39, v80, v80
  v_dot2c_f32_bf16 v208, v96, v37
  v_dot2c_f32_bf16 v38, v80, v37
  v_dot2c_f32_bf16 v209, v100, v37
  v_dot2c_f32_bf16 v210, v104, v37
  v_dot2c_f32_bf16 v39, v81, v81
  v_dot2c_f32_bf16 v208, v97, v37
  v_dot2c_f32_bf16 v38, v81, v37
  v_dot2c_f32_bf16 v209, v101, v37
  v_dot2c_f32_bf16 v210, v105, v37
  v_dot2c_f32_bf16 v39, v82, v82
  v_dot2c_f32_bf16 v208, v98, v37
  v_dot2c_f32_bf16 v38, v82, v37
  v_dot2c_f32_bf16 v209, v102, v37
  v_dot2c_f32_bf16 v210, v106, v37
  v_dot2c_f32_bf16 v39, v83, v83
  v_dot2c_f32_bf16 v208, v99, v37
  v_dot2c_f32_bf16 v38, v83, v37
  v_dot2c_f32_bf16 v209, v103, v37
  v_dot2c_f32_bf16 v210, v107, v37
  v_mfma_f32_32x32x16_bf16 v[144:159], v[96:99], v[80:83], v[144:159]
  ds_read_b128 v[88:91], v42 offset:28672
  ds_read_b64_tr_b16 v[120:121], v54 offset:29696
  ds_read_b64_tr_b16 v[122:123], v54 offset:29952
  ds_read_b64_tr_b16 v[124:125], v54 offset:30720
  ds_read_b64_tr_b16 v[126:127], v54 offset:30976
  v_mfma_f32_32x32x16_bf16 v[160:175], v[80:83], v[100:103], v[160:175]
  ds_read_b64_tr_b16 v[128:129], v54 offset:28672
  ds_read_b64_tr_b16 v[130:131], v54 offset:28928
  ds_read_b128 v[92:95], v43 offset:28672
  ds_read_b64_tr_b16 v[132:133], v55 offset:29696
  ds_read_b64_tr_b16 v[134:135], v55 offset:29952
  v_mfma_f32_32x32x16_bf16 v[176:191], v[104:107], v[80:83], v[176:191]
  ds_read_b64_tr_b16 v[136:137], v55 offset:30720
  ds_read_b64_tr_b16 v[138:139], v55 offset:30976
  ds_read_b64_tr_b16 v[140:141], v55 offset:28672
  ds_read_b64_tr_b16 v[142:143], v55 offset:28928
  ds_write_b128 v29, v[208:211]
  ds_write_b128 v30, v[208:211]
  ds_write_b128 v31, v[208:211]
  s_waitcnt lgkmcnt(10)
  v_dot2c_f32_bf16 v39, v84, v84
  v_dot2c_f32_bf16 v38, v84, v37
  v_dot2c_f32_bf16 v39, v85, v85
  v_dot2c_f32_bf16 v38, v85, v37
  v_dot2c_f32_bf16 v39, v86, v86
  v_dot2c_f32_bf16 v38, v86, v37
  v_dot2c_f32_bf16 v39, v87, v87
  v_dot2c_f32_bf16 v38, v87, v37
  v_dot2c_f32_bf16 v39, v88, v88
  v_dot2c_f32_bf16 v38, v88, v37
  v_dot2c_f32_bf16 v39, v89, v89
  v_dot2c_f32_bf16 v38, v89, v37
  v_dot2c_f32_bf16 v39, v90, v90
  v_dot2c_f32_bf16 v38, v90, v37
  v_dot2c_f32_bf16 v39, v91, v91
  v_dot2c_f32_bf16 v38, v91, v37
  v_mfma_f32_32x32x16_bf16 v[144:159], v[108:111], v[84:87], v[144:159]
  s_waitcnt lgkmcnt(0)
  s_barrier
  v_mfma_f32_32x32x16_bf16 v[160:175], v[84:87], v[112:115], v[160:175]
  ds_read_b128 v[212:215], v25 offset:0
  ds_read_b128 v[216:219], v25 offset:4096
  ds_read_b128 v[220:223], v25 offset:8192
  v_mfma_f32_32x32x16_bf16 v[176:191], v[116:119], v[84:87], v[176:191]
  v_dot2c_f32_bf16 v39, v92, v92
  v_dot2c_f32_bf16 v38, v92, v37
  v_dot2c_f32_bf16 v39, v93, v93
  v_dot2c_f32_bf16 v38, v93, v37
  v_dot2c_f32_bf16 v39, v94, v94
  v_dot2c_f32_bf16 v38, v94, v37
  v_dot2c_f32_bf16 v39, v95, v95
  v_dot2c_f32_bf16 v38, v95, v37
  v_mfma_f32_32x32x16_bf16 v[144:159], v[120:123], v[88:91], v[144:159]
  s_nop 1
  v_mov_b32 v64, v38
  v_mov_b32 v65, v39
  s_waitcnt lgkmcnt(0)
  v_mfma_f32_32x32x16_bf16 v[160:175], v[88:91], v[124:127], v[160:175]
  v_add_f32 v212, v212, v216
  v_add_f32 v208, v208, v220
  v_add_f32 v213, v213, v217
  v_permlane32_swap_b32 v38, v64
  v_permlane32_swap_b32 v39, v65
  v_add_f32 v38, v38, v64
  v_add_f32 v39, v39, v65
  v_add_f32 v208, v208, v212
  v_mfma_f32_32x32x16_bf16 v[176:191], v[128:131], v[88:91], v[176:191]
  v_mul_f32 v69, 0xbb124925, v38
  v_mul_f32 v39, 0x3b124925, v39
  v_add_f32 v209, v209, v221
  v_fma_f32 v39, -v69, v69, v39
  v_max_f32 v39, 0, v39
  v_add_f32 v39, 0x3727c5ac, v39
  v_mfma_f32_32x32x16_bf16 v[144:159], v[132:135], v[92:95], v[144:159]
  v_rsq_f32 v68, v39
  v_cvt_pk_bf16_f32 v236, v208, v208
  v_cvt_pk_bf16_f32 v232, v69, v69
  ds_write_b32 v76, v68 offset:1024
  v_add_f32 v214, v214, v218
  v_add_f32 v210, v210, v222
  v_add_f32 v209, v209, v213
  v_add_f32 v210, v210, v214
  v_mfma_f32_32x32x16_bf16 v[160:175], v[92:95], v[136:139], v[160:175]
  v_and_b32 v66, 0xffff0000, v236
  v_and_b32 v67, 0xffff0000, v232
  v_sub_f32 v66, v208, v66
  v_sub_f32 v67, v69, v67
  v_cvt_pk_bf16_f32 v237, v66, v66
  v_cvt_pk_bf16_f32 v232, v69, v67
  v_cvt_pk_bf16_f32 v244, v210, v210
  v_mov_b32 v233, v232
  v_mfma_f32_32x32x16_bf16 v[176:191], v[140:143], v[92:95], v[176:191]
  s_waitcnt lgkmcnt(0)
  ds_read_b128 v[192:195], v77 offset:1024
  ds_read_b128 v[196:199], v77 offset:1056
  ds_read_b128 v[200:203], v77 offset:1088
  ds_read_b128 v[204:207], v77 offset:1120
  v_and_b32 v66, 0xffff0000, v244
  v_cvt_pk_bf16_f32 v240, v209, v209
  v_sub_f32 v66, v210, v66
  v_and_b32 v67, 0xffff0000, v240
  v_cvt_pk_bf16_f32 v245, v66, v66
  v_sub_f32 v67, v209, v67
  v_cvt_pk_bf16_f32 v241, v67, v67
  v_mfma_f32_32x32x16_bf16 v[144:159], v[236:239], v[232:235], v[144:159]
  s_nop 0
  v_mfma_f32_32x32x16_bf16 v[160:175], v[232:235], v[240:243], v[160:175]
  v_mfma_f32_32x32x16_bf16 v[176:191], v[244:247], v[232:235], v[176:191]
  s_waitcnt vmcnt(4)
  s_add_u32 s4, s48, 16
  v_subrev_u32 v224, s4, v224
  v_subrev_u32 v225, s4, v225
  v_max_u32 v226, v224, v225
  v_cmp_lt_u32 vcc, 31, v226
  s_cbranch_vccnz md_2
ok_1:
  s_sub_u32 s4, s71, s4
  v_xor_b32 v224, s4, v224
  v_xor_b32 v225, s4, v225
  v_or_b32 v224, v224, v225
  v_and_b32 v224, 0xffffffef, v224
  v_cmp_ne_u32 vcc, 0, v224
  s_cmp_eq_u64 vcc, 0
  s_cselect_b32 s69, 1, 0
  v_pk_mul_f32 v[144:145], v[144:145], v[68:69] op_sel:[0,0] op_sel_hi:[1,0]
  v_pk_mul_f32 v[146:147], v[146:147], v[68:69] op_sel:[0,0] op_sel_hi:[1,0]
  v_pk_mul_f32 v[148:149], v[148:149], v[68:69] op_sel:[0,0] op_sel_hi:[1,0]
  v_pk_mul_f32 v[150:151], v[150:151], v[68:69] op_sel:[0,0] op_sel_hi:[1,0]
  v_pk_mul_f32 v[152:153], v[152:153], v[68:69] op_sel:[0,0] op_sel_hi:[1,0]
  v_pk_mul_f32 v[154:155], v[154:155], v[68:69] op_sel:[0,0] op_sel_hi:[1,0]
  v_pk_mul_f32 v[156:157], v[156:157], v[68:69] op_sel:[0,0] op_sel_hi:[1,0]
  v_pk_mul_f32 v[158:159], v[158:159], v[68:69] op_sel:[0,0] op_sel_hi:[1,0]
  v_cvt_pk_bf16_f32 v112, v144, v145
  v_cvt_pk_bf16_f32 v113, v146, v147
  v_cvt_pk_bf16_f32 v114, v148, v149
  v_cvt_pk_bf16_f32 v115, v150, v151
  v_cvt_pk_bf16_f32 v116, v152, v153
  v_cvt_pk_bf16_f32 v117, v154, v155
  v_cvt_pk_bf16_f32 v118, v156, v157
  v_cvt_pk_bf16_f32 v119, v158, v159
  s_mov_b32 exec_lo, 0
  v_mov_b32 v118, 0
  v_mov_b32 v119, 0
  s_mov_b32 exec_lo, -1
  s_waitcnt lgkmcnt(0)
  v_pk_mul_f32 v[160:161], v[160:161], v[192:193]
  v_pk_mul_f32 v[162:163], v[162:163], v[194:195]
  v_pk_mul_f32 v[164:165], v[164:165], v[196:197]
  v_pk_mul_f32 v[166:167], v[166:167], v[198:199]
  v_pk_mul_f32 v[168:169], v[168:169], v[200:201]
  v_pk_mul_f32 v[170:171], v[170:171], v[202:203]
  v_pk_mul_f32 v[172:173], v[172:173], v[204:205]
  v_pk_mul_f32 v[174:175], v[174:175], v[206:207]
  v_cvt_pk_bf16_f32 v120, v160, v161
  v_cvt_pk_bf16_f32 v121, v162, v163
  v_cvt_pk_bf16_f32 v122, v164, v165
  v_cvt_pk_bf16_f32 v123, v166, v167
  v_cvt_pk_bf16_f32 v124, v168, v169
  v_cvt_pk_bf16_f32 v125, v170, v171
  v_cvt_pk_bf16_f32 v126, v172, v173
  v_cvt_pk_bf16_f32 v127, v174, v175
  s_not_b64 exec, s[0:1]
  v_mov_b32 v120, 0x3f803f80
  v_mov_b32 v121, 0x3f803f80
  v_mov_b32 v122, 0x3f803f80
  v_mov_b32 v123, 0x3f803f80
  v_mov_b32 v124, 0x3f803f80
  v_mov_b32 v125, 0x3f803f80
  v_mov_b32 v126, 0x3f803f80
  v_mov_b32 v127, 0x3f803f80
  s_mov_b64 exec, -1
  s_cmp_eq_u32 s69, 0
  s_cbranch_scc1 far_4
  global_store_dwordx4 v2, v[112:115], s[12:13] offset:0
  global_store_dwordx4 v2, v[116:119], s[12:13] offset:1024
  global_store_dwordx4 v2, v[120:123], s[12:13] offset:2048
  global_store_dwordx4 v2, v[124:127], s[12:13] offset:3072
ok_3:
  v_mul_f32 v68, 0x3e8b97f6, v68
  v_pk_mul_f32 v[176:177], v[176:177], v[68:69] op_sel:[0,0] op_sel_hi:[1,0]
  v_pk_mul_f32 v[178:179], v[178:179], v[68:69] op_sel:[0,0] op_sel_hi:[1,0]
  v_pk_mul_f32 v[180:181], v[180:181], v[68:69] op_sel:[0,0] op_sel_hi:[1,0]
  v_pk_mul_f32 v[182:183], v[182:183], v[68:69] op_sel:[0,0] op_sel_hi:[1,0]
  v_pk_mul_f32 v[184:185], v[184:185], v[68:69] op_sel:[0,0] op_sel_hi:[1,0]
  v_pk_mul_f32 v[186:187], v[186:187], v[68:69] op_sel:[0,0] op_sel_hi:[1,0]
  v_pk_mul_f32 v[188:189], v[188:189], v[68:69] op_sel:[0,0] op_sel_hi:[1,0]
  v_pk_mul_f32 v[190:191], v[190:191], v[68:69] op_sel:[0,0] op_sel_hi:[1,0]
  v_cvt_pk_bf16_f32 v56, v176, v177
  v_cvt_pk_bf16_f32 v57, v178, v179
  v_cvt_pk_bf16_f32 v58, v180, v181
  v_cvt_pk_bf16_f32 v59, v182, v183
  v_cvt_pk_bf16_f32 v60, v184, v185
  v_cvt_pk_bf16_f32 v61, v186, v187
  v_cvt_pk_bf16_f32 v62, v188, v189
  v_cvt_pk_bf16_f32 v63, v190, v191
  s_mov_b32 exec_lo, 0
  v_mov_b32 v62, 0
  v_mov_b32 v63, 0
  s_mov_b32 exec_lo, -1
  ds_write_b128 v29, v[56:59] offset:2048
  ds_write_b128 v29, v[60:63] offset:3072
  ds_write_b128 v30, v[56:59] offset:2048
  ds_write_b128 v30, v[60:63] offset:3072
  ds_write_b128 v31, v[56:59] offset:2048
  ds_write_b128 v31, v[60:63] offset:3072
  v_mov_b32 v64, 0
  v_mov_b32 v65, 0
  v_mov_b32 v66, 0
  v_dot2c_f32_bf16 v64, v112, v112
  v_dot2c_f32_bf16 v65, v56, v56
  v_dot2c_f32_bf16 v66, v120, v120
  v_dot2c_f32_bf16 v64, v113, v113
  v_dot2c_f32_bf16 v65, v57, v57
  v_dot2c_f32_bf16 v66, v121, v121
  v_dot2c_f32_bf16 v64, v114, v114
  v_dot2c_f32_bf16 v65, v58, v58
  v_dot2c_f32_bf16 v66, v122, v122
  v_dot2c_f32_bf16 v64, v115, v115
  v_dot2c_f32_bf16 v65, v59, v59
  v_dot2c_f32_bf16 v66, v123, v123
  v_dot2c_f32_bf16 v64, v116, v116
  v_dot2c_f32_bf16 v65, v60, v60
  v_dot2c_f32_bf16 v66, v124, v124
  v_dot2c_f32_bf16 v64, v117, v117
  v_dot2c_f32_bf16 v65, v61, v61
  v_dot2c_f32_bf16 v66, v125, v125
  v_dot2c_f32_bf16 v64, v118, v118
  v_dot2c_f32_bf16 v65, v62, v62
  v_dot2c_f32_bf16 v66, v126, v126
  v_dot2c_f32_bf16 v64, v119, v119
  v_dot2c_f32_bf16 v65, v63, v63
  v_dot2c_f32_bf16 v66, v127, v127
  s_waitcnt lgkmcnt(0)
  s_barrier
  ds_read_b128 v[32:35], v25 offset:2048
  ds_read_b128 v[36:39], v25 offset:3072
  ds_read_b128 v[40:43], v25 offset:6144
  ds_read_b128 v[44:47], v25 offset:7168
  ds_read_b128 v[48:51], v25 offset:10240
  ds_read_b128 v[52:55], v25 offset:11264
  v_mov_b32 v67, v64
  v_mov_b32 v68, v65
  v_mov_b32 v69, 0x5d800000
  v_mov_b32 v70, 0x7f800000
  v_permlane32_swap_b32 v64, v67
  v_permlane32_swap_b32 v65, v68
  v_cmp_ge_f32 vcc, v69, v66
  v_add_f32 v64, v64, v67
  v_add_f32 v65, v65, v68
  v_cndmask_b32 v64, v70, v64, vcc
  s_nop 1
  v_max_u32_dpp v64, v64, v64 row_ror:8 row_mask:0xf bank_mask:0xf
  v_max_u32_dpp v65, v65, v65 row_ror:8 row_mask:0xf bank_mask:0xf
  s_nop 0
  v_max_u32_dpp v64, v64, v64 row_ror:4 row_mask:0xf bank_mask:0xf
  v_max_u32_dpp v65, v65, v65 row_ror:4 row_mask:0xf bank_mask:0xf
  s_nop 0
  v_max_u32_dpp v64, v64, v64 row_ror:2 row_mask:0xf bank_mask:0xf
  v_max_u32_dpp v65, v65, v65 row_ror:2 row_mask:0xf bank_mask:0xf
  s_nop 0
  v_max_u32_dpp v64, v64, v64 row_ror:1 row_mask:0xf bank_mask:0xf
  v_max_u32_dpp v65, v65, v65 row_ror:1 row_mask:0xf bank_mask:0xf
  v_readlane_b32 s4, v64, 0
  v_readlane_b32 s5, v64, 16
  v_readlane_b32 s6, v64, 32
  s_max_u32 s4, s4, s5
  v_readlane_b32 s5, v64, 48
  s_max_u32 s4, s4, s6
  v_readlane_b32 s6, v65, 0
  s_max_u32 s4, s4, s5
  v_readlane_b32 s5, v65, 16
  s_min_u32 s4, s4, 0x7fc00000
  s_add_u32 s4, s4, 0x10000
  s_and_b32 s4, s4, 0xffff0000
  s_max_u32 s5, s5, s6
  s_min_u32 s5, s5, 0x7fc00000
  s_lshr_b32 s5, s5, 16
  s_add_u32 s5, s5, 1
  s_or_b32 s4, s4, s5
  v_mov_b32 v16, s48
  v_mov_b32 v17, s4
  v_not_b32 v240, s48
  v_mov_b32 v252, -1
  v_mov_b32 v253, -1
  v_mov_b32 v254, -1
  v_mov_b32 v255, -1
  s_add_u32 s16, s16, s57
  s_addc_u32 s17, s17, 0
  s_add_u32 s24, s24, s59
  s_addc_u32 s25, s25, 0
  v_lshrrev_b32 v18, 5, v0
  v_mul_u32_u24 v18, 3584, v18
  v_sub_u32 v6, v6, v18
  s_add_u32 s20, s20, s58
  s_addc_u32 s21, s21, 0
  s_add_u32 s8, s8, s44
  s_addc_u32 s9, s9, 0
  s_add_u32 s40, s40, s46
  s_addc_u32 s41, s41, 0
  s_lshl_b32 s4, s55, 8
  s_lshl_b32 s5, s3, 6
  s_add_u32 s4, s4, s5
  s_add_u32 s36, s36, s4
  s_addc_u32 s37, s37, 0
  s_waitcnt vmcnt(0)
  s_mov_b64 exec, 1
  s_cmp_eq_u32 s69, 0
  s_cbranch_scc1 far_6
  buffer_store_dwordx2 v[16:17], off, s[28:31], s50
ok_5:
  s_mov_b64 exec, -1
  buffer_load_dwordx2 v[240:241], v15, s[28:31], 0 offen sc1
  s_waitcnt lgkmcnt(4)
  v_mfma_f32_32x32x16_bf16 v[64:79], v[112:115], v[32:35], 0
  v_mfma_f32_32x32x16_bf16 v[64:79], v[116:119], v[36:39], v[64:79]
  s_waitcnt lgkmcnt(2)
  v_mfma_f32_32x32x16_bf16 v[80:95], v[112:115], v[40:43], 0
  s_nop 9
  v_exp_f32 v64, v64
  v_exp_f32 v65, v65
  v_exp_f32 v66, v66
  v_exp_f32 v67, v67
  v_mfma_f32_32x32x16_bf16 v[80:95], v[116:119], v[44:47], v[80:95]
  s_add_u32 m0, s62, 0
  v_exp_f32 v68, v68
  v_exp_f32 v69, v69
  v_exp_f32 v70, v70
  v_exp_f32 v71, v71
  v_cvt_pk_bf16_f32 v96, v64, v65
  v_cvt_pk_bf16_f32 v97, v66, v67
  v_exp_f32 v72, v72
  v_exp_f32 v73, v73
  v_exp_f32 v74, v74
  v_exp_f32 v75, v75
  v_cvt_pk_bf16_f32 v98, v68, v69
  v_cvt_pk_bf16_f32 v99, v70, v71
  s_waitcnt lgkmcnt(0)
  v_exp_f32 v76, v76
  v_exp_f32 v77, v77
  v_exp_f32 v78, v78
  v_exp_f32 v79, v79
  v_cvt_pk_bf16_f32 v100, v72, v73
  v_cvt_pk_bf16_f32 v101, v74, v75
  v_cvt_pk_bf16_f32 v102, v76, v77
  v_cvt_pk_bf16_f32 v103, v78, v79
  v_mfma_f32_32x32x16_bf16 v[64:79], v[112:115], v[48:51], 0
  s_waitcnt vmcnt(0)
  v_cmp_eq_u32 s[42:43], s48, v240
  s_add_u32 s52, s52, 16384
  s_and_b32 s52, s52, 262143
  s_add_u32 s12, s14, s52
  s_addc_u32 s13, s15, 0
  s_bitcmp1_b32 s42, 1
  s_cbranch_scc0 late_8
ok_7:
  global_load_dwordx4 v[128:131], v2, s[12:13] offset:0 sc1
  global_load_dwordx4 v[132:135], v2, s[12:13] offset:1024 sc1
  v_exp_f32 v80, v80
  v_exp_f32 v81, v81
  v_exp_f32 v82, v82
  v_exp_f32 v83, v83
  v_mfma_f32_32x32x16_bf16 v[64:79], v[116:119], v[52:55], v[64:79]
  global_load_dwordx4 v[136:139], v2, s[12:13] offset:2048 sc1
  global_load_dwordx4 v[140:143], v2, s[12:13] offset:3072 sc1
  buffer_load_dwordx2 v[240:241], v15, s[28:31], 0 offen sc1
  v_exp_f32 v84, v84
  v_exp_f32 v85, v85
  v_exp_f32 v86, v86
  v_exp_f32 v87, v87
  v_cvt_pk_bf16_f32 v104, v80, v81
  v_cvt_pk_bf16_f32 v105, v82, v83
  v_mfma_f32_32x32x16_bf16 v[176:191], v[120:123], v[96:99], 0
  global_load_lds_dwordx4 v3, s[16:17] offset:0
  global_load_lds_dwordx4 v4, s[16:17] offset:1024
  v_exp_f32 v88, v88
  v_exp_f32 v89, v89
  v_exp_f32 v90, v90
  v_exp_f32 v91, v91
  v_cvt_pk_bf16_f32 v106, v84, v85
  v_cvt_pk_bf16_f32 v107, v86, v87
  v_mfma_f32_32x32x16_bf16 v[176:191], v[124:127], v[100:103], v[176:191]
  global_load_lds_dwordx4 v5, s[16:17] offset:2048
  global_load_lds_dwordx4 v6, s[16:17] offset:3072
  v_exp_f32 v92, v92
  v_exp_f32 v93, v93
  v_exp_f32 v94, v94
  v_exp_f32 v95, v95
  v_cvt_pk_bf16_f32 v108, v88, v89
  v_cvt_pk_bf16_f32 v109, v90, v91
  v_cvt_pk_bf16_f32 v110, v92, v93
  v_cvt_pk_bf16_f32 v111, v94, v95
  v_mfma_f32_32x32x16_bf16 v[80:95], v[112:115], v[56:59], 0
  v_exp_f32 v64, v64
  v_exp_f32 v65, v65
  v_exp_f32 v66, v66
  v_exp_f32 v67, v67
  v_mfma_f32_32x32x16_bf16 v[80:95], v[116:119], v[60:63], v[80:95]
  v_exp_f32 v68, v68
  v_exp_f32 v69, v69
  v_exp_f32 v70, v70
  v_exp_f32 v71, v71
  v_cvt_pk_bf16_f32 v96, v64, v65
  v_cvt_pk_bf16_f32 v97, v66, v67
  v_mfma_f32_32x32x16_bf16 v[192:207], v[120:123], v[104:107], 0
  v_exp_f32 v72, v72
  v_exp_f32 v73, v73
  v_exp_f32 v74, v74
  v_exp_f32 v75, v75
  v_cvt_pk_bf16_f32 v98, v68, v69
  v_cvt_pk_bf16_f32 v99, v70, v71
  v_mfma_f32_32x32x16_bf16 v[192:207], v[124:127], v[108:111], v[192:207]
  s_waitcnt vmcnt(5)
  v_exp_f32 v76, v76
  v_exp_f32 v77, v77
  v_exp_f32 v78, v78
  v_exp_f32 v79, v79
  v_cvt_pk_bf16_f32 v100, v72, v73
  v_cvt_pk_bf16_f32 v101, v74, v75
  v_cvt_pk_bf16_f32 v102, v76, v77
  v_cvt_pk_bf16_f32 v103, v78, v79
  v_mfma_f32_32x32x16_bf16 v[64:79], v[128:131], v[32:35], 0
  s_waitcnt vmcnt(4)
  v_cmp_eq_u32 s[42:43], s48, v240
  s_add_u32 s52, s52, 16384
  s_and_b32 s52, s52, 262143
  s_add_u32 s12, s14, s52
  s_addc_u32 s13, s15, 0
  s_bitcmp1_b32 s42, 2
  s_cbranch_scc0 late_10
ok_9:
  global_load_dwordx4 v[144:147], v2, s[12:13] offset:0 sc1
  global_load_dwordx4 v[148:151], v2, s[12:13] offset:1024 sc1
  v_exp_f32 v80, v80
  v_exp_f32 v81, v81
  v_exp_f32 v82, v82
  v_exp_f32 v83, v83
  v_mfma_f32_32x32x16_bf16 v[64:79], v[132:135], v[36:39], v[64:79]
  global_load_dwordx4 v[152:155], v2, s[12:13] offset:2048 sc1
  global_load_dwordx4 v[156:159], v2, s[12:13] offset:3072 sc1
  v_exp_f32 v84, v84
  v_exp_f32 v85, v85
  v_exp_f32 v86, v86
  v_exp_f32 v87, v87
  v_cvt_pk_bf16_f32 v104, v80, v81
  v_cvt_pk_bf16_f32 v105, v82, v83
  v_mfma_f32_32x32x16_bf16 v[208:223], v[120:123], v[96:99], 0
  v_exp_f32 v88, v88
  v_exp_f32 v89, v89
  v_exp_f32 v90, v90
  v_exp_f32 v91, v91
  v_cvt_pk_bf16_f32 v106, v84, v85
  v_cvt_pk_bf16_f32 v107, v86, v87
  v_mfma_f32_32x32x16_bf16 v[208:223], v[124:127], v[100:103], v[208:223]
  v_exp_f32 v92, v92
  v_exp_f32 v93, v93
  v_exp_f32 v94, v94
  v_exp_f32 v95, v95
  v_cvt_pk_bf16_f32 v108, v88, v89
  v_cvt_pk_bf16_f32 v109, v90, v91
  v_cvt_pk_bf16_f32 v110, v92, v93
  v_cvt_pk_bf16_f32 v111, v94, v95
  v_mfma_f32_32x32x16_bf16 v[80:95], v[128:131], v[40:43], 0
  v_exp_f32 v64, v64
  v_exp_f32 v65, v65
  v_exp_f32 v66, v66
  v_exp_f32 v67, v67
  v_mfma_f32_32x32x16_bf16 v[80:95], v[132:135], v[44:47], v[80:95]
  s_add_u32 m0, s62, 4096
  s_add_u32 s52, s52, 16384
  s_and_b32 s52, s52, 262143
  s_add_u32 s12, s14, s52
  s_addc_u32 s13, s15, 0
  s_bitcmp1_b32 s42, 3
  s_cbranch_scc0 late_12
ok_11:
  global_load_dwordx4 v[160:163], v2, s[12:13] offset:0 sc1
  global_load_dwordx4 v[164:167], v2, s[12:13] offset:1024 sc1
  v_exp_f32 v68, v68
  v_exp_f32 v69, v69
  v_exp_f32 v70, v70
  v_exp_f32 v71, v71
  v_cvt_pk_bf16_f32 v96, v64, v65
  v_cvt_pk_bf16_f32 v97, v66, v67
  v_mfma_f32_32x32x16_bf16 v[224:239], v[120:123], v[104:107], 0
  s_add_u32 s16, s16, 25088
  global_load_dwordx4 v[168:171], v2, s[12:13] offset:2048 sc1
  global_load_dwordx4 v[172:175], v2, s[12:13] offset:3072 sc1
  v_exp_f32 v72, v72
  v_exp_f32 v73, v73
  v_exp_f32 v74, v74
  v_exp_f32 v75, v75
  v_cvt_pk_bf16_f32 v98, v68, v69
  v_cvt_pk_bf16_f32 v99, v70, v71
  v_mfma_f32_32x32x16_bf16 v[224:239], v[124:127], v[108:111], v[224:239]
  s_addc_u32 s17, s17, 0
  buffer_load_dwordx2 v[240:241], v15, s[28:31], 0 offen sc1
  v_exp_f32 v76, v76
  v_exp_f32 v77, v77
  v_exp_f32 v78, v78
  v_exp_f32 v79, v79
  v_cvt_pk_bf16_f32 v100, v72, v73
  v_cvt_pk_bf16_f32 v101, v74, v75
  v_cvt_pk_bf16_f32 v102, v76, v77
  v_cvt_pk_bf16_f32 v103, v78, v79
  v_mfma_f32_32x32x16_bf16 v[64:79], v[128:131], v[48:51], 0
  s_add_u32 s52, s52, 16384
  global_load_lds_dwordx4 v3, s[16:17] offset:0
  global_load_lds_dwordx4 v4, s[16:17] offset:1024
  v_exp_f32 v80, v80
  v_exp_f32 v81, v81
  v_exp_f32 v82, v82
  v_exp_f32 v83, v83
  v_mfma_f32_32x32x16_bf16 v[64:79], v[132:135], v[52:55], v[64:79]
  s_and_b32 s52, s52, 262143
  global_load_lds_dwordx4 v5, s[16:17] offset:2048
  global_load_lds_dwordx4 v6, s[16:17] offset:3072
  v_exp_f32 v84, v84
  v_exp_f32 v85, v85
  v_exp_f32 v86, v86
  v_exp_f32 v87, v87
  v_cvt_pk_bf16_f32 v104, v80, v81
  v_cvt_pk_bf16_f32 v105, v82, v83
  v_mfma_f32_32x32x16_bf16 v[176:191], v[136:139], v[96:99], v[176:191]
  s_add_u32 s12, s14, s52
  v_exp_f32 v88, v88
  v_exp_f32 v89, v89
  v_exp_f32 v90, v90
  v_exp_f32 v91, v91
  v_cvt_pk_bf16_f32 v106, v84, v85
  v_cvt_pk_bf16_f32 v107, v86, v87
  v_mfma_f32_32x32x16_bf16 v[176:191], v[140:143], v[100:103], v[176:191]
  s_addc_u32 s13, s15, 0
  v_exp_f32 v92, v92
  v_exp_f32 v93, v93
  v_exp_f32 v94, v94
  v_exp_f32 v95, v95
  v_cvt_pk_bf16_f32 v108, v88, v89
  v_cvt_pk_bf16_f32 v109, v90, v91
  v_cvt_pk_bf16_f32 v110, v92, v93
  v_cvt_pk_bf16_f32 v111, v94, v95
  v_mfma_f32_32x32x16_bf16 v[80:95], v[128:131], v[56:59], 0
  s_bitcmp1_b32 s42, 4
  s_cbranch_scc0 late_14
ok_13:
  global_load_dwordx4 v[112:115], v2, s[12:13] offset:0 sc1
  global_load_dwordx4 v[116:119], v2, s[12:13] offset:1024 sc1
  v_exp_f32 v64, v64
  v_exp_f32 v65, v65
  v_exp_f32 v66, v66
  v_exp_f32 v67, v67
  v_mfma_f32_32x32x16_bf16 v[80:95], v[132:135], v[60:63], v[80:95]
  global_load_dwordx4 v[120:123], v2, s[12:13] offset:2048 sc1
  global_load_dwordx4 v[124:127], v2, s[12:13] offset:3072 sc1
  v_exp_f32 v68, v68
  v_exp_f32 v69, v69
  v_exp_f32 v70, v70
  v_exp_f32 v71, v71
  v_cvt_pk_bf16_f32 v96, v64, v65
  v_cvt_pk_bf16_f32 v97, v66, v67
  v_mfma_f32_32x32x16_bf16 v[192:207], v[136:139], v[104:107], v[192:207]
  s_add_u32 m0, s47, 0
  v_exp_f32 v72, v72
  v_exp_f32 v73, v73
  v_exp_f32 v74, v74
  v_exp_f32 v75, v75
  v_cvt_pk_bf16_f32 v98, v68, v69
  v_cvt_pk_bf16_f32 v99, v70, v71
  v_mfma_f32_32x32x16_bf16 v[192:207], v[140:143], v[108:111], v[192:207]
  s_waitcnt vmcnt(13)
  v_exp_f32 v76, v76
  v_exp_f32 v77, v77
  v_exp_f32 v78, v78
  v_exp_f32 v79, v79
  v_cvt_pk_bf16_f32 v100, v72, v73
  v_cvt_pk_bf16_f32 v101, v74, v75
  v_cvt_pk_bf16_f32 v102, v76, v77
  v_cvt_pk_bf16_f32 v103, v78, v79
  v_mfma_f32_32x32x16_bf16 v[64:79], v[144:147], v[32:35], 0
  global_load_lds_dwordx4 v7, s[20:21] offset:0
  global_load_lds_dwordx4 v8, s[20:21] offset:1024
  v_exp_f32 v80, v80
  v_exp_f32 v81, v81
  v_exp_f32 v82, v82
  v_exp_f32 v83, v83
  v_mfma_f32_32x32x16_bf16 v[64:79], v[148:151], v[36:39], v[64:79]
  global_load_lds_dwordx4 v9, s[20:21] offset:2048
  global_load_lds_dwordx4 v10, s[20:21] offset:3072
  v_exp_f32 v84, v84
  v_exp_f32 v85, v85
  v_exp_f32 v86, v86
  v_exp_f32 v87, v87
  v_cvt_pk_bf16_f32 v104, v80, v81
  v_cvt_pk_bf16_f32 v105, v82, v83
  v_mfma_f32_32x32x16_bf16 v[208:223], v[136:139], v[96:99], v[208:223]
  s_add_u32 s20, s20, 114688
  v_exp_f32 v88, v88
  v_exp_f32 v89, v89
  v_exp_f32 v90, v90
  v_exp_f32 v91, v91
  v_cvt_pk_bf16_f32 v106, v84, v85
  v_cvt_pk_bf16_f32 v107, v86, v87
  v_mfma_f32_32x32x16_bf16 v[208:223], v[140:143], v[100:103], v[208:223]
  s_addc_u32 s21, s21, 0
  v_exp_f32 v92, v92
  v_exp_f32 v93, v93
  v_exp_f32 v94, v94
  v_exp_f32 v95, v95
  v_cvt_pk_bf16_f32 v108, v88, v89
  v_cvt_pk_bf16_f32 v109, v90, v91
  v_cvt_pk_bf16_f32 v110, v92, v93
  v_cvt_pk_bf16_f32 v111, v94, v95
  v_mfma_f32_32x32x16_bf16 v[80:95], v[144:147], v[40:43], 0
  ds_read_b64_tr_b16 a[192:193], v11 offset:0
  v_exp_f32 v64, v64
  v_exp_f32 v65, v65
  v_exp_f32 v66, v66
  v_exp_f32 v67, v67
  v_mfma_f32_32x32x16_bf16 v[80:95], v[148:151], v[44:47], v[80:95]
  s_add_u32 m0, s62, 8192
  ds_read_b64_tr_b16 a[194:195], v11 offset:1024
  v_exp_f32 v68, v68
  v_exp_f32 v69, v69
  v_exp_f32 v70, v70
  v_exp_f32 v71, v71
  v_cvt_pk_bf16_f32 v96, v64, v65
  v_cvt_pk_bf16_f32 v97, v66, v67
  v_mfma_f32_32x32x16_bf16 v[224:239], v[136:139], v[104:107], v[224:239]
  s_add_u32 s16, s16, 25088
  ds_read_b64_tr_b16 a[196:197], v12 offset:0
  v_exp_f32 v72, v72
  v_exp_f32 v73, v73
  v_exp_f32 v74, v74
  v_exp_f32 v75, v75
  v_cvt_pk_bf16_f32 v98, v68, v69
  v_cvt_pk_bf16_f32 v99, v70, v71
  v_mfma_f32_32x32x16_bf16 v[224:239], v[140:143], v[108:111], v[224:239]
  s_addc_u32 s17, s17, 0
  ds_read_b64_tr_b16 a[198:199], v12 offset:1024
  v_exp_f32 v76, v76
  v_exp_f32 v77, v77
  v_exp_f32 v78, v78
  v_exp_f32 v79, v79
  v_cvt_pk_bf16_f32 v100, v72, v73
  v_cvt_pk_bf16_f32 v101, v74, v75
  v_cvt_pk_bf16_f32 v102, v76, v77
  v_cvt_pk_bf16_f32 v103, v78, v79
  v_mfma_f32_32x32x16_bf16 v[64:79], v[144:147], v[48:51], 0
  s_add_u32 s52, s52, 16384
  global_load_lds_dwordx4 v3, s[16:17] offset:0
  global_load_lds_dwordx4 v4, s[16:17] offset:1024
  v_exp_f32 v80, v80
  v_exp_f32 v81, v81
  v_exp_f32 v82, v82
  v_exp_f32 v83, v83
  v_mfma_f32_32x32x16_bf16 v[64:79], v[148:151], v[52:55], v[64:79]
  s_and_b32 s52, s52, 262143
  global_load_lds_dwordx4 v5, s[16:17] offset:2048
  global_load_lds_dwordx4 v6, s[16:17] offset:3072
  v_exp_f32 v84, v84
  v_exp_f32 v85, v85
  v_exp_f32 v86, v86
  v_exp_f32 v87, v87
  v_cvt_pk_bf16_f32 v104, v80, v81
  v_cvt_pk_bf16_f32 v105, v82, v83
  v_mfma_f32_32x32x16_bf16 v[176:191], v[152:155], v[96:99], v[176:191]
  s_add_u32 s12, s14, s52
  s_waitcnt vmcnt(16)
  v_cmp_eq_u32 s[42:43], s48, v240
  ds_read_b64_tr_b16 a[200:201], v11 offset:2048
  v_exp_f32 v88, v88
  v_exp_f32 v89, v89
  v_exp_f32 v90, v90
  v_exp_f32 v91, v91
  v_cvt_pk_bf16_f32 v106, v84, v85
  v_cvt_pk_bf16_f32 v107, v86, v87
  v_mfma_f32_32x32x16_bf16 v[176:191], v[156:159], v[100:103], v[176:191]
  s_addc_u32 s13, s15, 0
  ds_read_b64_tr_b16 a[202:203], v11 offset:3072
  v_exp_f32 v92, v92
  v_exp_f32 v93, v93
  v_exp_f32 v94, v94
  v_exp_f32 v95, v95
  v_cvt_pk_bf16_f32 v108, v88, v89
  v_cvt_pk_bf16_f32 v109, v90, v91
  v_cvt_pk_bf16_f32 v110, v92, v93
  v_cvt_pk_bf16_f32 v111, v94, v95
  v_mfma_f32_32x32x16_bf16 v[80:95], v[144:147], v[56:59], 0
  s_bitcmp1_b32 s42, 5
  s_cbranch_scc0 late_16
ok_15:
  global_load_dwordx4 v[128:131], v2, s[12:13] offset:0 sc1
  global_load_dwordx4 v[132:135], v2, s[12:13] offset:1024 sc1
  v_exp_f32 v64, v64
  v_exp_f32 v65, v65
  v_exp_f32 v66, v66
  v_exp_f32 v67, v67
  v_mfma_f32_32x32x16_bf16 v[80:95], v[148:151], v[60:63], v[80:95]
  global_load_dwordx4 v[136:139], v2, s[12:13] offset:2048 sc1
  global_load_dwordx4 v[140:143], v2, s[12:13] offset:3072 sc1
  v_exp_f32 v68, v68
  v_exp_f32 v69, v69
  v_exp_f32 v70, v70
  v_exp_f32 v71, v71
  v_cvt_pk_bf16_f32 v96, v64, v65
  v_cvt_pk_bf16_f32 v97, v66, v67
  v_mfma_f32_32x32x16_bf16 v[192:207], v[152:155], v[104:107], v[192:207]
  ds_read_b64_tr_b16 a[204:205], v12 offset:2048
  v_exp_f32 v72, v72
  v_exp_f32 v73, v73
  v_exp_f32 v74, v74
  v_exp_f32 v75, v75
  v_cvt_pk_bf16_f32 v98, v68, v69
  v_cvt_pk_bf16_f32 v99, v70, v71
  v_mfma_f32_32x32x16_bf16 v[192:207], v[156:159], v[108:111], v[192:207]
  ds_read_b64_tr_b16 a[206:207], v12 offset:3072
  v_exp_f32 v76, v76
  v_exp_f32 v77, v77
  v_exp_f32 v78, v78
  v_exp_f32 v79, v79
  v_cvt_pk_bf16_f32 v100, v72, v73
  v_cvt_pk_bf16_f32 v101, v74, v75
  v_cvt_pk_bf16_f32 v102, v76, v77
  v_cvt_pk_bf16_f32 v103, v78, v79
  v_mfma_f32_32x32x16_bf16 v[64:79], v[160:163], v[32:35], 0
  v_exp_f32 v80, v80
  v_exp_f32 v81, v81
  v_exp_f32 v82, v82
  v_exp_f32 v83, v83
  v_mfma_f32_32x32x16_bf16 v[64:79], v[164:167], v[36:39], v[64:79]
  s_cmp_eq_u32 s69, 0
  s_cbranch_scc1 far_18
  global_store_dwordx4 v1, v[252:255], s[22:23] offset:-3072
  global_store_dwordx4 v1, v[252:255], s[22:23] offset:-2048
  global_store_dwordx4 v1, v[252:255], s[22:23] offset:-1024
ok_17:
  v_exp_f32 v84, v84
  v_exp_f32 v85, v85
  v_exp_f32 v86, v86
  v_exp_f32 v87, v87
  v_cvt_pk_bf16_f32 v104, v80, v81
  v_cvt_pk_bf16_f32 v105, v82, v83
  v_mfma_f32_32x32x16_bf16 v[208:223], v[152:155], v[96:99], v[208:223]
  v_exp_f32 v88, v88
  v_exp_f32 v89, v89
  v_exp_f32 v90, v90
  v_exp_f32 v91, v91
  v_cvt_pk_bf16_f32 v106, v84, v85
  v_cvt_pk_bf16_f32 v107, v86, v87
  v_mfma_f32_32x32x16_bf16 v[208:223], v[156:159], v[100:103], v[208:223]
  v_exp_f32 v92, v92
  v_exp_f32 v93, v93
  v_exp_f32 v94, v94
  v_exp_f32 v95, v95
  v_cvt_pk_bf16_f32 v108, v88, v89
  v_cvt_pk_bf16_f32 v109, v90, v91
  v_cvt_pk_bf16_f32 v110, v92, v93
  v_cvt_pk_bf16_f32 v111, v94, v95
  v_mfma_f32_32x32x16_bf16 v[80:95], v[160:163], v[40:43], 0
  s_waitcnt vmcnt(19) lgkmcnt(0)
  ds_read_b64_tr_b16 a[208:209], v11 offset:4096
  v_exp_f32 v64, v64
  v_exp_f32 v65, v65
  v_exp_f32 v66, v66
  v_exp_f32 v67, v67
  v_mfma_f32_32x32x16_bf16 v[80:95], v[164:167], v[44:47], v[80:95]
  s_add_u32 m0, s62, 0
  ds_read_b64_tr_b16 a[210:211], v11 offset:5120
  v_exp_f32 v68, v68
  v_exp_f32 v69, v69
  v_exp_f32 v70, v70
  v_exp_f32 v71, v71
  v_cvt_pk_bf16_f32 v96, v64, v65
  v_cvt_pk_bf16_f32 v97, v66, v67
  v_mfma_f32_32x32x16_bf16 v[224:239], v[152:155], v[104:107], v[224:239]
  s_add_u32 s16, s16, 25088
  ds_read_b64_tr_b16 a[212:213], v12 offset:4096
  v_exp_f32 v72, v72
  v_exp_f32 v73, v73
  v_exp_f32 v74, v74
  v_exp_f32 v75, v75
  v_cvt_pk_bf16_f32 v98, v68, v69
  v_cvt_pk_bf16_f32 v99, v70, v71
  v_mfma_f32_32x32x16_bf16 v[224:239], v[156:159], v[108:111], v[224:239]
  s_addc_u32 s17, s17, 0
  buffer_load_dwordx2 v[240:241], v15, s[28:31], 0 offen sc1
  ds_read_b64_tr_b16 a[214:215], v12 offset:5120
  v_exp_f32 v76, v76
  v_exp_f32 v77, v77
  v_exp_f32 v78, v78
  v_exp_f32 v79, v79
  v_cvt_pk_bf16_f32 v100, v72, v73
  v_cvt_pk_bf16_f32 v101, v74, v75
  v_cvt_pk_bf16_f32 v102, v76, v77
  v_cvt_pk_bf16_f32 v103, v78, v79
  v_mfma_f32_32x32x16_bf16 v[64:79], v[160:163], v[48:51], 0
  s_add_u32 s52, s52, 16384
  global_load_lds_dwordx4 v3, s[16:17] offset:0
  global_load_lds_dwordx4 v4, s[16:17] offset:1024
  v_exp_f32 v80, v80
  v_exp_f32 v81, v81
  v_exp_f32 v82, v82
  v_exp_f32 v83, v83
  v_mfma_f32_32x32x16_bf16 v[64:79], v[164:167], v[52:55], v[64:79]
  s_and_b32 s52, s52, 262143
  global_load_lds_dwordx4 v5, s[16:17] offset:2048
  global_load_lds_dwordx4 v6, s[16:17] offset:3072
  v_exp_f32 v84, v84
  v_exp_f32 v85, v85
  v_exp_f32 v86, v86
  v_exp_f32 v87, v87
  v_cvt_pk_bf16_f32 v104, v80, v81
  v_cvt_pk_bf16_f32 v105, v82, v83
  v_mfma_f32_32x32x16_bf16 v[176:191], v[168:171], v[96:99], v[176:191]
  s_add_u32 s12, s14, s52
  ds_read_b64_tr_b16 a[216:217], v11 offset:6144
  v_exp_f32 v88, v88
  v_exp_f32 v89, v89
  v_exp_f32 v90, v90
  v_exp_f32 v91, v91
  v_cvt_pk_bf16_f32 v106, v84, v85
  v_cvt_pk_bf16_f32 v107, v86, v87
  v_mfma_f32_32x32x16_bf16 v[176:191], v[172:175], v[100:103], v[176:191]
  s_addc_u32 s13, s15, 0
  ds_read_b64_tr_b16 a[218:219], v11 offset:7168
  v_exp_f32 v92, v92
  v_exp_f32 v93, v93
  v_exp_f32 v94, v94
  v_exp_f32 v95, v95
  v_cvt_pk_bf16_f32 v108, v88, v89
  v_cvt_pk_bf16_f32 v109, v90, v91
  v_cvt_pk_bf16_f32 v110, v92, v93
  v_cvt_pk_bf16_f32 v111, v94, v95
  v_mfma_f32_32x32x16_bf16 v[80:95], v[160:163], v[56:59], 0
  s_bitcmp1_b32 s42, 6
  s_cbranch_scc0 late_20
ok_19:
  global_load_dwordx4 v[144:147], v2, s[12:13] offset:0 sc1
  global_load_dwordx4 v[148:151], v2, s[12:13] offset:1024 sc1
  v_exp_f32 v64, v64
  v_exp_f32 v65, v65
  v_exp_f32 v66, v66
  v_exp_f32 v67, v67
  v_mfma_f32_32x32x16_bf16 v[80:95], v[164:167], v[60:63], v[80:95]
  global_load_dwordx4 v[152:155], v2, s[12:13] offset:2048 sc1
  global_load_dwordx4 v[156:159], v2, s[12:13] offset:3072 sc1
  v_exp_f32 v68, v68
  v_exp_f32 v69, v69
  v_exp_f32 v70, v70
  v_exp_f32 v71, v71
  v_cvt_pk_bf16_f32 v96, v64, v65
  v_cvt_pk_bf16_f32 v97, v66, v67
  v_mfma_f32_32x32x16_bf16 v[192:207], v[168:171], v[104:107], v[192:207]
  s_add_u32 m0, s47, 4096
  ds_read_b64_tr_b16 a[220:221], v12 offset:6144
  v_exp_f32 v72, v72
  v_exp_f32 v73, v73
  v_exp_f32 v74, v74
  v_exp_f32 v75, v75
  v_cvt_pk_bf16_f32 v98, v68, v69
  v_cvt_pk_bf16_f32 v99, v70, v71
  v_mfma_f32_32x32x16_bf16 v[192:207], v[172:175], v[108:111], v[192:207]
  s_waitcnt vmcnt(24)
  ds_read_b64_tr_b16 a[222:223], v12 offset:7168
  v_exp_f32 v76, v76
  v_exp_f32 v77, v77
  v_exp_f32 v78, v78
  v_exp_f32 v79, v79
  v_cvt_pk_bf16_f32 v100, v72, v73
  v_cvt_pk_bf16_f32 v101, v74, v75
  v_cvt_pk_bf16_f32 v102, v76, v77
  v_cvt_pk_bf16_f32 v103, v78, v79
  v_mfma_f32_32x32x16_bf16 v[64:79], v[112:115], v[32:35], 0
  global_load_lds_dwordx4 v7, s[20:21] offset:0
  global_load_lds_dwordx4 v8, s[20:21] offset:1024
  v_exp_f32 v80, v80
  v_exp_f32 v81, v81
  v_exp_f32 v82, v82
  v_exp_f32 v83, v83
  v_mfma_f32_32x32x16_bf16 v[64:79], v[116:119], v[36:39], v[64:79]
  global_load_lds_dwordx4 v9, s[20:21] offset:2048
  global_load_lds_dwordx4 v10, s[20:21] offset:3072
  v_exp_f32 v84, v84
  v_exp_f32 v85, v85
  v_exp_f32 v86, v86
  v_exp_f32 v87, v87
  v_cvt_pk_bf16_f32 v104, v80, v81
  v_cvt_pk_bf16_f32 v105, v82, v83
  v_mfma_f32_32x32x16_bf16 v[208:223], v[168:171], v[96:99], v[208:223]
  s_add_u32 s20, s20, 114688
  v_exp_f32 v88, v88
  v_exp_f32 v89, v89
  v_exp_f32 v90, v90
  v_exp_f32 v91, v91
  v_cvt_pk_bf16_f32 v106, v84, v85
  v_cvt_pk_bf16_f32 v107, v86, v87
  v_mfma_f32_32x32x16_bf16 v[208:223], v[172:175], v[100:103], v[208:223]
  s_addc_u32 s21, s21, 0
  v_exp_f32 v92, v92
  v_exp_f32 v93, v93
  v_exp_f32 v94, v94
  v_exp_f32 v95, v95
  v_cvt_pk_bf16_f32 v108, v88, v89
  v_cvt_pk_bf16_f32 v109, v90, v91
  v_cvt_pk_bf16_f32 v110, v92, v93
  v_cvt_pk_bf16_f32 v111, v94, v95
  v_mfma_f32_32x32x16_bf16 v[80:95], v[112:115], v[40:43], 0
  s_waitcnt vmcnt(20) lgkmcnt(0)
  ds_read_b64_tr_b16 a[224:225], v11 offset:8192
  v_exp_f32 v64, v64
  v_exp_f32 v65, v65
  v_exp_f32 v66, v66
  v_exp_f32 v67, v67
  v_mfma_f32_32x32x16_bf16 v[80:95], v[116:119], v[44:47], v[80:95]
  s_add_u32 m0, s62, 4096
  ds_read_b64_tr_b16 a[226:227], v11 offset:9216
  v_exp_f32 v68, v68
  v_exp_f32 v69, v69
  v_exp_f32 v70, v70
  v_exp_f32 v71, v71
  v_cvt_pk_bf16_f32 v96, v64, v65
  v_cvt_pk_bf16_f32 v97, v66, v67
  v_mfma_f32_32x32x16_bf16 v[224:239], v[168:171], v[104:107], v[224:239]
  ds_read_b64_tr_b16 a[228:229], v12 offset:8192
  v_exp_f32 v72, v72
  v_exp_f32 v73, v73
  v_exp_f32 v74, v74
  v_exp_f32 v75, v75
  v_cvt_pk_bf16_f32 v98, v68, v69
  v_cvt_pk_bf16_f32 v99, v70, v71
  v_mfma_f32_32x32x16_bf16 v[224:239], v[172:175], v[108:111], v[224:239]
  v_add_u32 v5, 14336, v5
  v_add_u32 v6, 6144, v5
  ds_read_b64_tr_b16 a[230:231], v12 offset:9216
  v_exp_f32 v76, v76
  v_exp_f32 v77, v77
  v_exp_f32 v78, v78
  v_exp_f32 v79, v79
  v_cvt_pk_bf16_f32 v100, v72, v73
  v_cvt_pk_bf16_f32 v101, v74, v75
  v_cvt_pk_bf16_f32 v102, v76, v77
  v_cvt_pk_bf16_f32 v103, v78, v79
  v_mfma_f32_32x32x16_bf16 v[64:79], v[112:115], v[48:51], 0
  s_add_u32 s52, s52, 16384
  global_load_lds_dwordx4 v3, s[24:25] offset:0
  global_load_lds_dwordx4 v4, s[24:25] offset:1024
  v_exp_f32 v80, v80
  v_exp_f32 v81, v81
  v_exp_f32 v82, v82
  v_exp_f32 v83, v83
  v_mfma_f32_32x32x16_bf16 v[64:79], v[116:119], v[52:55], v[64:79]
  s_and_b32 s52, s52, 262143
  global_load_lds_dwordx4 v5, s[24:25] offset:2048
  global_load_lds_dwordx4 v6, s[24:25] offset:3072
  v_exp_f32 v84, v84
  v_exp_f32 v85, v85
  v_exp_f32 v86, v86
  v_exp_f32 v87, v87
  v_cvt_pk_bf16_f32 v104, v80, v81
  v_cvt_pk_bf16_f32 v105, v82, v83
  v_mfma_f32_32x32x16_bf16 v[176:191], v[120:123], v[96:99], v[176:191]
  s_add_u32 s12, s14, s52
  s_waitcnt vmcnt(16)
  v_cmp_eq_u32 s[42:43], s48, v240
  ds_read_b64_tr_b16 a[232:233], v11 offset:10240
  v_exp_f32 v88, v88
  v_exp_f32 v89, v89
  v_exp_f32 v90, v90
  v_exp_f32 v91, v91
  v_cvt_pk_bf16_f32 v106, v84, v85
  v_cvt_pk_bf16_f32 v107, v86, v87
  v_mfma_f32_32x32x16_bf16 v[176:191], v[124:127], v[100:103], v[176:191]
  s_addc_u32 s13, s15, 0
  ds_read_b64_tr_b16 a[234:235], v11 offset:11264
  v_exp_f32 v92, v92
  v_exp_f32 v93, v93
  v_exp_f32 v94, v94
  v_exp_f32 v95, v95
  v_cvt_pk_bf16_f32 v108, v88, v89
  v_cvt_pk_bf16_f32 v109, v90, v91
  v_cvt_pk_bf16_f32 v110, v92, v93
  v_cvt_pk_bf16_f32 v111, v94, v95
  v_mfma_f32_32x32x16_bf16 v[80:95], v[112:115], v[56:59], 0
  s_andn2_b32 s4, 1048449, s42
  s_cbranch_scc1 late_22
ok_21:
  global_load_dwordx4 v[160:163], v2, s[12:13] offset:0 sc1
  global_load_dwordx4 v[164:167], v2, s[12:13] offset:1024 sc1
  v_exp_f32 v64, v64
  v_exp_f32 v65, v65
  v_exp_f32 v66, v66
  v_exp_f32 v67, v67
  v_mfma_f32_32x32x16_bf16 v[80:95], v[116:119], v[60:63], v[80:95]
  global_load_dwordx4 v[168:171], v2, s[12:13] offset:2048 sc1
  global_load_dwordx4 v[172:175], v2, s[12:13] offset:3072 sc1
  v_exp_f32 v68, v68
  v_exp_f32 v69, v69
  v_exp_f32 v70, v70
  v_exp_f32 v71, v71
  v_cvt_pk_bf16_f32 v96, v64, v65
  v_cvt_pk_bf16_f32 v97, v66, v67
  v_mfma_f32_32x32x16_bf16 v[192:207], v[120:123], v[104:107], v[192:207]
  ds_read_b64_tr_b16 a[236:237], v12 offset:10240
  v_exp_f32 v72, v72
  v_exp_f32 v73, v73
  v_exp_f32 v74, v74
  v_exp_f32 v75, v75
  v_cvt_pk_bf16_f32 v98, v68, v69
  v_cvt_pk_bf16_f32 v99, v70, v71
  v_mfma_f32_32x32x16_bf16 v[192:207], v[124:127], v[108:111], v[192:207]
  ds_read_b64_tr_b16 a[238:239], v12 offset:11264
  v_exp_f32 v76, v76
  v_exp_f32 v77, v77
  v_exp_f32 v78, v78
  v_exp_f32 v79, v79
  v_cvt_pk_bf16_f32 v100, v72, v73
  v_cvt_pk_bf16_f32 v101, v74, v75
  v_cvt_pk_bf16_f32 v102, v76, v77
  v_cvt_pk_bf16_f32 v103, v78, v79
  v_mfma_f32_32x32x16_bf16 v[64:79], v[128:131], v[32:35], 0
  v_exp_f32 v80, v80
  v_exp_f32 v81, v81
  v_exp_f32 v82, v82
  v_exp_f32 v83, v83
  v_mfma_f32_32x32x16_bf16 v[64:79], v[132:135], v[36:39], v[64:79]
  s_cmp_eq_u32 s69, 0
  s_cbranch_scc1 far_24
  global_store_dwordx4 v1, v[252:255], s[22:23] offset:0
  global_store_dwordx4 v1, v[252:255], s[22:23] offset:1024
  global_store_dwordx4 v1, v[252:255], s[22:23] offset:2048
  global_store_dwordx4 v1, v[252:255], s[22:23] offset:3072
ok_23:
  v_exp_f32 v84, v84
  v_exp_f32 v85, v85
  v_exp_f32 v86, v86
  v_exp_f32 v87, v87
  v_cvt_pk_bf16_f32 v104, v80, v81
  v_cvt_pk_bf16_f32 v105, v82, v83
  v_mfma_f32_32x32x16_bf16 v[208:223], v[120:123], v[96:99], v[208:223]
  v_exp_f32 v88, v88
  v_exp_f32 v89, v89
  v_exp_f32 v90, v90
  v_exp_f32 v91, v91
  v_cvt_pk_bf16_f32 v106, v84, v85
  v_cvt_pk_bf16_f32 v107, v86, v87
  v_mfma_f32_32x32x16_bf16 v[208:223], v[124:127], v[100:103], v[208:223]
  v_exp_f32 v92, v92
  v_exp_f32 v93, v93
  v_exp_f32 v94, v94
  v_exp_f32 v95, v95
  v_cvt_pk_bf16_f32 v108, v88, v89
  v_cvt_pk_bf16_f32 v109, v90, v91
  v_cvt_pk_bf16_f32 v110, v92, v93
  v_cvt_pk_bf16_f32 v111, v94, v95
  v_mfma_f32_32x32x16_bf16 v[80:95], v[128:131], v[40:43], 0
  s_waitcnt vmcnt(20) lgkmcnt(0)
  ds_read_b64_tr_b16 a[240:241], v11 offset:0
  v_exp_f32 v64, v64
  v_exp_f32 v65, v65
  v_exp_f32 v66, v66
  v_exp_f32 v67, v67
  v_mfma_f32_32x32x16_bf16 v[80:95], v[132:135], v[44:47], v[80:95]
  s_add_u32 m0, s62, 8192
  ds_read_b64_tr_b16 a[242:243], v11 offset:1024
  v_exp_f32 v68, v68
  v_exp_f32 v69, v69
  v_exp_f32 v70, v70
  v_exp_f32 v71, v71
  v_cvt_pk_bf16_f32 v96, v64, v65
  v_cvt_pk_bf16_f32 v97, v66, v67
  v_mfma_f32_32x32x16_bf16 v[224:239], v[120:123], v[104:107], v[224:239]
  s_add_u32 s24, s24, s60
  ds_read_b64_tr_b16 a[244:245], v12 offset:0
  v_exp_f32 v72, v72
  v_exp_f32 v73, v73
  v_exp_f32 v74, v74
  v_exp_f32 v75, v75
  v_cvt_pk_bf16_f32 v98, v68, v69
  v_cvt_pk_bf16_f32 v99, v70, v71
  v_mfma_f32_32x32x16_bf16 v[224:239], v[124:127], v[108:111], v[224:239]
  s_addc_u32 s25, s25, 0
  ds_read_b64_tr_b16 a[246:247], v12 offset:1024
  v_exp_f32 v76, v76
  v_exp_f32 v77, v77
  v_exp_f32 v78, v78
  v_exp_f32 v79, v79
  v_cvt_pk_bf16_f32 v100, v72, v73
  v_cvt_pk_bf16_f32 v101, v74, v75
  v_cvt_pk_bf16_f32 v102, v76, v77
  v_cvt_pk_bf16_f32 v103, v78, v79
  v_mfma_f32_32x32x16_bf16 v[64:79], v[128:131], v[48:51], 0
  s_add_u32 s52, s52, 16384
  global_load_lds_dwordx4 v3, s[24:25] offset:0
  global_load_lds_dwordx4 v4, s[24:25] offset:1024
  v_exp_f32 v80, v80
  v_exp_f32 v81, v81
  v_exp_f32 v82, v82
  v_exp_f32 v83, v83
  v_mfma_f32_32x32x16_bf16 v[64:79], v[132:135], v[52:55], v[64:79]
  s_and_b32 s52, s52, 262143
  global_load_lds_dwordx4 v5, s[24:25] offset:2048
  global_load_lds_dwordx4 v6, s[24:25] offset:3072
  v_exp_f32 v84, v84
  v_exp_f32 v85, v85
  v_exp_f32 v86, v86
  v_exp_f32 v87, v87
  v_cvt_pk_bf16_f32 v104, v80, v81
  v_cvt_pk_bf16_f32 v105, v82, v83
  v_mfma_f32_32x32x16_bf16 v[176:191], v[136:139], v[96:99], v[176:191]
  s_add_u32 s12, s14, s52
  ds_read_b64_tr_b16 a[248:249], v11 offset:2048
  v_exp_f32 v88, v88
  v_exp_f32 v89, v89
  v_exp_f32 v90, v90
  v_exp_f32 v91, v91
  v_cvt_pk_bf16_f32 v106, v84, v85
  v_cvt_pk_bf16_f32 v107, v86, v87
  v_mfma_f32_32x32x16_bf16 v[176:191], v[140:143], v[100:103], v[176:191]
  s_addc_u32 s13, s15, 0
  ds_read_b64_tr_b16 a[250:251], v11 offset:3072
  v_exp_f32 v92, v92
  v_exp_f32 v93, v93
  v_exp_f32 v94, v94
  v_exp_f32 v95, v95
  v_cvt_pk_bf16_f32 v108, v88, v89
  v_cvt_pk_bf16_f32 v109, v90, v91
  v_cvt_pk_bf16_f32 v110, v92, v93
  v_cvt_pk_bf16_f32 v111, v94, v95
  v_mfma_f32_32x32x16_bf16 v[80:95], v[128:131], v[56:59], 0
  global_load_dwordx4 v[112:115], v2, s[12:13] offset:0 sc1
  global_load_dwordx4 v[116:119], v2, s[12:13] offset:1024 sc1
  v_exp_f32 v64, v64
  v_exp_f32 v65, v65
  v_exp_f32 v66, v66
  v_exp_f32 v67, v67
  v_mfma_f32_32x32x16_bf16 v[80:95], v[132:135], v[60:63], v[80:95]
  global_load_dwordx4 v[120:123], v2, s[12:13] offset:2048 sc1
  global_load_dwordx4 v[124:127], v2, s[12:13] offset:3072 sc1
  v_exp_f32 v68, v68
  v_exp_f32 v69, v69
  v_exp_f32 v70, v70
  v_exp_f32 v71, v71
  v_cvt_pk_bf16_f32 v96, v64, v65
  v_cvt_pk_bf16_f32 v97, v66, v67
  v_mfma_f32_32x32x16_bf16 v[192:207], v[136:139], v[104:107], v[192:207]
  s_add_u32 m0, s47, 8192
  ds_read_b64_tr_b16 a[252:253], v12 offset:2048
  v_exp_f32 v72, v72
  v_exp_f32 v73, v73
  v_exp_f32 v74, v74
  v_exp_f32 v75, v75
  v_cvt_pk_bf16_f32 v98, v68, v69
  v_cvt_pk_bf16_f32 v99, v70, v71
  v_mfma_f32_32x32x16_bf16 v[192:207], v[140:143], v[108:111], v[192:207]
  s_waitcnt vmcnt(24)
  ds_read_b64_tr_b16 a[254:255], v12 offset:3072
  v_exp_f32 v76, v76
  v_exp_f32 v77, v77
  v_exp_f32 v78, v78
  v_exp_f32 v79, v79
  v_cvt_pk_bf16_f32 v100, v72, v73
  v_cvt_pk_bf16_f32 v101, v74, v75
  v_cvt_pk_bf16_f32 v102, v76, v77
  v_cvt_pk_bf16_f32 v103, v78, v79
  v_mfma_f32_32x32x16_bf16 v[64:79], v[144:147], v[32:35], 0
  global_load_lds_dwordx4 v7, s[20:21] offset:0
  global_load_lds_dwordx4 v8, s[20:21] offset:1024
  v_exp_f32 v80, v80
  v_exp_f32 v81, v81
  v_exp_f32 v82, v82
  v_exp_f32 v83, v83
  v_mfma_f32_32x32x16_bf16 v[64:79], v[148:151], v[36:39], v[64:79]
  global_load_lds_dwordx4 v9, s[20:21] offset:2048
  global_load_lds_dwordx4 v10, s[20:21] offset:3072
  v_exp_f32 v84, v84
  v_exp_f32 v85, v85
  v_exp_f32 v86, v86
  v_exp_f32 v87, v87
  v_cvt_pk_bf16_f32 v104, v80, v81
  v_cvt_pk_bf16_f32 v105, v82, v83
  v_mfma_f32_32x32x16_bf16 v[208:223], v[136:139], v[96:99], v[208:223]
  s_add_u32 s20, s20, 114688
  v_exp_f32 v88, v88
  v_exp_f32 v89, v89
  v_exp_f32 v90, v90
  v_exp_f32 v91, v91
  v_cvt_pk_bf16_f32 v106, v84, v85
  v_cvt_pk_bf16_f32 v107, v86, v87
  v_mfma_f32_32x32x16_bf16 v[208:223], v[140:143], v[100:103], v[208:223]
  s_addc_u32 s21, s21, 0
  v_exp_f32 v92, v92
  v_exp_f32 v93, v93
  v_exp_f32 v94, v94
  v_exp_f32 v95, v95
  v_cvt_pk_bf16_f32 v108, v88, v89
  v_cvt_pk_bf16_f32 v109, v90, v91
  v_cvt_pk_bf16_f32 v110, v92, v93
  v_cvt_pk_bf16_f32 v111, v94, v95
  v_mfma_f32_32x32x16_bf16 v[80:95], v[144:147], v[40:43], 0
  s_waitcnt vmcnt(20) lgkmcnt(0)
  ds_read_b64_tr_b16 a[0:1], v11 offset:4096
  v_exp_f32 v64, v64
  v_exp_f32 v65, v65
  v_exp_f32 v66, v66
  v_exp_f32 v67, v67
  v_mfma_f32_32x32x16_bf16 v[80:95], v[148:151], v[44:47], v[80:95]
  s_add_u32 m0, s62, 0
  ds_read_b64_tr_b16 a[2:3], v11 offset:5120
  v_exp_f32 v68, v68
  v_exp_f32 v69, v69
  v_exp_f32 v70, v70
  v_exp_f32 v71, v71
  v_cvt_pk_bf16_f32 v96, v64, v65
  v_cvt_pk_bf16_f32 v97, v66, v67
  v_mfma_f32_32x32x16_bf16 v[224:239], v[136:139], v[104:107], v[224:239]
  s_add_u32 s24, s24, s61
  ds_read_b64_tr_b16 a[4:5], v12 offset:4096
  v_exp_f32 v72, v72
  v_exp_f32 v73, v73
  v_exp_f32 v74, v74
  v_exp_f32 v75, v75
  v_cvt_pk_bf16_f32 v98, v68, v69
  v_cvt_pk_bf16_f32 v99, v70, v71
  v_mfma_f32_32x32x16_bf16 v[224:239], v[140:143], v[108:111], v[224:239]
  s_addc_u32 s25, s25, 0
  ds_read_b64_tr_b16 a[6:7], v12 offset:5120
  v_exp_f32 v76, v76
  v_exp_f32 v77, v77
  v_exp_f32 v78, v78
  v_exp_f32 v79, v79
  v_cvt_pk_bf16_f32 v100, v72, v73
  v_cvt_pk_bf16_f32 v101, v74, v75
  v_cvt_pk_bf16_f32 v102, v76, v77
  v_cvt_pk_bf16_f32 v103, v78, v79
  v_mfma_f32_32x32x16_bf16 v[64:79], v[144:147], v[48:51], 0
  s_add_u32 s52, s52, 16384
  global_load_lds_dwordx4 v3, s[24:25] offset:0
  global_load_lds_dwordx4 v4, s[24:25] offset:1024
  v_exp_f32 v80, v80
  v_exp_f32 v81, v81
  v_exp_f32 v82, v82
  v_exp_f32 v83, v83
  v_mfma_f32_32x32x16_bf16 v[64:79], v[148:151], v[52:55], v[64:79]
  s_and_b32 s52, s52, 262143
  global_load_lds_dwordx4 v5, s[24:25] offset:2048
  global_load_lds_dwordx4 v6, s[24:25] offset:3072
  v_exp_f32 v84, v84
  v_exp_f32 v85, v85
  v_exp_f32 v86, v86
  v_exp_f32 v87, v87
  v_cvt_pk_bf16_f32 v104, v80, v81
  v_cvt_pk_bf16_f32 v105, v82, v83
  v_mfma_f32_32x32x16_bf16 v[176:191], v[152:155], v[96:99], v[176:191]
  s_add_u32 s12, s14, s52
  ds_read_b64_tr_b16 a[56:57], v11 offset:6144
  v_exp_f32 v88, v88
  v_exp_f32 v89, v89
  v_exp_f32 v90, v90
  v_exp_f32 v91, v91
  v_cvt_pk_bf16_f32 v106, v84, v85
  v_cvt_pk_bf16_f32 v107, v86, v87
  v_mfma_f32_32x32x16_bf16 v[176:191], v[156:159], v[100:103], v[176:191]
  s_addc_u32 s13, s15, 0
  ds_read_b64_tr_b16 a[58:59], v11 offset:7168
  v_exp_f32 v92, v92
  v_exp_f32 v93, v93
  v_exp_f32 v94, v94
  v_exp_f32 v95, v95
  v_cvt_pk_bf16_f32 v108, v88, v89
  v_cvt_pk_bf16_f32 v109, v90, v91
  v_cvt_pk_bf16_f32 v110, v92, v93
  v_cvt_pk_bf16_f32 v111, v94, v95
  v_mfma_f32_32x32x16_bf16 v[80:95], v[144:147], v[56:59], 0
  global_load_dwordx4 v[128:131], v2, s[12:13] offset:0 sc1
  global_load_dwordx4 v[132:135], v2, s[12:13] offset:1024 sc1
  v_exp_f32 v64, v64
  v_exp_f32 v65, v65
  v_exp_f32 v66, v66
  v_exp_f32 v67, v67
  v_mfma_f32_32x32x16_bf16 v[80:95], v[148:151], v[60:63], v[80:95]
  global_load_dwordx4 v[136:139], v2, s[12:13] offset:2048 sc1
  global_load_dwordx4 v[140:143], v2, s[12:13] offset:3072 sc1
  v_exp_f32 v68, v68
  v_exp_f32 v69, v69
  v_exp_f32 v70, v70
  v_exp_f32 v71, v71
  v_cvt_pk_bf16_f32 v96, v64, v65
  v_cvt_pk_bf16_f32 v97, v66, v67
  v_mfma_f32_32x32x16_bf16 v[192:207], v[152:155], v[104:107], v[192:207]
  ds_read_b64_tr_b16 a[60:61], v12 offset:6144
  v_exp_f32 v72, v72
  v_exp_f32 v73, v73
  v_exp_f32 v74, v74
  v_exp_f32 v75, v75
  v_cvt_pk_bf16_f32 v98, v68, v69
  v_cvt_pk_bf16_f32 v99, v70, v71
  v_mfma_f32_32x32x16_bf16 v[192:207], v[156:159], v[108:111], v[192:207]
  s_waitcnt vmcnt(24)
  ds_read_b64_tr_b16 a[62:63], v12 offset:7168
  v_exp_f32 v76, v76
  v_exp_f32 v77, v77
  v_exp_f32 v78, v78
  v_exp_f32 v79, v79
  v_cvt_pk_bf16_f32 v100, v72, v73
  v_cvt_pk_bf16_f32 v101, v74, v75
  v_cvt_pk_bf16_f32 v102, v76, v77
  v_cvt_pk_bf16_f32 v103, v78, v79
  v_mfma_f32_32x32x16_bf16 v[64:79], v[160:163], v[32:35], 0
  v_exp_f32 v80, v80
  v_exp_f32 v81, v81
  v_exp_f32 v82, v82
  v_exp_f32 v83, v83
  v_mfma_f32_32x32x16_bf16 v[64:79], v[164:167], v[36:39], v[64:79]
  s_cmp_eq_u32 s69, 0
  s_cbranch_scc1 far_26
  global_store_dwordx4 v1, v[252:255], s[26:27] offset:0
  global_store_dwordx4 v1, v[252:255], s[26:27] offset:1024
ok_25:
  v_exp_f32 v84, v84
  v_exp_f32 v85, v85
  v_exp_f32 v86, v86
  v_exp_f32 v87, v87
  v_cvt_pk_bf16_f32 v104, v80, v81
  v_cvt_pk_bf16_f32 v105, v82, v83
  v_mfma_f32_32x32x16_bf16 v[208:223], v[152:155], v[96:99], v[208:223]
  global_store_dwordx4 v1, v[252:255], s[18:19] offset:0 sc1
  global_store_dwordx4 v1, v[252:255], s[18:19] offset:1024 sc1
  v_exp_f32 v88, v88
  v_exp_f32 v89, v89
  v_exp_f32 v90, v90
  v_exp_f32 v91, v91
  v_cvt_pk_bf16_f32 v106, v84, v85
  v_cvt_pk_bf16_f32 v107, v86, v87
  v_mfma_f32_32x32x16_bf16 v[208:223], v[156:159], v[100:103], v[208:223]
  v_exp_f32 v92, v92
  v_exp_f32 v93, v93
  v_exp_f32 v94, v94
  v_exp_f32 v95, v95
  v_cvt_pk_bf16_f32 v108, v88, v89
  v_cvt_pk_bf16_f32 v109, v90, v91
  v_cvt_pk_bf16_f32 v110, v92, v93
  v_cvt_pk_bf16_f32 v111, v94, v95
  v_mfma_f32_32x32x16_bf16 v[80:95], v[160:163], v[40:43], 0
  s_waitcnt vmcnt(20) lgkmcnt(0)
  ds_read_b64_tr_b16 a[8:9], v11 offset:8192
  v_exp_f32 v64, v64
  v_exp_f32 v65, v65
  v_exp_f32 v66, v66
  v_exp_f32 v67, v67
  v_mfma_f32_32x32x16_bf16 v[80:95], v[164:167], v[44:47], v[80:95]
  s_add_u32 m0, s62, 4096
  ds_read_b64_tr_b16 a[10:11], v11 offset:9216
  v_exp_f32 v68, v68
  v_exp_f32 v69, v69
  v_exp_f32 v70, v70
  v_exp_f32 v71, v71
  v_cvt_pk_bf16_f32 v96, v64, v65
  v_cvt_pk_bf16_f32 v97, v66, v67
  v_mfma_f32_32x32x16_bf16 v[224:239], v[152:155], v[104:107], v[224:239]
  s_add_u32 s24, s24, s60
  ds_read_b64_tr_b16 a[12:13], v12 offset:8192
  v_exp_f32 v72, v72
  v_exp_f32 v73, v73
  v_exp_f32 v74, v74
  v_exp_f32 v75, v75
  v_cvt_pk_bf16_f32 v98, v68, v69
  v_cvt_pk_bf16_f32 v99, v70, v71
  v_mfma_f32_32x32x16_bf16 v[224:239], v[156:159], v[108:111], v[224:239]
  s_addc_u32 s25, s25, 0
  ds_read_b64_tr_b16 a[14:15], v12 offset:9216
  v_exp_f32 v76, v76
  v_exp_f32 v77, v77
  v_exp_f32 v78, v78
  v_exp_f32 v79, v79
  v_cvt_pk_bf16_f32 v100, v72, v73
  v_cvt_pk_bf16_f32 v101, v74, v75
  v_cvt_pk_bf16_f32 v102, v76, v77
  v_cvt_pk_bf16_f32 v103, v78, v79
  v_mfma_f32_32x32x16_bf16 v[64:79], v[160:163], v[48:51], 0
  s_add_u32 s52, s52, 16384
  global_load_lds_dwordx4 v3, s[24:25] offset:0
  global_load_lds_dwordx4 v4, s[24:25] offset:1024
  v_exp_f32 v80, v80
  v_exp_f32 v81, v81
  v_exp_f32 v82, v82
  v_exp_f32 v83, v83
  v_mfma_f32_32x32x16_bf16 v[64:79], v[164:167], v[52:55], v[64:79]
  s_and_b32 s52, s52, 262143
  global_load_lds_dwordx4 v5, s[24:25] offset:2048
  global_load_lds_dwordx4 v6, s[24:25] offset:3072
  v_exp_f32 v84, v84
  v_exp_f32 v85, v85
  v_exp_f32 v86, v86
  v_exp_f32 v87, v87
  v_cvt_pk_bf16_f32 v104, v80, v81
  v_cvt_pk_bf16_f32 v105, v82, v83
  v_mfma_f32_32x32x16_bf16 v[176:191], v[168:171], v[96:99], v[176:191]
  s_add_u32 s12, s14, s52
  ds_read_b64_tr_b16 a[64:65], v11 offset:10240
  v_exp_f32 v88, v88
  v_exp_f32 v89, v89
  v_exp_f32 v90, v90
  v_exp_f32 v91, v91
  v_cvt_pk_bf16_f32 v106, v84, v85
  v_cvt_pk_bf16_f32 v107, v86, v87
  v_mfma_f32_32x32x16_bf16 v[176:191], v[172:175], v[100:103], v[176:191]
  s_addc_u32 s13, s15, 0
  ds_read_b64_tr_b16 a[66:67], v11 offset:11264
  v_exp_f32 v92, v92
  v_exp_f32 v93, v93
  v_exp_f32 v94, v94
  v_exp_f32 v95, v95
  v_cvt_pk_bf16_f32 v108, v88, v89
  v_cvt_pk_bf16_f32 v109, v90, v91
  v_cvt_pk_bf16_f32 v110, v92, v93
  v_cvt_pk_bf16_f32 v111, v94, v95
  v_mfma_f32_32x32x16_bf16 v[80:95], v[160:163], v[56:59], 0
  global_load_dwordx4 v[144:147], v2, s[12:13] offset:0 sc1
  global_load_dwordx4 v[148:151], v2, s[12:13] offset:1024 sc1
  v_exp_f32 v64, v64
  v_exp_f32 v65, v65
  v_exp_f32 v66, v66
  v_exp_f32 v67, v67
  v_mfma_f32_32x32x16_bf16 v[80:95], v[164:167], v[60:63], v[80:95]
  global_load_dwordx4 v[152:155], v2, s[12:13] offset:2048 sc1
  global_load_dwordx4 v[156:159], v2, s[12:13] offset:3072 sc1
  v_exp_f32 v68, v68
  v_exp_f32 v69, v69
  v_exp_f32 v70, v70
  v_exp_f32 v71, v71
  v_cvt_pk_bf16_f32 v96, v64, v65
  v_cvt_pk_bf16_f32 v97, v66, v67
  v_mfma_f32_32x32x16_bf16 v[192:207], v[168:171], v[104:107], v[192:207]
  s_add_u32 m0, s47, 12288
  ds_read_b64_tr_b16 a[68:69], v12 offset:10240
  v_exp_f32 v72, v72
  v_exp_f32 v73, v73
  v_exp_f32 v74, v74
  v_exp_f32 v75, v75
  v_cvt_pk_bf16_f32 v98, v68, v69
  v_cvt_pk_bf16_f32 v99, v70, v71
  v_mfma_f32_32x32x16_bf16 v[192:207], v[172:175], v[108:111], v[192:207]
  s_waitcnt vmcnt(24)
  ds_read_b64_tr_b16 a[70:71], v12 offset:11264
  v_exp_f32 v76, v76
  v_exp_f32 v77, v77
  v_exp_f32 v78, v78
  v_exp_f32 v79, v79
  v_cvt_pk_bf16_f32 v100, v72, v73
  v_cvt_pk_bf16_f32 v101, v74, v75
  v_cvt_pk_bf16_f32 v102, v76, v77
  v_cvt_pk_bf16_f32 v103, v78, v79
  v_mfma_f32_32x32x16_bf16 v[64:79], v[112:115], v[32:35], 0
  global_load_lds_dwordx4 v7, s[20:21] offset:0
  global_load_lds_dwordx4 v8, s[20:21] offset:1024
  v_exp_f32 v80, v80
  v_exp_f32 v81, v81
  v_exp_f32 v82, v82
  v_exp_f32 v83, v83
  v_mfma_f32_32x32x16_bf16 v[64:79], v[116:119], v[36:39], v[64:79]
  global_load_lds_dwordx4 v9, s[20:21] offset:2048
  global_load_lds_dwordx4 v10, s[20:21] offset:3072
  v_exp_f32 v84, v84
  v_exp_f32 v85, v85
  v_exp_f32 v86, v86
  v_exp_f32 v87, v87
  v_cvt_pk_bf16_f32 v104, v80, v81
  v_cvt_pk_bf16_f32 v105, v82, v83
  v_mfma_f32_32x32x16_bf16 v[208:223], v[168:171], v[96:99], v[208:223]
  s_add_u32 s20, s20, 114688
  v_exp_f32 v88, v88
  v_exp_f32 v89, v89
  v_exp_f32 v90, v90
  v_exp_f32 v91, v91
  v_cvt_pk_bf16_f32 v106, v84, v85
  v_cvt_pk_bf16_f32 v107, v86, v87
  v_mfma_f32_32x32x16_bf16 v[208:223], v[172:175], v[100:103], v[208:223]
  s_addc_u32 s21, s21, 0
  v_exp_f32 v92, v92
  v_exp_f32 v93, v93
  v_exp_f32 v94, v94
  v_exp_f32 v95, v95
  v_cvt_pk_bf16_f32 v108, v88, v89
  v_cvt_pk_bf16_f32 v109, v90, v91
  v_cvt_pk_bf16_f32 v110, v92, v93
  v_cvt_pk_bf16_f32 v111, v94, v95
  v_mfma_f32_32x32x16_bf16 v[80:95], v[112:115], v[40:43], 0
  s_waitcnt vmcnt(20) lgkmcnt(0)
  ds_read_b64_tr_b16 a[16:17], v11 offset:0
  v_exp_f32 v64, v64
  v_exp_f32 v65, v65
  v_exp_f32 v66, v66
  v_exp_f32 v67, v67
  v_mfma_f32_32x32x16_bf16 v[80:95], v[116:119], v[44:47], v[80:95]
  s_add_u32 m0, s62, 8192
  ds_read_b64_tr_b16 a[18:19], v11 offset:1024
  v_exp_f32 v68, v68
  v_exp_f32 v69, v69
  v_exp_f32 v70, v70
  v_exp_f32 v71, v71
  v_cvt_pk_bf16_f32 v96, v64, v65
  v_cvt_pk_bf16_f32 v97, v66, v67
  v_mfma_f32_32x32x16_bf16 v[224:239], v[168:171], v[104:107], v[224:239]
  s_add_u32 s24, s24, s61
  ds_read_b64_tr_b16 a[20:21], v12 offset:0
  v_exp_f32 v72, v72
  v_exp_f32 v73, v73
  v_exp_f32 v74, v74
  v_exp_f32 v75, v75
  v_cvt_pk_bf16_f32 v98, v68, v69
  v_cvt_pk_bf16_f32 v99, v70, v71
  v_mfma_f32_32x32x16_bf16 v[224:239], v[172:175], v[108:111], v[224:239]
  s_addc_u32 s25, s25, 0
  ds_read_b64_tr_b16 a[22:23], v12 offset:1024
  v_exp_f32 v76, v76
  v_exp_f32 v77, v77
  v_exp_f32 v78, v78
  v_exp_f32 v79, v79
  v_cvt_pk_bf16_f32 v100, v72, v73
  v_cvt_pk_bf16_f32 v101, v74, v75
  v_cvt_pk_bf16_f32 v102, v76, v77
  v_cvt_pk_bf16_f32 v103, v78, v79
  v_mfma_f32_32x32x16_bf16 v[64:79], v[112:115], v[48:51], 0
  s_add_u32 s52, s52, 16384
  global_load_lds_dwordx4 v3, s[24:25] offset:0
  global_load_lds_dwordx4 v4, s[24:25] offset:1024
  v_exp_f32 v80, v80
  v_exp_f32 v81, v81
  v_exp_f32 v82, v82
  v_exp_f32 v83, v83
  v_mfma_f32_32x32x16_bf16 v[64:79], v[116:119], v[52:55], v[64:79]
  s_and_b32 s52, s52, 262143
  global_load_lds_dwordx4 v5, s[24:25] offset:2048
  global_load_lds_dwordx4 v6, s[24:25] offset:3072
  v_exp_f32 v84, v84
  v_exp_f32 v85, v85
  v_exp_f32 v86, v86
  v_exp_f32 v87, v87
  v_cvt_pk_bf16_f32 v104, v80, v81
  v_cvt_pk_bf16_f32 v105, v82, v83
  v_mfma_f32_32x32x16_bf16 v[176:191], v[120:123], v[96:99], v[176:191]
  s_add_u32 s12, s14, s52
  ds_read_b64_tr_b16 a[72:73], v11 offset:2048
  v_exp_f32 v88, v88
  v_exp_f32 v89, v89
  v_exp_f32 v90, v90
  v_exp_f32 v91, v91
  v_cvt_pk_bf16_f32 v106, v84, v85
  v_cvt_pk_bf16_f32 v107, v86, v87
  v_mfma_f32_32x32x16_bf16 v[176:191], v[124:127], v[100:103], v[176:191]
  s_addc_u32 s13, s15, 0
  ds_read_b64_tr_b16 a[74:75], v11 offset:3072
  v_exp_f32 v92, v92
  v_exp_f32 v93, v93
  v_exp_f32 v94, v94
  v_exp_f32 v95, v95
  v_cvt_pk_bf16_f32 v108, v88, v89
  v_cvt_pk_bf16_f32 v109, v90, v91
  v_cvt_pk_bf16_f32 v110, v92, v93
  v_cvt_pk_bf16_f32 v111, v94, v95
  v_mfma_f32_32x32x16_bf16 v[80:95], v[112:115], v[56:59], 0
  global_load_dwordx4 v[160:163], v2, s[12:13] offset:0 sc1
  global_load_dwordx4 v[164:167], v2, s[12:13] offset:1024 sc1
  v_exp_f32 v64, v64
  v_exp_f32 v65, v65
  v_exp_f32 v66, v66
  v_exp_f32 v67, v67
  v_mfma_f32_32x32x16_bf16 v[80:95], v[116:119], v[60:63], v[80:95]
  global_load_dwordx4 v[168:171], v2, s[12:13] offset:2048 sc1
  global_load_dwordx4 v[172:175], v2, s[12:13] offset:3072 sc1
  v_exp_f32 v68, v68
  v_exp_f32 v69, v69
  v_exp_f32 v70, v70
  v_exp_f32 v71, v71
  v_cvt_pk_bf16_f32 v96, v64, v65
  v_cvt_pk_bf16_f32 v97, v66, v67
  v_mfma_f32_32x32x16_bf16 v[192:207], v[120:123], v[104:107], v[192:207]
  ds_read_b64_tr_b16 a[76:77], v12 offset:2048
  v_exp_f32 v72, v72
  v_exp_f32 v73, v73
  v_exp_f32 v74, v74
  v_exp_f32 v75, v75
  v_cvt_pk_bf16_f32 v98, v68, v69
  v_cvt_pk_bf16_f32 v99, v70, v71
  v_mfma_f32_32x32x16_bf16 v[192:207], v[124:127], v[108:111], v[192:207]
  s_waitcnt vmcnt(24)
  ds_read_b64_tr_b16 a[78:79], v12 offset:3072
  v_exp_f32 v76, v76
  v_exp_f32 v77, v77
  v_exp_f32 v78, v78
  v_exp_f32 v79, v79
  v_cvt_pk_bf16_f32 v100, v72, v73
  v_cvt_pk_bf16_f32 v101, v74, v75
  v_cvt_pk_bf16_f32 v102, v76, v77
  v_cvt_pk_bf16_f32 v103, v78, v79
  v_mfma_f32_32x32x16_bf16 v[64:79], v[128:131], v[32:35], 0
  v_exp_f32 v80, v80
  v_exp_f32 v81, v81
  v_exp_f32 v82, v82
  v_exp_f32 v83, v83
  v_mfma_f32_32x32x16_bf16 v[64:79], v[132:135], v[36:39], v[64:79]
  v_exp_f32 v84, v84
  v_exp_f32 v85, v85
  v_exp_f32 v86, v86
  v_exp_f32 v87, v87
  v_cvt_pk_bf16_f32 v104, v80, v81
  v_cvt_pk_bf16_f32 v105, v82, v83
  v_mfma_f32_32x32x16_bf16 v[208:223], v[120:123], v[96:99], v[208:223]
  v_exp_f32 v88, v88
  v_exp_f32 v89, v89
  v_exp_f32 v90, v90
  v_exp_f32 v91, v91
  v_cvt_pk_bf16_f32 v106, v84, v85
  v_cvt_pk_bf16_f32 v107, v86, v87
  v_mfma_f32_32x32x16_bf16 v[208:223], v[124:127], v[100:103], v[208:223]
  v_exp_f32 v92, v92
  v_exp_f32 v93, v93
  v_exp_f32 v94, v94
  v_exp_f32 v95, v95
  v_cvt_pk_bf16_f32 v108, v88, v89
  v_cvt_pk_bf16_f32 v109, v90, v91
  v_cvt_pk_bf16_f32 v110, v92, v93
  v_cvt_pk_bf16_f32 v111, v94, v95
  v_mfma_f32_32x32x16_bf16 v[80:95], v[128:131], v[40:43], 0
  s_waitcnt vmcnt(16) lgkmcnt(0)
  ds_read_b64_tr_b16 a[24:25], v11 offset:4096
  v_exp_f32 v64, v64
  v_exp_f32 v65, v65
  v_exp_f32 v66, v66
  v_exp_f32 v67, v67
  v_mfma_f32_32x32x16_bf16 v[80:95], v[132:135], v[44:47], v[80:95]
  s_add_u32 m0, s62, 0
  ds_read_b64_tr_b16 a[26:27], v11 offset:5120
  v_exp_f32 v68, v68
  v_exp_f32 v69, v69
  v_exp_f32 v70, v70
  v_exp_f32 v71, v71
  v_cvt_pk_bf16_f32 v96, v64, v65
  v_cvt_pk_bf16_f32 v97, v66, v67
  v_mfma_f32_32x32x16_bf16 v[224:239], v[120:123], v[104:107], v[224:239]
  s_add_u32 s24, s24, s60
  ds_read_b64_tr_b16 a[28:29], v12 offset:4096
  v_exp_f32 v72, v72
  v_exp_f32 v73, v73
  v_exp_f32 v74, v74
  v_exp_f32 v75, v75
  v_cvt_pk_bf16_f32 v98, v68, v69
  v_cvt_pk_bf16_f32 v99, v70, v71
  v_mfma_f32_32x32x16_bf16 v[224:239], v[124:127], v[108:111], v[224:239]
  s_addc_u32 s25, s25, 0
  ds_read_b64_tr_b16 a[30:31], v12 offset:5120
  v_exp_f32 v76, v76
  v_exp_f32 v77, v77
  v_exp_f32 v78, v78
  v_exp_f32 v79, v79
  v_cvt_pk_bf16_f32 v100, v72, v73
  v_cvt_pk_bf16_f32 v101, v74, v75
  v_cvt_pk_bf16_f32 v102, v76, v77
  v_cvt_pk_bf16_f32 v103, v78, v79
  v_mfma_f32_32x32x16_bf16 v[64:79], v[128:131], v[48:51], 0
  s_add_u32 s52, s52, 16384
  global_load_lds_dwordx4 v3, s[24:25] offset:0
  global_load_lds_dwordx4 v4, s[24:25] offset:1024
  v_exp_f32 v80, v80
  v_exp_f32 v81, v81
  v_exp_f32 v82, v82
  v_exp_f32 v83, v83
  v_mfma_f32_32x32x16_bf16 v[64:79], v[132:135], v[52:55], v[64:79]
  s_and_b32 s52, s52, 262143
  global_load_lds_dwordx4 v5, s[24:25] offset:2048
  global_load_lds_dwordx4 v6, s[24:25] offset:3072
  v_exp_f32 v84, v84
  v_exp_f32 v85, v85
  v_exp_f32 v86, v86
  v_exp_f32 v87, v87
  v_cvt_pk_bf16_f32 v104, v80, v81
  v_cvt_pk_bf16_f32 v105, v82, v83
  v_mfma_f32_32x32x16_bf16 v[176:191], v[136:139], v[96:99], v[176:191]
  s_add_u32 s12, s14, s52
  ds_read_b64_tr_b16 a[80:81], v11 offset:6144
  v_exp_f32 v88, v88
  v_exp_f32 v89, v89
  v_exp_f32 v90, v90
  v_exp_f32 v91, v91
  v_cvt_pk_bf16_f32 v106, v84, v85
  v_cvt_pk_bf16_f32 v107, v86, v87
  v_mfma_f32_32x32x16_bf16 v[176:191], v[140:143], v[100:103], v[176:191]
  s_addc_u32 s13, s15, 0
  ds_read_b64_tr_b16 a[82:83], v11 offset:7168
  v_exp_f32 v92, v92
  v_exp_f32 v93, v93
  v_exp_f32 v94, v94
  v_exp_f32 v95, v95
  v_cvt_pk_bf16_f32 v108, v88, v89
  v_cvt_pk_bf16_f32 v109, v90, v91
  v_cvt_pk_bf16_f32 v110, v92, v93
  v_cvt_pk_bf16_f32 v111, v94, v95
  v_mfma_f32_32x32x16_bf16 v[80:95], v[128:131], v[56:59], 0
  global_load_dwordx4 v[112:115], v2, s[12:13] offset:0 sc1
  global_load_dwordx4 v[116:119], v2, s[12:13] offset:1024 sc1
  v_exp_f32 v64, v64
  v_exp_f32 v65, v65
  v_exp_f32 v66, v66
  v_exp_f32 v67, v67
  v_mfma_f32_32x32x16_bf16 v[80:95], v[132:135], v[60:63], v[80:95]
  global_load_dwordx4 v[120:123], v2, s[12:13] offset:2048 sc1
  global_load_dwordx4 v[124:127], v2, s[12:13] offset:3072 sc1
  v_exp_f32 v68, v68
  v_exp_f32 v69, v69
  v_exp_f32 v70, v70
  v_exp_f32 v71, v71
  v_cvt_pk_bf16_f32 v96, v64, v65
  v_cvt_pk_bf16_f32 v97, v66, v67
  v_mfma_f32_32x32x16_bf16 v[192:207], v[136:139], v[104:107], v[192:207]
  s_add_u32 m0, s47, 16384
  v_mov_b32 v16, s48
  ds_read_b64_tr_b16 a[84:85], v12 offset:6144
  v_exp_f32 v72, v72
  v_exp_f32 v73, v73
  v_exp_f32 v74, v74
  v_exp_f32 v75, v75
  v_cvt_pk_bf16_f32 v98, v68, v69
  v_cvt_pk_bf16_f32 v99, v70, v71
  v_mfma_f32_32x32x16_bf16 v[192:207], v[140:143], v[108:111], v[192:207]
  s_waitcnt vmcnt(20)
  ds_read_b64_tr_b16 a[86:87], v12 offset:7168
  v_exp_f32 v76, v76
  v_exp_f32 v77, v77
  v_exp_f32 v78, v78
  v_exp_f32 v79, v79
  v_cvt_pk_bf16_f32 v100, v72, v73
  v_cvt_pk_bf16_f32 v101, v74, v75
  v_cvt_pk_bf16_f32 v102, v76, v77
  v_cvt_pk_bf16_f32 v103, v78, v79
  v_mfma_f32_32x32x16_bf16 v[64:79], v[144:147], v[32:35], 0
  global_load_lds_dwordx4 v7, s[20:21] offset:0
  global_load_lds_dwordx4 v8, s[20:21] offset:1024
  s_mov_b64 exec, 1
  buffer_store_dword v16, off, s[28:31], s51 sc1
  s_mov_b64 exec, -1
  v_exp_f32 v80, v80
  v_exp_f32 v81, v81
  v_exp_f32 v82, v82
  v_exp_f32 v83, v83
  v_mfma_f32_32x32x16_bf16 v[64:79], v[148:151], v[36:39], v[64:79]
  global_load_lds_dwordx4 v9, s[20:21] offset:2048
  global_load_lds_dwordx4 v10, s[20:21] offset:3072
  v_exp_f32 v84, v84
  v_exp_f32 v85, v85
  v_exp_f32 v86, v86
  v_exp_f32 v87, v87
  v_cvt_pk_bf16_f32 v104, v80, v81
  v_cvt_pk_bf16_f32 v105, v82, v83
  v_mfma_f32_32x32x16_bf16 v[208:223], v[136:139], v[96:99], v[208:223]
  s_add_u32 s20, s20, 114688
  v_exp_f32 v88, v88
  v_exp_f32 v89, v89
  v_exp_f32 v90, v90
  v_exp_f32 v91, v91
  v_cvt_pk_bf16_f32 v106, v84, v85
  v_cvt_pk_bf16_f32 v107, v86, v87
  v_mfma_f32_32x32x16_bf16 v[208:223], v[140:143], v[100:103], v[208:223]
  s_addc_u32 s21, s21, 0
  v_exp_f32 v92, v92
  v_exp_f32 v93, v93
  v_exp_f32 v94, v94
  v_exp_f32 v95, v95
  v_cvt_pk_bf16_f32 v108, v88, v89
  v_cvt_pk_bf16_f32 v109, v90, v91
  v_cvt_pk_bf16_f32 v110, v92, v93
  v_cvt_pk_bf16_f32 v111, v94, v95
  v_mfma_f32_32x32x16_bf16 v[80:95], v[144:147], v[40:43], 0
  s_waitcnt vmcnt(17) lgkmcnt(0)
  ds_read_b64_tr_b16 a[32:33], v11 offset:8192
  v_exp_f32 v64, v64
  v_exp_f32 v65, v65
  v_exp_f32 v66, v66
  v_exp_f32 v67, v67
  v_mfma_f32_32x32x16_bf16 v[80:95], v[148:151], v[44:47], v[80:95]
  s_add_u32 m0, s62, 4096
  ds_read_b64_tr_b16 a[34:35], v11 offset:9216
  v_exp_f32 v68, v68
  v_exp_f32 v69, v69
  v_exp_f32 v70, v70
  v_exp_f32 v71, v71
  v_cvt_pk_bf16_f32 v96, v64, v65
  v_cvt_pk_bf16_f32 v97, v66, v67
  v_mfma_f32_32x32x16_bf16 v[224:239], v[136:139], v[104:107], v[224:239]
  s_add_u32 s24, s24, s61
  ds_read_b64_tr_b16 a[36:37], v12 offset:8192
  v_exp_f32 v72, v72
  v_exp_f32 v73, v73
  v_exp_f32 v74, v74
  v_exp_f32 v75, v75
  v_cvt_pk_bf16_f32 v98, v68, v69
  v_cvt_pk_bf16_f32 v99, v70, v71
  v_mfma_f32_32x32x16_bf16 v[224:239], v[140:143], v[108:111], v[224:239]
  s_addc_u32 s25, s25, 0
  ds_read_b64_tr_b16 a[38:39], v12 offset:9216
  v_exp_f32 v76, v76
  v_exp_f32 v77, v77
  v_exp_f32 v78, v78
  v_exp_f32 v79, v79
  v_cvt_pk_bf16_f32 v100, v72, v73
  v_cvt_pk_bf16_f32 v101, v74, v75
  v_cvt_pk_bf16_f32 v102, v76, v77
  v_cvt_pk_bf16_f32 v103, v78, v79
  v_mfma_f32_32x32x16_bf16 v[64:79], v[144:147], v[48:51], 0
  s_add_u32 s52, s52, 16384
  global_load_lds_dwordx4 v3, s[24:25] offset:0
  global_load_lds_dwordx4 v4, s[24:25] offset:1024
  v_exp_f32 v80, v80
  v_exp_f32 v81, v81
  v_exp_f32 v82, v82
  v_exp_f32 v83, v83
  v_mfma_f32_32x32x16_bf16 v[64:79], v[148:151], v[52:55], v[64:79]
  s_and_b32 s52, s52, 262143
  global_load_lds_dwordx4 v5, s[24:25] offset:2048
  global_load_lds_dwordx4 v6, s[24:25] offset:3072
  v_exp_f32 v84, v84
  v_exp_f32 v85, v85
  v_exp_f32 v86, v86
  v_exp_f32 v87, v87
  v_cvt_pk_bf16_f32 v104, v80, v81
  v_cvt_pk_bf16_f32 v105, v82, v83
  v_mfma_f32_32x32x16_bf16 v[176:191], v[152:155], v[96:99], v[176:191]
  s_add_u32 s12, s14, s52
  ds_read_b64_tr_b16 a[88:89], v11 offset:10240
  v_exp_f32 v88, v88
  v_exp_f32 v89, v89
  v_exp_f32 v90, v90
  v_exp_f32 v91, v91
  v_cvt_pk_bf16_f32 v106, v84, v85
  v_cvt_pk_bf16_f32 v107, v86, v87
  v_mfma_f32_32x32x16_bf16 v[176:191], v[156:159], v[100:103], v[176:191]
  s_addc_u32 s13, s15, 0
  ds_read_b64_tr_b16 a[90:91], v11 offset:11264
  v_exp_f32 v92, v92
  v_exp_f32 v93, v93
  v_exp_f32 v94, v94
  v_exp_f32 v95, v95
  v_cvt_pk_bf16_f32 v108, v88, v89
  v_cvt_pk_bf16_f32 v109, v90, v91
  v_cvt_pk_bf16_f32 v110, v92, v93
  v_cvt_pk_bf16_f32 v111, v94, v95
  v_mfma_f32_32x32x16_bf16 v[80:95], v[144:147], v[56:59], 0
  global_load_dwordx4 v[128:131], v2, s[12:13] offset:0 sc1
  global_load_dwordx4 v[132:135], v2, s[12:13] offset:1024 sc1
  v_exp_f32 v64, v64
  v_exp_f32 v65, v65
  v_exp_f32 v66, v66
  v_exp_f32 v67, v67
  v_mfma_f32_32x32x16_bf16 v[80:95], v[148:151], v[60:63], v[80:95]
  global_load_dwordx4 v[136:139], v2, s[12:13] offset:2048 sc1
  global_load_dwordx4 v[140:143], v2, s[12:13] offset:3072 sc1
  v_exp_f32 v68, v68
  v_exp_f32 v69, v69
  v_exp_f32 v70, v70
  v_exp_f32 v71, v71
  v_cvt_pk_bf16_f32 v96, v64, v65
  v_cvt_pk_bf16_f32 v97, v66, v67
  v_mfma_f32_32x32x16_bf16 v[192:207], v[152:155], v[104:107], v[192:207]
  ds_read_b64_tr_b16 a[92:93], v12 offset:10240
  v_exp_f32 v72, v72
  v_exp_f32 v73, v73
  v_exp_f32 v74, v74
  v_exp_f32 v75, v75
  v_cvt_pk_bf16_f32 v98, v68, v69
  v_cvt_pk_bf16_f32 v99, v70, v71
  v_mfma_f32_32x32x16_bf16 v[192:207], v[156:159], v[108:111], v[192:207]
  s_waitcnt vmcnt(21)
  ds_read_b64_tr_b16 a[94:95], v12 offset:11264
  v_exp_f32 v76, v76
  v_exp_f32 v77, v77
  v_exp_f32 v78, v78
  v_exp_f32 v79, v79
  v_cvt_pk_bf16_f32 v100, v72, v73
  v_cvt_pk_bf16_f32 v101, v74, v75
  v_cvt_pk_bf16_f32 v102, v76, v77
  v_cvt_pk_bf16_f32 v103, v78, v79
  v_mfma_f32_32x32x16_bf16 v[64:79], v[160:163], v[32:35], 0
  v_exp_f32 v80, v80
  v_exp_f32 v81, v81
  v_exp_f32 v82, v82
  v_exp_f32 v83, v83
  v_mfma_f32_32x32x16_bf16 v[64:79], v[164:167], v[36:39], v[64:79]
  v_exp_f32 v84, v84
  v_exp_f32 v85, v85
  v_exp_f32 v86, v86
  v_exp_f32 v87, v87
  v_cvt_pk_bf16_f32 v104, v80, v81
  v_cvt_pk_bf16_f32 v105, v82, v83
  v_mfma_f32_32x32x16_bf16 v[208:223], v[152:155], v[96:99], v[208:223]
  v_exp_f32 v88, v88
  v_exp_f32 v89, v89
  v_exp_f32 v90, v90
  v_exp_f32 v91, v91
  v_cvt_pk_bf16_f32 v106, v84, v85
  v_cvt_pk_bf16_f32 v107, v86, v87
  v_mfma_f32_32x32x16_bf16 v[208:223], v[156:159], v[100:103], v[208:223]
  v_exp_f32 v92, v92
  v_exp_f32 v93, v93
  v_exp_f32 v94, v94
  v_exp_f32 v95, v95
  v_cvt_pk_bf16_f32 v108, v88, v89
  v_cvt_pk_bf16_f32 v109, v90, v91
  v_cvt_pk_bf16_f32 v110, v92, v93
  v_cvt_pk_bf16_f32 v111, v94, v95
  v_mfma_f32_32x32x16_bf16 v[80:95], v[160:163], v[40:43], 0
  s_waitcnt vmcnt(17) lgkmcnt(0)
  ds_read_b64_tr_b16 a[40:41], v11 offset:0
  v_exp_f32 v64, v64
  v_exp_f32 v65, v65
  v_exp_f32 v66, v66
  v_exp_f32 v67, v67
  v_mfma_f32_32x32x16_bf16 v[80:95], v[164:167], v[44:47], v[80:95]
  s_add_u32 m0, s62, 8192
  ds_read_b64_tr_b16 a[42:43], v11 offset:1024
  v_exp_f32 v68, v68
  v_exp_f32 v69, v69
  v_exp_f32 v70, v70
  v_exp_f32 v71, v71
  v_cvt_pk_bf16_f32 v96, v64, v65
  v_cvt_pk_bf16_f32 v97, v66, v67
  v_mfma_f32_32x32x16_bf16 v[224:239], v[152:155], v[104:107], v[224:239]
  s_sub_u32 s24, s24, 286720
  ds_read_b64_tr_b16 a[44:45], v12 offset:0
  v_exp_f32 v72, v72
  v_exp_f32 v73, v73
  v_exp_f32 v74, v74
  v_exp_f32 v75, v75
  v_cvt_pk_bf16_f32 v98, v68, v69
  v_cvt_pk_bf16_f32 v99, v70, v71
  v_mfma_f32_32x32x16_bf16 v[224:239], v[156:159], v[108:111], v[224:239]
  s_subb_u32 s25, s25, 0
  ds_read_b64_tr_b16 a[46:47], v12 offset:1024
  v_exp_f32 v76, v76
  v_exp_f32 v77, v77
  v_exp_f32 v78, v78
  v_exp_f32 v79, v79
  v_cvt_pk_bf16_f32 v100, v72, v73
  v_cvt_pk_bf16_f32 v101, v74, v75
  v_cvt_pk_bf16_f32 v102, v76, v77
  v_cvt_pk_bf16_f32 v103, v78, v79
  v_mfma_f32_32x32x16_bf16 v[64:79], v[160:163], v[48:51], 0
  s_add_u32 s52, s52, 16384
  global_load_lds_dwordx4 v3, s[24:25] offset:0
  global_load_lds_dwordx4 v4, s[24:25] offset:1024
  v_exp_f32 v80, v80
  v_exp_f32 v81, v81
  v_exp_f32 v82, v82
  v_exp_f32 v83, v83
  v_mfma_f32_32x32x16_bf16 v[64:79], v[164:167], v[52:55], v[64:79]
  s_and_b32 s52, s52, 262143
  global_load_lds_dwordx4 v5, s[24:25] offset:2048
  global_load_lds_dwordx4 v6, s[24:25] offset:3072
  v_exp_f32 v84, v84
  v_exp_f32 v85, v85
  v_exp_f32 v86, v86
  v_exp_f32 v87, v87
  v_cvt_pk_bf16_f32 v104, v80, v81
  v_cvt_pk_bf16_f32 v105, v82, v83
  v_mfma_f32_32x32x16_bf16 v[176:191], v[168:171], v[96:99], v[176:191]
  s_add_u32 s12, s14, s52
  ds_read_b64_tr_b16 a[96:97], v11 offset:2048
  v_exp_f32 v88, v88
  v_exp_f32 v89, v89
  v_exp_f32 v90, v90
  v_exp_f32 v91, v91
  v_cvt_pk_bf16_f32 v106, v84, v85
  v_cvt_pk_bf16_f32 v107, v86, v87
  v_mfma_f32_32x32x16_bf16 v[176:191], v[172:175], v[100:103], v[176:191]
  s_addc_u32 s13, s15, 0
  ds_read_b64_tr_b16 a[98:99], v11 offset:3072
  v_exp_f32 v92, v92
  v_exp_f32 v93, v93
  v_exp_f32 v94, v94
  v_exp_f32 v95, v95
  v_cvt_pk_bf16_f32 v108, v88, v89
  v_cvt_pk_bf16_f32 v109, v90, v91
  v_cvt_pk_bf16_f32 v110, v92, v93
  v_cvt_pk_bf16_f32 v111, v94, v95
  v_mfma_f32_32x32x16_bf16 v[80:95], v[160:163], v[56:59], 0
  global_load_dwordx4 v[144:147], v2, s[12:13] offset:0 sc1
  global_load_dwordx4 v[148:151], v2, s[12:13] offset:1024 sc1
  v_exp_f32 v64, v64
  v_exp_f32 v65, v65
  v_exp_f32 v66, v66
  v_exp_f32 v67, v67
  v_mfma_f32_32x32x16_bf16 v[80:95], v[164:167], v[60:63], v[80:95]
  global_load_dwordx4 v[152:155], v2, s[12:13] offset:2048 sc1
  global_load_dwordx4 v[156:159], v2, s[12:13] offset:3072 sc1
  v_exp_f32 v68, v68
  v_exp_f32 v69, v69
  v_exp_f32 v70, v70
  v_exp_f32 v71, v71
  v_cvt_pk_bf16_f32 v96, v64, v65
  v_cvt_pk_bf16_f32 v97, v66, v67
  v_mfma_f32_32x32x16_bf16 v[192:207], v[168:171], v[104:107], v[192:207]
  s_add_u32 m0, s47, 20480
  ds_read_b64_tr_b16 a[100:101], v12 offset:2048
  v_exp_f32 v72, v72
  v_exp_f32 v73, v73
  v_exp_f32 v74, v74
  v_exp_f32 v75, v75
  v_cvt_pk_bf16_f32 v98, v68, v69
  v_cvt_pk_bf16_f32 v99, v70, v71
  v_mfma_f32_32x32x16_bf16 v[192:207], v[172:175], v[108:111], v[192:207]
  s_waitcnt vmcnt(21)
  ds_read_b64_tr_b16 a[102:103], v12 offset:3072
  v_exp_f32 v76, v76
  v_exp_f32 v77, v77
  v_exp_f32 v78, v78
  v_exp_f32 v79, v79
  v_cvt_pk_bf16_f32 v100, v72, v73
  v_cvt_pk_bf16_f32 v101, v74, v75
  v_cvt_pk_bf16_f32 v102, v76, v77
  v_cvt_pk_bf16_f32 v103, v78, v79
  v_mfma_f32_32x32x16_bf16 v[64:79], v[112:115], v[32:35], 0
  global_load_lds_dwordx4 v7, s[20:21] offset:0
  global_load_lds_dwordx4 v8, s[20:21] offset:1024
  v_exp_f32 v80, v80
  v_exp_f32 v81, v81
  v_exp_f32 v82, v82
  v_exp_f32 v83, v83
  v_mfma_f32_32x32x16_bf16 v[64:79], v[116:119], v[36:39], v[64:79]
  global_load_lds_dwordx4 v9, s[20:21] offset:2048
  global_load_lds_dwordx4 v10, s[20:21] offset:3072
  v_exp_f32 v84, v84
  v_exp_f32 v85, v85
  v_exp_f32 v86, v86
  v_exp_f32 v87, v87
  v_cvt_pk_bf16_f32 v104, v80, v81
  v_cvt_pk_bf16_f32 v105, v82, v83
  v_mfma_f32_32x32x16_bf16 v[208:223], v[168:171], v[96:99], v[208:223]
  s_add_u32 s20, s20, 114688
  v_exp_f32 v88, v88
  v_exp_f32 v89, v89
  v_exp_f32 v90, v90
  v_exp_f32 v91, v91
  v_cvt_pk_bf16_f32 v106, v84, v85
  v_cvt_pk_bf16_f32 v107, v86, v87
  v_mfma_f32_32x32x16_bf16 v[208:223], v[172:175], v[100:103], v[208:223]
  s_addc_u32 s21, s21, 0
  v_exp_f32 v92, v92
  v_exp_f32 v93, v93
  v_exp_f32 v94, v94
  v_exp_f32 v95, v95
  v_cvt_pk_bf16_f32 v108, v88, v89
  v_cvt_pk_bf16_f32 v109, v90, v91
  v_cvt_pk_bf16_f32 v110, v92, v93
  v_cvt_pk_bf16_f32 v111, v94, v95
  v_mfma_f32_32x32x16_bf16 v[80:95], v[112:115], v[40:43], 0
  s_waitcnt vmcnt(16) lgkmcnt(0)
  ds_read_b64_tr_b16 a[48:49], v11 offset:4096
  v_exp_f32 v64, v64
  v_exp_f32 v65, v65
  v_exp_f32 v66, v66
  v_exp_f32 v67, v67
  v_mfma_f32_32x32x16_bf16 v[80:95], v[116:119], v[44:47], v[80:95]
  s_add_u32 m0, s62, 0
  ds_read_b64_tr_b16 a[50:51], v11 offset:5120
  v_exp_f32 v68, v68
  v_exp_f32 v69, v69
  v_exp_f32 v70, v70
  v_exp_f32 v71, v71
  v_cvt_pk_bf16_f32 v96, v64, v65
  v_cvt_pk_bf16_f32 v97, v66, v67
  v_mfma_f32_32x32x16_bf16 v[224:239], v[168:171], v[104:107], v[224:239]
  s_add_u32 s24, s24, s60
  ds_read_b64_tr_b16 a[52:53], v12 offset:4096
  v_exp_f32 v72, v72
  v_exp_f32 v73, v73
  v_exp_f32 v74, v74
  v_exp_f32 v75, v75
  v_cvt_pk_bf16_f32 v98, v68, v69
  v_cvt_pk_bf16_f32 v99, v70, v71
  v_mfma_f32_32x32x16_bf16 v[224:239], v[172:175], v[108:111], v[224:239]
  s_addc_u32 s25, s25, 0
  ds_read_b64_tr_b16 a[54:55], v12 offset:5120
  v_exp_f32 v76, v76
  v_exp_f32 v77, v77
  v_exp_f32 v78, v78
  v_exp_f32 v79, v79
  v_cvt_pk_bf16_f32 v100, v72, v73
  v_cvt_pk_bf16_f32 v101, v74, v75
  v_cvt_pk_bf16_f32 v102, v76, v77
  v_cvt_pk_bf16_f32 v103, v78, v79
  v_mfma_f32_32x32x16_bf16 v[64:79], v[112:115], v[48:51], 0
  s_add_u32 s52, s52, 16384
  global_load_lds_dwordx4 v3, s[24:25] offset:0
  global_load_lds_dwordx4 v4, s[24:25] offset:1024
  v_exp_f32 v80, v80
  v_exp_f32 v81, v81
  v_exp_f32 v82, v82
  v_exp_f32 v83, v83
  v_mfma_f32_32x32x16_bf16 v[64:79], v[116:119], v[52:55], v[64:79]
  s_and_b32 s52, s52, 262143
  global_load_lds_dwordx4 v5, s[24:25] offset:2048
  global_load_lds_dwordx4 v6, s[24:25] offset:3072
  v_exp_f32 v84, v84
  v_exp_f32 v85, v85
  v_exp_f32 v86, v86
  v_exp_f32 v87, v87
  v_cvt_pk_bf16_f32 v104, v80, v81
  v_cvt_pk_bf16_f32 v105, v82, v83
  v_mfma_f32_32x32x16_bf16 v[176:191], v[120:123], v[96:99], v[176:191]
  s_add_u32 s12, s14, s52
  ds_read_b64_tr_b16 a[104:105], v11 offset:6144
  v_exp_f32 v88, v88
  v_exp_f32 v89, v89
  v_exp_f32 v90, v90
  v_exp_f32 v91, v91
  v_cvt_pk_bf16_f32 v106, v84, v85
  v_cvt_pk_bf16_f32 v107, v86, v87
  v_mfma_f32_32x32x16_bf16 v[176:191], v[124:127], v[100:103], v[176:191]
  s_addc_u32 s13, s15, 0
  ds_read_b64_tr_b16 a[106:107], v11 offset:7168
  v_exp_f32 v92, v92
  v_exp_f32 v93, v93
  v_exp_f32 v94, v94
  v_exp_f32 v95, v95
  v_cvt_pk_bf16_f32 v108, v88, v89
  v_cvt_pk_bf16_f32 v109, v90, v91
  v_cvt_pk_bf16_f32 v110, v92, v93
  v_cvt_pk_bf16_f32 v111, v94, v95
  v_mfma_f32_32x32x16_bf16 v[80:95], v[112:115], v[56:59], 0
  global_load_dwordx4 v[160:163], v2, s[12:13] offset:0 sc1
  global_load_dwordx4 v[164:167], v2, s[12:13] offset:1024 sc1
  v_exp_f32 v64, v64
  v_exp_f32 v65, v65
  v_exp_f32 v66, v66
  v_exp_f32 v67, v67
  v_mfma_f32_32x32x16_bf16 v[80:95], v[116:119], v[60:63], v[80:95]
  global_load_dwordx4 v[168:171], v2, s[12:13] offset:2048 sc1
  global_load_dwordx4 v[172:175], v2, s[12:13] offset:3072 sc1
  v_exp_f32 v68, v68
  v_exp_f32 v69, v69
  v_exp_f32 v70, v70
  v_exp_f32 v71, v71
  v_cvt_pk_bf16_f32 v96, v64, v65
  v_cvt_pk_bf16_f32 v97, v66, v67
  v_mfma_f32_32x32x16_bf16 v[192:207], v[120:123], v[104:107], v[192:207]
  v_and_b32 v16, 0xffff0000, v241
  v_lshlrev_b32 v18, 16, v241
  ds_read_b64_tr_b16 a[108:109], v12 offset:6144
  v_exp_f32 v72, v72
  v_exp_f32 v73, v73
  v_exp_f32 v74, v74
  v_exp_f32 v75, v75
  v_cvt_pk_bf16_f32 v98, v68, v69
  v_cvt_pk_bf16_f32 v99, v70, v71
  v_mfma_f32_32x32x16_bf16 v[192:207], v[124:127], v[108:111], v[192:207]
  s_waitcnt vmcnt(20)
  ds_read_b64_tr_b16 a[110:111], v12 offset:7168
  v_exp_f32 v76, v76
  v_exp_f32 v77, v77
  v_exp_f32 v78, v78
  v_exp_f32 v79, v79
  v_cvt_pk_bf16_f32 v100, v72, v73
  v_cvt_pk_bf16_f32 v101, v74, v75
  v_cvt_pk_bf16_f32 v102, v76, v77
  v_cvt_pk_bf16_f32 v103, v78, v79
  v_mfma_f32_32x32x16_bf16 v[64:79], v[128:131], v[32:35], 0
  v_exp_f32 v80, v80
  v_exp_f32 v81, v81
  v_exp_f32 v82, v82
  v_exp_f32 v83, v83
  v_mfma_f32_32x32x16_bf16 v[64:79], v[132:135], v[36:39], v[64:79]
  v_exp_f32 v84, v84
  v_exp_f32 v85, v85
  v_exp_f32 v86, v86
  v_exp_f32 v87, v87
  v_cvt_pk_bf16_f32 v104, v80, v81
  v_cvt_pk_bf16_f32 v105, v82, v83
  v_mfma_f32_32x32x16_bf16 v[208:223], v[120:123], v[96:99], v[208:223]
  v_exp_f32 v88, v88
  v_exp_f32 v89, v89
  v_exp_f32 v90, v90
  v_exp_f32 v91, v91
  v_cvt_pk_bf16_f32 v106, v84, v85
  v_cvt_pk_bf16_f32 v107, v86, v87
  v_mfma_f32_32x32x16_bf16 v[208:223], v[124:127], v[100:103], v[208:223]
  v_mov_b32 v17, 0x45c80000
  v_exp_f32 v92, v92
  v_exp_f32 v93, v93
  v_exp_f32 v94, v94
  v_exp_f32 v95, v95
  v_cvt_pk_bf16_f32 v108, v88, v89
  v_cvt_pk_bf16_f32 v109, v90, v91
  v_cvt_pk_bf16_f32 v110, v92, v93
  v_cvt_pk_bf16_f32 v111, v94, v95
  v_mfma_f32_32x32x16_bf16 v[80:95], v[128:131], v[40:43], 0
  s_waitcnt vmcnt(16) lgkmcnt(0)
  v_readlane_b32 s4, v18, 16
  v_readlane_b32 s5, v18, 17
  ds_read_b64_tr_b16 a[112:113], v11 offset:8192
  v_exp_f32 v64, v64
  v_exp_f32 v65, v65
  v_exp_f32 v66, v66
  v_exp_f32 v67, v67
  v_mfma_f32_32x32x16_bf16 v[80:95], v[132:135], v[44:47], v[80:95]
  s_add_u32 m0, s62, 4096
  v_readlane_b32 s6, v18, 18
  s_max_u32 s4, s4, s5
  v_readlane_b32 s5, v18, 19
  ds_read_b64_tr_b16 a[114:115], v11 offset:9216
  v_exp_f32 v68, v68
  v_exp_f32 v69, v69
  v_exp_f32 v70, v70
  v_exp_f32 v71, v71
  v_cvt_pk_bf16_f32 v96, v64, v65
  v_cvt_pk_bf16_f32 v97, v66, v67
  v_mfma_f32_32x32x16_bf16 v[224:239], v[120:123], v[104:107], v[224:239]
  s_add_u32 s24, s24, s61
  s_addc_u32 s25, s25, 0
  s_max_u32 s4, s4, s6
  s_max_u32 s4, s4, s5
  ds_read_b64_tr_b16 a[116:117], v12 offset:8192
  v_exp_f32 v72, v72
  v_exp_f32 v73, v73
  v_exp_f32 v74, v74
  v_exp_f32 v75, v75
  v_cvt_pk_bf16_f32 v98, v68, v69
  v_cvt_pk_bf16_f32 v99, v70, v71
  v_mfma_f32_32x32x16_bf16 v[224:239], v[124:127], v[108:111], v[224:239]
  v_mul_f32 v16, s4, v16
  ds_read_b64_tr_b16 a[118:119], v12 offset:9216
  v_exp_f32 v76, v76
  v_exp_f32 v77, v77
  v_exp_f32 v78, v78
  v_exp_f32 v79, v79
  v_cvt_pk_bf16_f32 v100, v72, v73
  v_cvt_pk_bf16_f32 v101, v74, v75
  v_cvt_pk_bf16_f32 v102, v76, v77
  v_cvt_pk_bf16_f32 v103, v78, v79
  v_mfma_f32_32x32x16_bf16 v[64:79], v[128:131], v[48:51], 0
  global_load_lds_dwordx4 v3, s[24:25] offset:0
  global_load_lds_dwordx4 v4, s[24:25] offset:1024
  v_cmp_ge_f32 vcc, v17, v16
  v_exp_f32 v80, v80
  v_exp_f32 v81, v81
  v_exp_f32 v82, v82
  v_exp_f32 v83, v83
  v_mfma_f32_32x32x16_bf16 v[64:79], v[132:135], v[52:55], v[64:79]
  global_load_lds_dwordx4 v5, s[24:25] offset:2048
  global_load_lds_dwordx4 v6, s[24:25] offset:3072
  s_andn2_b32 s45, 0xffff, vcc_lo
  v_exp_f32 v84, v84
  v_exp_f32 v85, v85
  v_exp_f32 v86, v86
  v_exp_f32 v87, v87
  v_cvt_pk_bf16_f32 v104, v80, v81
  v_cvt_pk_bf16_f32 v105, v82, v83
  v_mfma_f32_32x32x16_bf16 v[176:191], v[136:139], v[96:99], v[176:191]
  global_load_dwordx2 v[240:241], v13, s[8:9] offset:0
  ds_read_b64_tr_b16 a[168:169], v11 offset:10240
  v_exp_f32 v88, v88
  v_exp_f32 v89, v89
  v_exp_f32 v90, v90
  v_exp_f32 v91, v91
  v_cvt_pk_bf16_f32 v106, v84, v85
  v_cvt_pk_bf16_f32 v107, v86, v87
  v_mfma_f32_32x32x16_bf16 v[176:191], v[140:143], v[100:103], v[176:191]
  global_load_dwordx2 v[242:243], v13, s[8:9] offset:16
  ds_read_b64_tr_b16 a[170:171], v11 offset:11264
  v_exp_f32 v92, v92
  v_exp_f32 v93, v93
  v_exp_f32 v94, v94
  v_exp_f32 v95, v95
  v_cvt_pk_bf16_f32 v108, v88, v89
  v_cvt_pk_bf16_f32 v109, v90, v91
  v_cvt_pk_bf16_f32 v110, v92, v93
  v_cvt_pk_bf16_f32 v111, v94, v95
  v_mfma_f32_32x32x16_bf16 v[80:95], v[128:131], v[56:59], 0
  global_load_dwordx2 v[244:245], v13, s[8:9] offset:32
  v_exp_f32 v64, v64
  v_exp_f32 v65, v65
  v_exp_f32 v66, v66
  v_exp_f32 v67, v67
  v_mfma_f32_32x32x16_bf16 v[80:95], v[132:135], v[60:63], v[80:95]
  global_load_dwordx2 v[246:247], v13, s[8:9] offset:48
  v_exp_f32 v68, v68
  v_exp_f32 v69, v69
  v_exp_f32 v70, v70
  v_exp_f32 v71, v71
  v_cvt_pk_bf16_f32 v96, v64, v65
  v_cvt_pk_bf16_f32 v97, v66, v67
  v_mfma_f32_32x32x16_bf16 v[192:207], v[136:139], v[104:107], v[192:207]
  s_add_u32 m0, s47, 24576
  ds_read_b64_tr_b16 a[172:173], v12 offset:10240
  v_exp_f32 v72, v72
  v_exp_f32 v73, v73
  v_exp_f32 v74, v74
  v_exp_f32 v75, v75
  v_cvt_pk_bf16_f32 v98, v68, v69
  v_cvt_pk_bf16_f32 v99, v70, v71
  v_mfma_f32_32x32x16_bf16 v[192:207], v[140:143], v[108:111], v[192:207]
  s_waitcnt vmcnt(20)
  ds_read_b64_tr_b16 a[174:175], v12 offset:11264
  v_exp_f32 v76, v76
  v_exp_f32 v77, v77
  v_exp_f32 v78, v78
  v_exp_f32 v79, v79
  v_cvt_pk_bf16_f32 v100, v72, v73
  v_cvt_pk_bf16_f32 v101, v74, v75
  v_cvt_pk_bf16_f32 v102, v76, v77
  v_cvt_pk_bf16_f32 v103, v78, v79
  v_mfma_f32_32x32x16_bf16 v[64:79], v[144:147], v[32:35], 0
  global_load_lds_dwordx4 v7, s[20:21] offset:0
  global_load_lds_dwordx4 v8, s[20:21] offset:1024
  v_exp_f32 v80, v80
  v_exp_f32 v81, v81
  v_exp_f32 v82, v82
  v_exp_f32 v83, v83
  v_mfma_f32_32x32x16_bf16 v[64:79], v[148:151], v[36:39], v[64:79]
  global_load_lds_dwordx4 v9, s[20:21] offset:2048
  global_load_lds_dwordx4 v10, s[20:21] offset:3072
  v_exp_f32 v84, v84
  v_exp_f32 v85, v85
  v_exp_f32 v86, v86
  v_exp_f32 v87, v87
  v_cvt_pk_bf16_f32 v104, v80, v81
  v_cvt_pk_bf16_f32 v105, v82, v83
  v_mfma_f32_32x32x16_bf16 v[208:223], v[136:139], v[96:99], v[208:223]
  v_exp_f32 v88, v88
  v_exp_f32 v89, v89
  v_exp_f32 v90, v90
  v_exp_f32 v91, v91
  v_cvt_pk_bf16_f32 v106, v84, v85
  v_cvt_pk_bf16_f32 v107, v86, v87
  v_mfma_f32_32x32x16_bf16 v[208:223], v[140:143], v[100:103], v[208:223]
  v_exp_f32 v92, v92
  v_exp_f32 v93, v93
  v_exp_f32 v94, v94
  v_exp_f32 v95, v95
  v_cvt_pk_bf16_f32 v108, v88, v89
  v_cvt_pk_bf16_f32 v109, v90, v91
  v_cvt_pk_bf16_f32 v110, v92, v93
  v_cvt_pk_bf16_f32 v111, v94, v95
  v_mfma_f32_32x32x16_bf16 v[80:95], v[144:147], v[40:43], 0
  s_waitcnt vmcnt(16) lgkmcnt(0)
  ds_read_b64_tr_b16 a[120:121], v11 offset:0
  v_exp_f32 v64, v64
  v_exp_f32 v65, v65
  v_exp_f32 v66, v66
  v_exp_f32 v67, v67
  v_mfma_f32_32x32x16_bf16 v[80:95], v[148:151], v[44:47], v[80:95]
  ds_read_b64_tr_b16 a[122:123], v11 offset:1024
  v_exp_f32 v68, v68
  v_exp_f32 v69, v69
  v_exp_f32 v70, v70
  v_exp_f32 v71, v71
  v_cvt_pk_bf16_f32 v96, v64, v65
  v_cvt_pk_bf16_f32 v97, v66, v67
  v_mfma_f32_32x32x16_bf16 v[224:239], v[136:139], v[104:107], v[224:239]
  ds_read_b64_tr_b16 a[124:125], v12 offset:0
  v_exp_f32 v72, v72
  v_exp_f32 v73, v73
  v_exp_f32 v74, v74
  v_exp_f32 v75, v75
  v_cvt_pk_bf16_f32 v98, v68, v69
  v_cvt_pk_bf16_f32 v99, v70, v71
  v_mfma_f32_32x32x16_bf16 v[224:239], v[140:143], v[108:111], v[224:239]
  ds_read_b64_tr_b16 a[126:127], v12 offset:1024
  v_exp_f32 v76, v76
  v_exp_f32 v77, v77
  v_exp_f32 v78, v78
  v_exp_f32 v79, v79
  v_cvt_pk_bf16_f32 v100, v72, v73
  v_cvt_pk_bf16_f32 v101, v74, v75
  v_cvt_pk_bf16_f32 v102, v76, v77
  v_cvt_pk_bf16_f32 v103, v78, v79
  v_mfma_f32_32x32x16_bf16 v[64:79], v[144:147], v[48:51], 0
  global_load_dwordx2 v[248:249], v14, s[40:41] offset:0
  v_exp_f32 v80, v80
  v_exp_f32 v81, v81
  v_exp_f32 v82, v82
  v_exp_f32 v83, v83
  v_mfma_f32_32x32x16_bf16 v[64:79], v[148:151], v[52:55], v[64:79]
  global_load_dwordx2 v[250:251], v14, s[40:41] offset:16
  v_exp_f32 v84, v84
  v_exp_f32 v85, v85
  v_exp_f32 v86, v86
  v_exp_f32 v87, v87
  v_cvt_pk_bf16_f32 v104, v80, v81
  v_cvt_pk_bf16_f32 v105, v82, v83
  v_mfma_f32_32x32x16_bf16 v[176:191], v[152:155], v[96:99], v[176:191]
  global_load_dwordx2 v[252:253], v14, s[40:41] offset:32
  ds_read_b64_tr_b16 a[176:177], v11 offset:2048
  v_exp_f32 v88, v88
  v_exp_f32 v89, v89
  v_exp_f32 v90, v90
  v_exp_f32 v91, v91
  v_cvt_pk_bf16_f32 v106, v84, v85
  v_cvt_pk_bf16_f32 v107, v86, v87
  v_mfma_f32_32x32x16_bf16 v[176:191], v[156:159], v[100:103], v[176:191]
  global_load_dwordx2 v[254:255], v14, s[40:41] offset:48
  ds_read_b64_tr_b16 a[178:179], v11 offset:3072
  v_exp_f32 v92, v92
  v_exp_f32 v93, v93
  v_exp_f32 v94, v94
  v_exp_f32 v95, v95
  v_cvt_pk_bf16_f32 v108, v88, v89
  v_cvt_pk_bf16_f32 v109, v90, v91
  v_cvt_pk_bf16_f32 v110, v92, v93
  v_cvt_pk_bf16_f32 v111, v94, v95
  v_mfma_f32_32x32x16_bf16 v[80:95], v[144:147], v[56:59], 0
  v_exp_f32 v64, v64
  v_exp_f32 v65, v65
  v_exp_f32 v66, v66
  v_exp_f32 v67, v67
  v_mfma_f32_32x32x16_bf16 v[80:95], v[148:151], v[60:63], v[80:95]
  v_and_b32 v20, 31, v0
  v_exp_f32 v68, v68
  v_exp_f32 v69, v69
  v_exp_f32 v70, v70
  v_exp_f32 v71, v71
  v_cvt_pk_bf16_f32 v96, v64, v65
  v_cvt_pk_bf16_f32 v97, v66, v67
  v_mfma_f32_32x32x16_bf16 v[192:207], v[152:155], v[104:107], v[192:207]
  ds_read_b64_tr_b16 a[180:181], v12 offset:2048
  v_exp_f32 v72, v72
  v_exp_f32 v73, v73
  v_exp_f32 v74, v74
  v_exp_f32 v75, v75
  v_cvt_pk_bf16_f32 v98, v68, v69
  v_cvt_pk_bf16_f32 v99, v70, v71
  v_mfma_f32_32x32x16_bf16 v[192:207], v[156:159], v[108:111], v[192:207]
  s_waitcnt vmcnt(16)
  ds_read_b64_tr_b16 a[182:183], v12 offset:3072
  v_exp_f32 v76, v76
  v_exp_f32 v77, v77
  v_exp_f32 v78, v78
  v_exp_f32 v79, v79
  v_cvt_pk_bf16_f32 v100, v72, v73
  v_cvt_pk_bf16_f32 v101, v74, v75
  v_cvt_pk_bf16_f32 v102, v76, v77
  v_cvt_pk_bf16_f32 v103, v78, v79
  v_mfma_f32_32x32x16_bf16 v[64:79], v[160:163], v[32:35], 0
  s_cmp_lg_u32 s45, 0
  s_cbranch_scc1 L_poison
L_pret:
  v_lshlrev_b32 v20, 1, v20
  v_exp_f32 v80, v80
  v_exp_f32 v81, v81
  v_exp_f32 v82, v82
  v_exp_f32 v83, v83
  v_mfma_f32_32x32x16_bf16 v[64:79], v[164:167], v[36:39], v[64:79]
  global_load_ushort v20, v20, s[36:37]
  v_exp_f32 v84, v84
  v_exp_f32 v85, v85
  v_exp_f32 v86, v86
  v_exp_f32 v87, v87
  v_cvt_pk_bf16_f32 v104, v80, v81
  v_cvt_pk_bf16_f32 v105, v82, v83
  v_mfma_f32_32x32x16_bf16 v[208:223], v[152:155], v[96:99], v[208:223]
  buffer_load_dword v16, v26, s[28:31], 0 offen sc1
  v_exp_f32 v88, v88
  v_exp_f32 v89, v89
  v_exp_f32 v90, v90
  v_exp_f32 v91, v91
  v_cvt_pk_bf16_f32 v106, v84, v85
  v_cvt_pk_bf16_f32 v107, v86, v87
  v_mfma_f32_32x32x16_bf16 v[208:223], v[156:159], v[100:103], v[208:223]
  v_exp_f32 v92, v92
  v_exp_f32 v93, v93
  v_exp_f32 v94, v94
  v_exp_f32 v95, v95
  v_cvt_pk_bf16_f32 v108, v88, v89
  v_cvt_pk_bf16_f32 v109, v90, v91
  v_cvt_pk_bf16_f32 v110, v92, v93
  v_cvt_pk_bf16_f32 v111, v94, v95
  v_mfma_f32_32x32x16_bf16 v[80:95], v[160:163], v[40:43], 0
  s_waitcnt vmcnt(14) lgkmcnt(0)
  ds_read_b64_tr_b16 a[128:129], v11 offset:4096
  v_exp_f32 v64, v64
  v_exp_f32 v65, v65
  v_exp_f32 v66, v66
  v_exp_f32 v67, v67
  v_mfma_f32_32x32x16_bf16 v[80:95], v[164:167], v[44:47], v[80:95]
  ds_read_b64_tr_b16 a[130:131], v11 offset:5120
  v_exp_f32 v68, v68
  v_exp_f32 v69, v69
  v_exp_f32 v70, v70
  v_exp_f32 v71, v71
  v_cvt_pk_bf16_f32 v96, v64, v65
  v_cvt_pk_bf16_f32 v97, v66, v67
  v_mfma_f32_32x32x16_bf16 v[224:239], v[152:155], v[104:107], v[224:239]
  ds_read_b64_tr_b16 a[132:133], v12 offset:4096
  v_exp_f32 v72, v72
  v_exp_f32 v73, v73
  v_exp_f32 v74, v74
  v_exp_f32 v75, v75
  v_cvt_pk_bf16_f32 v98, v68, v69
  v_cvt_pk_bf16_f32 v99, v70, v71
  v_mfma_f32_32x32x16_bf16 v[224:239], v[156:159], v[108:111], v[224:239]
  ds_read_b64_tr_b16 a[134:135], v12 offset:5120
  v_exp_f32 v76, v76
  v_exp_f32 v77, v77
  v_exp_f32 v78, v78
  v_exp_f32 v79, v79
  v_cvt_pk_bf16_f32 v100, v72, v73
  v_cvt_pk_bf16_f32 v101, v74, v75
  v_cvt_pk_bf16_f32 v102, v76, v77
  v_cvt_pk_bf16_f32 v103, v78, v79
  v_mfma_f32_32x32x16_bf16 v[64:79], v[160:163], v[48:51], 0
  ds_read_b64_tr_b16 a[184:185], v11 offset:6144
  v_exp_f32 v80, v80
  v_exp_f32 v81, v81
  v_exp_f32 v82, v82
  v_exp_f32 v83, v83
  v_mfma_f32_32x32x16_bf16 v[64:79], v[164:167], v[52:55], v[64:79]
  ds_read_b64_tr_b16 a[186:187], v11 offset:7168
  v_exp_f32 v84, v84
  v_exp_f32 v85, v85
  v_exp_f32 v86, v86
  v_exp_f32 v87, v87
  v_cvt_pk_bf16_f32 v104, v80, v81
  v_cvt_pk_bf16_f32 v105, v82, v83
  v_mfma_f32_32x32x16_bf16 v[176:191], v[168:171], v[96:99], v[176:191]
  ds_read_b64_tr_b16 a[188:189], v12 offset:6144
  v_exp_f32 v88, v88
  v_exp_f32 v89, v89
  v_exp_f32 v90, v90
  v_exp_f32 v91, v91
  v_cvt_pk_bf16_f32 v106, v84, v85
  v_cvt_pk_bf16_f32 v107, v86, v87
  v_mfma_f32_32x32x16_bf16 v[176:191], v[172:175], v[100:103], v[176:191]
  ds_read_b64_tr_b16 a[190:191], v12 offset:7168
  v_exp_f32 v92, v92
  v_exp_f32 v93, v93
  v_exp_f32 v94, v94
  v_exp_f32 v95, v95
  v_cvt_pk_bf16_f32 v108, v88, v89
  v_cvt_pk_bf16_f32 v109, v90, v91
  v_cvt_pk_bf16_f32 v110, v92, v93
  v_cvt_pk_bf16_f32 v111, v94, v95
  v_mfma_f32_32x32x16_bf16 v[80:95], v[160:163], v[56:59], 0
  v_exp_f32 v64, v64
  v_exp_f32 v65, v65
  v_exp_f32 v66, v66
  v_exp_f32 v67, v67
  v_mfma_f32_32x32x16_bf16 v[80:95], v[164:167], v[60:63], v[80:95]
  ds_write_b128 v25, v[176:179] offset:0
  v_exp_f32 v68, v68
  v_exp_f32 v69, v69
  v_exp_f32 v70, v70
  v_exp_f32 v71, v71
  v_cvt_pk_bf16_f32 v96, v64, v65
  v_cvt_pk_bf16_f32 v97, v66, v67
  v_mfma_f32_32x32x16_bf16 v[192:207], v[168:171], v[104:107], v[192:207]
  ds_write_b128 v25, v[180:183] offset:1024
  v_exp_f32 v72, v72
  v_exp_f32 v73, v73
  v_exp_f32 v74, v74
  v_exp_f32 v75, v75
  v_cvt_pk_bf16_f32 v98, v68, v69
  v_cvt_pk_bf16_f32 v99, v70, v71
  v_mfma_f32_32x32x16_bf16 v[192:207], v[172:175], v[108:111], v[192:207]
  ds_write_b128 v25, v[184:187] offset:2048
  ds_write_b128 v25, v[188:191] offset:3072
  v_exp_f32 v76, v76
  v_exp_f32 v77, v77
  v_exp_f32 v78, v78
  v_exp_f32 v79, v79
  v_cvt_pk_bf16_f32 v100, v72, v73
  v_cvt_pk_bf16_f32 v101, v74, v75
  v_cvt_pk_bf16_f32 v102, v76, v77
  v_cvt_pk_bf16_f32 v103, v78, v79
  v_exp_f32 v80, v80
  v_exp_f32 v81, v81
  v_exp_f32 v82, v82
  v_exp_f32 v83, v83
  v_exp_f32 v84, v84
  v_exp_f32 v85, v85
  v_exp_f32 v86, v86
  v_exp_f32 v87, v87
  v_cvt_pk_bf16_f32 v104, v80, v81
  v_cvt_pk_bf16_f32 v105, v82, v83
  v_mfma_f32_32x32x16_bf16 v[208:223], v[168:171], v[96:99], v[208:223]
  ds_write_b128 v25, v[192:195] offset:4096
  ds_write_b128 v25, v[196:199] offset:5120
  v_exp_f32 v88, v88
  v_exp_f32 v89, v89
  v_exp_f32 v90, v90
  v_exp_f32 v91, v91
  v_cvt_pk_bf16_f32 v106, v84, v85
  v_cvt_pk_bf16_f32 v107, v86, v87
  v_mfma_f32_32x32x16_bf16 v[208:223], v[172:175], v[100:103], v[208:223]
  ds_write_b128 v25, v[200:203] offset:6144
  ds_write_b128 v25, v[204:207] offset:7168
  v_exp_f32 v92, v92
  v_exp_f32 v93, v93
  v_exp_f32 v94, v94
  v_exp_f32 v95, v95
  v_cvt_pk_bf16_f32 v108, v88, v89
  v_cvt_pk_bf16_f32 v109, v90, v91
  v_cvt_pk_bf16_f32 v110, v92, v93
  v_cvt_pk_bf16_f32 v111, v94, v95
  v_mfma_f32_32x32x16_bf16 v[224:239], v[168:171], v[104:107], v[224:239]
  s_nop 0
  v_mfma_f32_32x32x16_bf16 v[224:239], v[172:175], v[108:111], v[224:239]
  ds_write_b128 v25, v[208:211] offset:8192
  ds_write_b128 v25, v[212:215] offset:9216
  ds_write_b128 v25, v[216:219] offset:10240
  ds_write_b128 v25, v[220:223] offset:11264
  s_waitcnt vmcnt(6)
  s_waitcnt lgkmcnt(0)
  s_barrier
  ds_read_b128 v[64:67], v29 offset:0
  ds_read_b128 v[68:71], v29 offset:1024
  ds_read_b128 v[72:75], v29 offset:2048
  ds_read_b128 v[76:79], v29 offset:3072
  ds_read_b128 v[80:83], v30 offset:0
  ds_read_b128 v[84:87], v30 offset:1024
  ds_read_b128 v[88:91], v30 offset:2048
  ds_read_b128 v[92:95], v30 offset:3072
  ds_read_b128 v[96:99], v31 offset:0
  ds_read_b128 v[100:103], v31 offset:1024
  ds_read_b128 v[104:107], v31 offset:2048
  ds_read_b128 v[108:111], v31 offset:3072
  s_waitcnt vmcnt(0)
  v_cmp_ne_u32 vcc, s48, v16
  s_cmp_lg_u64 vcc, 0
  s_cbranch_scc1 fx_28
ok_27:
  s_waitcnt lgkmcnt(8)
  v_pk_add_f32 v[224:225], v[224:225], v[64:65]
  v_pk_add_f32 v[226:227], v[226:227], v[66:67]
  v_pk_add_f32 v[228:229], v[228:229], v[68:69]
  v_pk_add_f32 v[230:231], v[230:231], v[70:71]
  v_pk_add_f32 v[232:233], v[232:233], v[72:73]
  v_pk_add_f32 v[234:235], v[234:235], v[74:75]
  v_pk_add_f32 v[236:237], v[236:237], v[76:77]
  v_pk_add_f32 v[238:239], v[238:239], v[78:79]
  s_waitcnt lgkmcnt(4)
  v_pk_add_f32 v[224:225], v[224:225], v[80:81]
  v_pk_add_f32 v[226:227], v[226:227], v[82:83]
  v_pk_add_f32 v[228:229], v[228:229], v[84:85]
  v_pk_add_f32 v[230:231], v[230:231], v[86:87]
  v_pk_add_f32 v[232:233], v[232:233], v[88:89]
  v_pk_add_f32 v[234:235], v[234:235], v[90:91]
  v_pk_add_f32 v[236:237], v[236:237], v[92:93]
  v_pk_add_f32 v[238:239], v[238:239], v[94:95]
  s_waitcnt lgkmcnt(0)
  v_pk_add_f32 v[224:225], v[224:225], v[96:97]
  v_pk_add_f32 v[226:227], v[226:227], v[98:99]
  v_pk_add_f32 v[228:229], v[228:229], v[100:101]
  v_pk_add_f32 v[230:231], v[230:231], v[102:103]
  v_pk_add_f32 v[232:233], v[232:233], v[104:105]
  v_pk_add_f32 v[234:235], v[234:235], v[106:107]
  v_pk_add_f32 v[236:237], v[236:237], v[108:109]
  v_pk_add_f32 v[238:239], v[238:239], v[110:111]
  v_cmp_u_f32 vcc, v236, v236
  s_cbranch_vccnz L_fallback
L_fbret:
  v_mov_b32 v18, v236
  v_mov_b32 v19, v236
  s_nop 1
  v_permlane32_swap_b32 v18, v19
  v_rcp_f32 v18, v19
  s_nop 0
  v_pk_mul_f32 v[224:225], v[224:225], v[18:19] op_sel:[0,0] op_sel_hi:[1,0]
  v_pk_mul_f32 v[226:227], v[226:227], v[18:19] op_sel:[0,0] op_sel_hi:[1,0]
  v_pk_mul_f32 v[228:229], v[228:229], v[18:19] op_sel:[0,0] op_sel_hi:[1,0]
  v_pk_mul_f32 v[230:231], v[230:231], v[18:19] op_sel:[0,0] op_sel_hi:[1,0]
  v_pk_mul_f32 v[232:233], v[232:233], v[18:19] op_sel:[0,0] op_sel_hi:[1,0]
  v_pk_mul_f32 v[234:235], v[234:235], v[18:19] op_sel:[0,0] op_sel_hi:[1,0]
  v_pk_mul_f32 v[236:237], v[236:237], v[18:19] op_sel:[0,0] op_sel_hi:[1,0]
  v_pk_mul_f32 v[238:239], v[238:239], v[18:19] op_sel:[0,0] op_sel_hi:[1,0]
  v_cvt_pk_bf16_f32 v64, v224, v225
  v_cvt_pk_bf16_f32 v65, v226, v227
  v_cvt_pk_bf16_f32 v66, v228, v229
  v_cvt_pk_bf16_f32 v67, v230, v231
  v_cvt_pk_bf16_f32 v68, v232, v233
  v_cvt_pk_bf16_f32 v69, v234, v235
  v_cvt_pk_bf16_f32 v70, v236, v237
  v_cvt_pk_bf16_f32 v71, v238, v239
  s_mov_b32 exec_lo, 0
  v_mov_b32 v70, 0
  v_mov_b32 v71, 0
  s_mov_b32 exec_lo, -1
  buffer_store_dwordx4 v[64:67], v1, s[28:31], s64 offen offset:0 sc1
  buffer_store_dwordx4 v[68:71], v1, s[28:31], s64 offen offset:1024 sc1
  s_cmp_lt_u32 s2, 224
  s_cbranch_scc0 L_fin
  s_barrier
  s_lshr_b32 s4, s3, 1
  s_mul_i32 s4, s4, 57344
  s_sub_u32 s4, s4, s62
  v_add_u32 v19, s4, v11
  v_mov_b32 v28, 0x3f803f80
  v_mov_b32 v21, 0
  v_mov_b32 v22, 0
  ds_read_b64_tr_b16 v[128:129], v19 offset:0
  ds_read_b64_tr_b16 v[130:131], v19 offset:1024
  ds_read_b64_tr_b16 v[132:133], v19 offset:2048
  ds_read_b64_tr_b16 v[134:135], v19 offset:3072
  ds_read_b64_tr_b16 v[136:137], v19 offset:4096
  ds_read_b64_tr_b16 v[138:139], v19 offset:5120
  ds_read_b64_tr_b16 v[140:141], v19 offset:6144
  ds_read_b64_tr_b16 v[142:143], v19 offset:7168
  ds_read_b64_tr_b16 v[144:145], v19 offset:8192
  ds_read_b64_tr_b16 v[146:147], v19 offset:9216
  ds_read_b64_tr_b16 v[148:149], v19 offset:10240
  ds_read_b64_tr_b16 v[150:151], v19 offset:11264
  ds_read_b64_tr_b16 v[152:153], v19 offset:12288
  ds_read_b64_tr_b16 v[154:155], v19 offset:13312
  s_and_b32 s5, s3, 1
  s_lshl_b32 s5, s5, 6
  v_subrev_u32 v7, s62, v11
  v_xor_b32 v7, s5, v7
  v_xor_b32 v8, 64, v7
  s_xor_b32 s4, s3, 1
  s_mul_i32 s4, s4, 12288
  s_add_u32 s4, s4, 114688
  v_add_u32 v29, s4, v1
  s_xor_b32 s4, s3, 2
  s_mul_i32 s4, s4, 12288
  s_add_u32 s4, s4, 118784
  v_add_u32 v30, s4, v1
  s_xor_b32 s4, s3, 3
  s_mul_i32 s4, s4, 12288
  s_add_u32 s4, s4, 122880
  v_add_u32 v31, s4, v1
  s_lshr_b32 s4, s3, 1
  s_add_u32 s51, s53, s4
  s_xor_b32 s5, s51, 1
  s_lshl_b32 s6, s3, 13
  s_add_u32 s6, s6, 5242880
  s_lshl_b32 s5, s5, 15
  s_add_u32 s57, s5, s6
  s_lshl_b32 s5, s51, 15
  s_add_u32 s58, s5, s6
  v_add_u32 v23, 4096, v1
  ds_read_b64_tr_b16 v[156:157], v19 offset:14336
  ds_read_b64_tr_b16 v[158:159], v19 offset:15360
  s_waitcnt lgkmcnt(14)
  v_dot2c_f32_bf16 v21, v128, v28
  v_dot2c_f32_bf16 v22, v129, v28
  v_dot2c_f32_bf16 v21, v130, v28
  v_dot2c_f32_bf16 v22, v131, v28
  ds_read_b64_tr_b16 v[160:161], v19 offset:16384
  ds_read_b64_tr_b16 v[162:163], v19 offset:17408
  s_waitcnt lgkmcnt(14)
  v_dot2c_f32_bf16 v21, v132, v28
  v_dot2c_f32_bf16 v22, v133, v28
  v_dot2c_f32_bf16 v21, v134, v28
  v_dot2c_f32_bf16 v22, v135, v28
  ds_read_b64_tr_b16 v[164:165], v19 offset:18432
  ds_read_b64_tr_b16 v[166:167], v19 offset:19456
  s_waitcnt lgkmcnt(14)
  v_dot2c_f32_bf16 v21, v136, v28
  v_dot2c_f32_bf16 v22, v137, v28
  v_dot2c_f32_bf16 v21, v138, v28
  v_dot2c_f32_bf16 v22, v139, v28
  ds_read_b64_tr_b16 v[168:169], v19 offset:20480
  ds_read_b64_tr_b16 v[170:171], v19 offset:21504
  s_waitcnt lgkmcnt(14)
  v_dot2c_f32_bf16 v21, v140, v28
  v_dot2c_f32_bf16 v22, v141, v28
  v_dot2c_f32_bf16 v21, v142, v28
  v_dot2c_f32_bf16 v22, v143, v28
  ds_read_b64_tr_b16 v[172:173], v19 offset:22528
  ds_read_b64_tr_b16 v[174:175], v19 offset:23552
  s_waitcnt lgkmcnt(14)
  v_dot2c_f32_bf16 v21, v144, v28
  v_dot2c_f32_bf16 v22, v145, v28
  v_dot2c_f32_bf16 v21, v146, v28
  v_dot2c_f32_bf16 v22, v147, v28
  ds_read_b64_tr_b16 v[176:177], v19 offset:24576
  ds_read_b64_tr_b16 v[178:179], v19 offset:25600
  s_waitcnt lgkmcnt(14)
  v_dot2c_f32_bf16 v21, v148, v28
  v_dot2c_f32_bf16 v22, v149, v28
  v_dot2c_f32_bf16 v21, v150, v28
  v_dot2c_f32_bf16 v22, v151, v28
  ds_read_b64_tr_b16 v[180:181], v19 offset:26624
  ds_read_b64_tr_b16 v[182:183], v19 offset:27648
  s_waitcnt lgkmcnt(14)
  v_dot2c_f32_bf16 v21, v152, v28
  v_dot2c_f32_bf16 v22, v153, v28
  v_dot2c_f32_bf16 v21, v154, v28
  v_dot2c_f32_bf16 v22, v155, v28
  ds_read_b64_tr_b16 v[184:185], v19 offset:28672
  ds_read_b64_tr_b16 v[186:187], v19 offset:29696
  s_waitcnt lgkmcnt(14)
  v_dot2c_f32_bf16 v21, v156, v28
  v_dot2c_f32_bf16 v22, v157, v28
  v_dot2c_f32_bf16 v21, v158, v28
  v_dot2c_f32_bf16 v22, v159, v28
  ds_read_b64_tr_b16 v[188:189], v19 offset:30720
  ds_read_b64_tr_b16 v[190:191], v19 offset:31744
  s_waitcnt lgkmcnt(14)
  v_dot2c_f32_bf16 v21, v160, v28
  v_dot2c_f32_bf16 v22, v161, v28
  v_dot2c_f32_bf16 v21, v162, v28
  v_dot2c_f32_bf16 v22, v163, v28
  ds_read_b64_tr_b16 v[192:193], v19 offset:32768
  ds_read_b64_tr_b16 v[194:195], v19 offset:33792
  s_waitcnt lgkmcnt(14)
  v_dot2c_f32_bf16 v21, v164, v28
  v_dot2c_f32_bf16 v22, v165, v28
  v_dot2c_f32_bf16 v21, v166, v28
  v_dot2c_f32_bf16 v22, v167, v28
  ds_read_b64_tr_b16 v[196:197], v19 offset:34816
  ds_read_b64_tr_b16 v[198:199], v19 offset:35840
  s_waitcnt lgkmcnt(14)
  v_dot2c_f32_bf16 v21, v168, v28
  v_dot2c_f32_bf16 v22, v169, v28
  v_dot2c_f32_bf16 v21, v170, v28
  v_dot2c_f32_bf16 v22, v171, v28
  ds_read_b64_tr_b16 v[200:201], v19 offset:36864
  ds_read_b64_tr_b16 v[202:203], v19 offset:37888
  s_waitcnt lgkmcnt(14)
  v_dot2c_f32_bf16 v21, v172, v28
  v_dot2c_f32_bf16 v22, v173, v28
  v_dot2c_f32_bf16 v21, v174, v28
  v_dot2c_f32_bf16 v22, v175, v28
  ds_read_b64_tr_b16 v[204:205], v19 offset:38912
  ds_read_b64_tr_b16 v[206:207], v19 offset:39936
  s_waitcnt lgkmcnt(14)
  v_dot2c_f32_bf16 v21, v176, v28
  v_dot2c_f32_bf16 v22, v177, v28
  v_dot2c_f32_bf16 v21, v178, v28
  v_dot2c_f32_bf16 v22, v179, v28
  ds_read_b64_tr_b16 v[208:209], v19 offset:40960
  ds_read_b64_tr_b16 v[210:211], v19 offset:41984
  s_waitcnt lgkmcnt(14)
  v_dot2c_f32_bf16 v21, v180, v28
  v_dot2c_f32_bf16 v22, v181, v28
  v_dot2c_f32_bf16 v21, v182, v28
  v_dot2c_f32_bf16 v22, v183, v28
  ds_read_b64_tr_b16 v[212:213], v19 offset:43008
  ds_read_b64_tr_b16 v[214:215], v19 offset:44032
  s_waitcnt lgkmcnt(14)
  v_dot2c_f32_bf16 v21, v184, v28
  v_dot2c_f32_bf16 v22, v185, v28
  v_dot2c_f32_bf16 v21, v186, v28
  v_dot2c_f32_bf16 v22, v187, v28
  ds_read_b64_tr_b16 v[216:217], v19 offset:45056
  ds_read_b64_tr_b16 v[218:219], v19 offset:46080
  s_waitcnt lgkmcnt(14)
  v_dot2c_f32_bf16 v21, v188, v28
  v_dot2c_f32_bf16 v22, v189, v28
  v_dot2c_f32_bf16 v21, v190, v28
  v_dot2c_f32_bf16 v22, v191, v28
  ds_read_b64_tr_b16 v[220:221], v19 offset:47104
  ds_read_b64_tr_b16 v[222:223], v19 offset:48128
  s_waitcnt lgkmcnt(14)
  v_dot2c_f32_bf16 v21, v192, v28
  v_dot2c_f32_bf16 v22, v193, v28
  v_dot2c_f32_bf16 v21, v194, v28
  v_dot2c_f32_bf16 v22, v195, v28
  ds_read_b64_tr_b16 v[224:225], v19 offset:49152
  ds_read_b64_tr_b16 v[226:227], v19 offset:50176
  s_waitcnt lgkmcnt(14)
  v_dot2c_f32_bf16 v21, v196, v28
  v_dot2c_f32_bf16 v22, v197, v28
  v_dot2c_f32_bf16 v21, v198, v28
  v_dot2c_f32_bf16 v22, v199, v28
  ds_read_b64_tr_b16 v[228:229], v19 offset:51200
  ds_read_b64_tr_b16 v[230:231], v19 offset:52224
  s_waitcnt lgkmcnt(14)
  v_dot2c_f32_bf16 v21, v200, v28
  v_dot2c_f32_bf16 v22, v201, v28
  v_dot2c_f32_bf16 v21, v202, v28
  v_dot2c_f32_bf16 v22, v203, v28
  ds_read_b64_tr_b16 v[232:233], v19 offset:53248
  ds_read_b64_tr_b16 v[234:235], v19 offset:54272
  s_waitcnt lgkmcnt(14)
  v_dot2c_f32_bf16 v21, v204, v28
  v_dot2c_f32_bf16 v22, v205, v28
  v_dot2c_f32_bf16 v21, v206, v28
  v_dot2c_f32_bf16 v22, v207, v28
  ds_read_b64_tr_b16 v[236:237], v19 offset:55296
  ds_read_b64_tr_b16 v[238:239], v19 offset:56320
  s_waitcnt lgkmcnt(14)
  v_dot2c_f32_bf16 v21, v208, v28
  v_dot2c_f32_bf16 v22, v209, v28
  v_dot2c_f32_bf16 v21, v210, v28
  v_dot2c_f32_bf16 v22, v211, v28
  s_waitcnt lgkmcnt(12)
  v_dot2c_f32_bf16 v21, v212, v28
  v_dot2c_f32_bf16 v22, v213, v28
  v_dot2c_f32_bf16 v21, v214, v28
  v_dot2c_f32_bf16 v22, v215, v28
  s_waitcnt lgkmcnt(10)
  v_dot2c_f32_bf16 v21, v216, v28
  v_dot2c_f32_bf16 v22, v217, v28
  v_dot2c_f32_bf16 v21, v218, v28
  v_dot2c_f32_bf16 v22, v219, v28
  s_waitcnt lgkmcnt(8)
  v_dot2c_f32_bf16 v21, v220, v28
  v_dot2c_f32_bf16 v22, v221, v28
  v_dot2c_f32_bf16 v21, v222, v28
  v_dot2c_f32_bf16 v22, v223, v28
  s_waitcnt lgkmcnt(6)
  v_dot2c_f32_bf16 v21, v224, v28
  v_dot2c_f32_bf16 v22, v225, v28
  v_dot2c_f32_bf16 v21, v226, v28
  v_dot2c_f32_bf16 v22, v227, v28
  s_waitcnt lgkmcnt(4)
  v_dot2c_f32_bf16 v21, v228, v28
  v_dot2c_f32_bf16 v22, v229, v28
  v_dot2c_f32_bf16 v21, v230, v28
  v_dot2c_f32_bf16 v22, v231, v28
  s_waitcnt lgkmcnt(2)
  v_dot2c_f32_bf16 v21, v232, v28
  v_dot2c_f32_bf16 v22, v233, v28
  v_dot2c_f32_bf16 v21, v234, v28
  v_dot2c_f32_bf16 v22, v235, v28
  s_waitcnt lgkmcnt(0)
  v_dot2c_f32_bf16 v21, v236, v28
  v_dot2c_f32_bf16 v22, v237, v28
  v_dot2c_f32_bf16 v21, v238, v28
  v_dot2c_f32_bf16 v22, v239, v28
  s_nop 2
  v_add_f32 v21, v21, v22
  v_lshl_or_b32 v98, v20, 16, v20
  v_mov_b32 v99, 0
  v_cvt_pk_bf16_f32 v96, v21, v21
  v_and_b32 v22, 0xffff0000, v96
  v_sub_f32 v21, v21, v22
  v_cvt_pk_bf16_f32 v97, v21, v21
  s_mov_b32 exec_lo, 0
  v_mov_b32 v98, 0
  s_mov_b32 exec_lo, -1
  ds_write_b128 v25, v[96:99]
  v_add_u32 v19, 114688, v1
  buffer_load_dwordx4 v[64:67], v1, s[28:31], s57 offen offset:0 sc1
  buffer_load_dwordx4 v[68:71], v1, s[28:31], s57 offen offset:1024 sc1
  s_waitcnt lgkmcnt(0)
  s_barrier
  ds_read_b128 v[96:99], v19 offset:0
  ds_read_b128 v[100:103], v19 offset:12288
  ds_read_b128 v[104:107], v19 offset:24576
  ds_read_b128 v[108:111], v19 offset:36864
  buffer_load_dwordx4 v[72:75], v1, s[28:31], s57 offen offset:2048 sc1
  buffer_load_dwordx4 v[76:79], v1, s[28:31], s57 offen offset:3072 sc1
  v_lshlrev_b32 v112, 16, v240
  v_and_b32 v113, 0xffff0000, v240
  v_lshlrev_b32 v114, 16, v241
  v_and_b32 v115, 0xffff0000, v241
  v_lshlrev_b32 v116, 16, v242
  v_and_b32 v117, 0xffff0000, v242
  v_lshlrev_b32 v118, 16, v243
  v_and_b32 v119, 0xffff0000, v243
  v_lshlrev_b32 v120, 16, v244
  v_and_b32 v121, 0xffff0000, v244
  v_lshlrev_b32 v122, 16, v245
  v_and_b32 v123, 0xffff0000, v245
  v_lshlrev_b32 v124, 16, v246
  v_and_b32 v125, 0xffff0000, v246
  v_lshlrev_b32 v126, 16, v247
  v_and_b32 v127, 0xffff0000, v247
  buffer_load_dwordx4 v[80:83], v23, s[28:31], s57 offen offset:0 sc1
  buffer_load_dwordx4 v[84:87], v23, s[28:31], s57 offen offset:1024 sc1
  s_waitcnt lgkmcnt(0)
  s_barrier
  buffer_load_dwordx4 v[88:91], v23, s[28:31], s57 offen offset:2048 sc1
  buffer_load_dwordx4 v[92:95], v23, s[28:31], s57 offen offset:3072 sc1
  buffer_load_dwordx4 v[32:35], v1, s[28:31], s58 offen offset:0 sc1
  buffer_load_dwordx4 v[36:39], v1, s[28:31], s58 offen offset:1024 sc1
  buffer_load_dwordx4 v[40:43], v1, s[28:31], s58 offen offset:2048 sc1
  buffer_load_dwordx4 v[44:47], v1, s[28:31], s58 offen offset:3072 sc1
  buffer_load_dwordx4 v[48:51], v23, s[28:31], s58 offen offset:0 sc1
  buffer_load_dwordx4 v[52:55], v23, s[28:31], s58 offen offset:1024 sc1
  buffer_load_dwordx4 v[56:59], v23, s[28:31], s58 offen offset:2048 sc1
  buffer_load_dwordx4 v[60:63], v23, s[28:31], s58 offen offset:3072 sc1
  s_waitcnt vmcnt(15)
ck_29:
  v_cmp_u_f32 vcc, v65, v67
  s_cbranch_vccnz rp_31
ok_30:
  v_mfma_f32_32x32x16_bf16 v[144:159], a[192:195], v[64:67], 0
  s_waitcnt vmcnt(14)
  v_cmp_u_f32 vcc, v69, v71
  v_mfma_f32_32x32x16_bf16 v[160:175], a[196:199], v[64:67], 0
  s_cbranch_vccnz rp_33
ok_32:
  v_mfma_f32_32x32x16_bf16 v[144:159], a[200:203], v[68:71], v[144:159]
  s_waitcnt vmcnt(13)
  v_cmp_u_f32 vcc, v73, v75
  v_mfma_f32_32x32x16_bf16 v[160:175], a[204:207], v[68:71], v[160:175]
  s_cbranch_vccnz rp_35
ok_34:
  v_mfma_f32_32x32x16_bf16 v[144:159], a[208:211], v[72:75], v[144:159]
  s_waitcnt vmcnt(12)
  v_cmp_u_f32 vcc, v77, v79
  v_mfma_f32_32x32x16_bf16 v[160:175], a[212:215], v[72:75], v[160:175]
  s_cbranch_vccnz rp_37
ok_36:
  v_mfma_f32_32x32x16_bf16 v[144:159], a[216:219], v[76:79], v[144:159]
  s_waitcnt vmcnt(11)
  v_cmp_u_f32 vcc, v81, v83
  v_mfma_f32_32x32x16_bf16 v[160:175], a[220:223], v[76:79], v[160:175]
  s_cbranch_vccnz rp_39
ok_38:
  v_mfma_f32_32x32x16_bf16 v[144:159], a[224:227], v[80:83], v[144:159]
  s_waitcnt vmcnt(10)
  v_cmp_u_f32 vcc, v85, v87
  v_mfma_f32_32x32x16_bf16 v[160:175], a[228:231], v[80:83], v[160:175]
  s_cbranch_vccnz rp_41
ok_40:
  v_mfma_f32_32x32x16_bf16 v[144:159], a[232:235], v[84:87], v[144:159]
  s_waitcnt vmcnt(9)
  v_cmp_u_f32 vcc, v89, v91
  v_mfma_f32_32x32x16_bf16 v[160:175], a[236:239], v[84:87], v[160:175]
  s_cbranch_vccnz rp_43
ok_42:
  v_mfma_f32_32x32x16_bf16 v[144:159], a[240:243], v[88:91], v[144:159]
  s_waitcnt vmcnt(8)
  v_cmp_u_f32 vcc, v93, v95
  v_mfma_f32_32x32x16_bf16 v[160:175], a[244:247], v[88:91], v[160:175]
  s_cbranch_vccnz rp_45
ok_44:
  v_mfma_f32_32x32x16_bf16 v[144:159], a[248:251], v[92:95], v[144:159]
  s_waitcnt vmcnt(6)
  v_max3_u32 v24, v33, v35, v37
  v_cmp_u_f32 vcc, v24, v39
  v_mfma_f32_32x32x16_bf16 v[160:175], a[252:255], v[92:95], v[160:175]
  s_cbranch_vccnz rp_47
ok_46:
  v_mfma_f32_32x32x16_bf16 v[128:143], a[196:199], v[32:35], 0
  s_waitcnt vmcnt(4)
  v_max3_u32 v24, v41, v43, v45
  v_cmp_u_f32 vcc, v24, v47
  v_mfma_f32_32x32x16_bf16 v[128:143], a[204:207], v[36:39], v[128:143]
  s_cbranch_vccnz rp_49
ok_48:
  v_mfma_f32_32x32x16_bf16 v[128:143], a[212:215], v[40:43], v[128:143]
  ds_write_b128 v25, v[144:147] offset:4096
  s_waitcnt vmcnt(2)
  v_max3_u32 v24, v49, v51, v53
  v_cmp_u_f32 vcc, v24, v55
  v_mfma_f32_32x32x16_bf16 v[128:143], a[220:223], v[44:47], v[128:143]
  ds_write_b128 v25, v[148:151] offset:5120
  s_cbranch_vccnz rp_51
ok_50:
  v_mfma_f32_32x32x16_bf16 v[128:143], a[228:231], v[48:51], v[128:143]
  ds_write_b128 v25, v[152:155] offset:6144
  s_waitcnt vmcnt(0)
  v_max3_u32 v24, v57, v59, v61
  v_cmp_u_f32 vcc, v24, v63
  v_mfma_f32_32x32x16_bf16 v[128:143], a[236:239], v[52:55], v[128:143]
  ds_write_b128 v25, v[156:159] offset:7168
  s_cbranch_vccnz rp_53
ok_52:
  v_mfma_f32_32x32x16_bf16 v[128:143], a[244:247], v[56:59], v[128:143]
  ds_write_b128 v25, v[160:163] offset:8192
  ds_write_b128 v25, v[164:167] offset:9216
  v_mfma_f32_32x32x16_bf16 v[128:143], a[252:255], v[60:63], v[128:143]
  ds_write_b128 v25, v[168:171] offset:10240
  ds_write_b128 v25, v[172:175] offset:11264
  v_mfma_f32_32x32x16_bf16 v[112:127], a[192:195], v[32:35], v[112:127]
  v_mfma_f32_32x32x16_bf16 v[112:127], a[200:203], v[36:39], v[112:127]
  v_mfma_f32_32x32x16_bf16 v[112:127], a[208:211], v[40:43], v[112:127]
  s_nop 6
  ds_write_b128 v25, v[128:131] offset:0
  v_mfma_f32_32x32x16_bf16 v[112:127], a[216:219], v[44:47], v[112:127]
  ds_write_b128 v25, v[132:135] offset:1024
  v_mfma_f32_32x32x16_bf16 v[112:127], a[224:227], v[48:51], v[112:127]
  ds_write_b128 v25, v[136:139] offset:2048
  v_mfma_f32_32x32x16_bf16 v[112:127], a[232:235], v[52:55], v[112:127]
  ds_write_b128 v25, v[140:143] offset:3072
  v_mfma_f32_32x32x16_bf16 v[112:127], a[240:243], v[56:59], v[112:127]
  v_mfma_f32_32x32x16_bf16 v[112:127], a[248:251], v[60:63], v[112:127]
  v_mov_b32 v18, 0
  v_mov_b32 v19, 0
  v_and_b32 v21, 15, v0
  v_min_u32 v21, 13, v21
  v_lshlrev_b32 v21, 8, v21
  s_add_u32 s4, s73, 252
  v_add_u32 v15, s4, v21
  s_waitcnt lgkmcnt(0)
  s_barrier
  ds_read_b128 v[128:131], v29 offset:0
  ds_read_b128 v[132:135], v29 offset:1024
  ds_read_b128 v[136:139], v29 offset:2048
  ds_read_b128 v[140:143], v29 offset:3072
  ds_read_b128 v[144:147], v30 offset:0
  ds_read_b128 v[148:151], v30 offset:1024
  ds_read_b128 v[152:155], v30 offset:2048
  ds_read_b128 v[156:159], v30 offset:3072
  ds_read_b128 v[160:163], v31 offset:0
  ds_read_b128 v[164:167], v31 offset:1024
  ds_read_b128 v[168:171], v31 offset:2048
  ds_read_b128 v[172:175], v31 offset:3072
  s_waitcnt lgkmcnt(8)
  v_pk_add_f32 v[112:113], v[112:113], v[128:129]
  v_pk_add_f32 v[114:115], v[114:115], v[130:131]
  v_pk_add_f32 v[116:117], v[116:117], v[132:133]
  v_pk_add_f32 v[118:119], v[118:119], v[134:135]
  v_pk_add_f32 v[120:121], v[120:121], v[136:137]
  v_pk_add_f32 v[122:123], v[122:123], v[138:139]
  v_pk_add_f32 v[124:125], v[124:125], v[140:141]
  v_pk_add_f32 v[126:127], v[126:127], v[142:143]
  s_waitcnt lgkmcnt(4)
  v_pk_add_f32 v[112:113], v[112:113], v[144:145]
  v_pk_add_f32 v[114:115], v[114:115], v[146:147]
  v_pk_add_f32 v[116:117], v[116:117], v[148:149]
  v_pk_add_f32 v[118:119], v[118:119], v[150:151]
  v_pk_add_f32 v[120:121], v[120:121], v[152:153]
  v_pk_add_f32 v[122:123], v[122:123], v[154:155]
  v_pk_add_f32 v[124:125], v[124:125], v[156:157]
  v_pk_add_f32 v[126:127], v[126:127], v[158:159]
  s_waitcnt lgkmcnt(0)
  v_pk_add_f32 v[112:113], v[112:113], v[160:161]
  v_pk_add_f32 v[114:115], v[114:115], v[162:163]
  v_pk_add_f32 v[116:117], v[116:117], v[164:165]
  v_pk_add_f32 v[118:119], v[118:119], v[166:167]
  v_pk_add_f32 v[120:121], v[120:121], v[168:169]
  v_pk_add_f32 v[122:123], v[122:123], v[170:171]
  v_pk_add_f32 v[124:125], v[124:125], v[172:173]
  v_pk_add_f32 v[126:127], v[126:127], v[174:175]
  v_cvt_pk_bf16_f32 v176, v112, v113
  v_cvt_pk_bf16_f32 v177, v114, v115
  v_cvt_pk_bf16_f32 v178, v116, v117
  v_cvt_pk_bf16_f32 v179, v118, v119
  v_cvt_pk_bf16_f32 v180, v120, v121
  v_cvt_pk_bf16_f32 v181, v122, v123
  v_cvt_pk_bf16_f32 v182, v124, v125
  v_cvt_pk_bf16_f32 v183, v126, v127
  s_cmp_eq_u32 s69, 0
  s_cbranch_scc1 far_55
  buffer_store_dwordx4 v[176:179], v1, s[28:31], s65 offen offset:0
  buffer_store_dwordx4 v[180:183], v1, s[28:31], s65 offen offset:1024
ok_54:
  v_dot2c_f32_bf16 v18, v176, v28
  v_dot2c_f32_bf16 v19, v176, v176
  v_dot2c_f32_bf16 v18, v177, v28
  v_dot2c_f32_bf16 v19, v177, v177
  v_dot2c_f32_bf16 v18, v178, v28
  v_dot2c_f32_bf16 v19, v178, v178
  v_dot2c_f32_bf16 v18, v179, v28
  v_dot2c_f32_bf16 v19, v179, v179
  v_dot2c_f32_bf16 v18, v180, v28
  v_dot2c_f32_bf16 v19, v180, v180
  v_dot2c_f32_bf16 v18, v181, v28
  v_dot2c_f32_bf16 v19, v181, v181
  v_dot2c_f32_bf16 v18, v182, v28
  v_dot2c_f32_bf16 v19, v182, v182
  v_dot2c_f32_bf16 v18, v183, v28
  v_dot2c_f32_bf16 v19, v183, v183
  s_nop 1
  v_mov_b32 v20, v18
  v_mov_b32 v21, v19
  s_nop 0
  v_permlane32_swap_b32 v18, v20
  v_permlane32_swap_b32 v19, v21
  v_pk_add_f32 v[18:19], v[18:19], v[20:21]
  s_mov_b32 exec_hi, 0
  s_cmp_eq_u32 s69, 0
  s_cbranch_scc1 far_57
  buffer_store_dwordx2 v[18:19], v27, s[28:31], s66 offen
ok_56:
  s_mov_b32 exec_hi, -1
  s_waitcnt vmcnt(3)
  s_barrier
  v_lshlrev_b32 v20, 16, v248
  v_and_b32 v21, 0xffff0000, v248
  v_lshlrev_b32 v240, 16, v176
  v_and_b32 v241, 0xffff0000, v176
  v_pk_add_f32 v[240:241], v[240:241], v[20:21]
  v_lshlrev_b32 v20, 16, v249
  v_and_b32 v21, 0xffff0000, v249
  v_lshlrev_b32 v242, 16, v177
  v_and_b32 v243, 0xffff0000, v177
  v_pk_add_f32 v[242:243], v[242:243], v[20:21]
  v_lshlrev_b32 v20, 16, v250
  v_and_b32 v21, 0xffff0000, v250
  v_lshlrev_b32 v244, 16, v178
  v_and_b32 v245, 0xffff0000, v178
  v_pk_add_f32 v[244:245], v[244:245], v[20:21]
  v_lshlrev_b32 v20, 16, v251
  v_and_b32 v21, 0xffff0000, v251
  v_lshlrev_b32 v246, 16, v179
  v_and_b32 v247, 0xffff0000, v179
  v_pk_add_f32 v[246:247], v[246:247], v[20:21]
  v_lshlrev_b32 v20, 16, v252
  v_and_b32 v21, 0xffff0000, v252
  v_lshlrev_b32 v248, 16, v180
  v_and_b32 v249, 0xffff0000, v180
  v_pk_add_f32 v[248:249], v[248:249], v[20:21]
  v_lshlrev_b32 v20, 16, v253
  v_and_b32 v21, 0xffff0000, v253
  v_lshlrev_b32 v250, 16, v181
  v_and_b32 v251, 0xffff0000, v181
  v_pk_add_f32 v[250:251], v[250:251], v[20:21]
  buffer_load_dword v16, v15, s[28:31], 0 offen sc1
  v_lshlrev_b32 v20, 16, v254
  v_and_b32 v21, 0xffff0000, v254
  v_lshlrev_b32 v252, 16, v182
  v_and_b32 v253, 0xffff0000, v182
  v_pk_add_f32 v[252:253], v[252:253], v[20:21]
  v_lshlrev_b32 v20, 16, v255
  v_and_b32 v21, 0xffff0000, v255
  v_lshlrev_b32 v254, 16, v183
  v_and_b32 v255, 0xffff0000, v183
  v_pk_add_f32 v[254:255], v[254:255], v[20:21]
  v_and_b32 v21, 31, v0
  v_lshrrev_b32 v22, 5, v0
  v_lshlrev_b32 v22, 8, v22
  v_lshl_add_u32 v20, v21, 3, v22
  v_mov_b32 v115, 0
  ds_read_b64_tr_b16 v[64:65], v7 offset:0
  ds_read_b64_tr_b16 v[66:67], v7 offset:1024
  ds_read_b64_tr_b16 v[68:69], v8 offset:0
  ds_read_b64_tr_b16 v[70:71], v8 offset:1024
  ds_read_b64_tr_b16 v[72:73], v7 offset:2048
  ds_read_b64_tr_b16 v[74:75], v7 offset:3072
  v_add_u32 v116, 4096, v1
  v_add_u32 v117, 8192, v1
  v_add_u32 v118, 12288, v1
  v_add_u32 v119, 16384, v1
  v_add_u32 v120, 20480, v1
  v_add_u32 v121, 24576, v1
  s_waitcnt vmcnt(0)
  v_cmp_eq_u32 vcc, -1, v16
  s_cbranch_vccnz spin_59
ok_58:
  buffer_load_dwordx4 v[128:131], v1, s[28:31], s72 offen offset:0 sc1
  buffer_load_dwordx4 v[132:135], v1, s[28:31], s72 offen offset:1024 sc1
  buffer_load_dwordx2 v[80:81], v20, s[28:31], s73 offen offset:0 sc1
  buffer_load_dwordx4 v[136:139], v1, s[28:31], s72 offen offset:2048 sc1
  buffer_load_dwordx4 v[140:143], v1, s[28:31], s72 offen offset:3072 sc1
  buffer_load_dwordx2 v[82:83], v20, s[28:31], s73 offen offset:512 sc1
  buffer_load_dwordx4 v[144:147], v116, s[28:31], s72 offen offset:0 sc1
  buffer_load_dwordx4 v[148:151], v116, s[28:31], s72 offen offset:1024 sc1
  buffer_load_dwordx2 v[84:85], v20, s[28:31], s73 offen offset:1024 sc1
  buffer_load_dwordx4 v[152:155], v116, s[28:31], s72 offen offset:2048 sc1
  buffer_load_dwordx4 v[156:159], v116, s[28:31], s72 offen offset:3072 sc1
  buffer_load_dwordx2 v[86:87], v20, s[28:31], s73 offen offset:1536 sc1
  buffer_load_dwordx4 v[160:163], v117, s[28:31], s72 offen offset:0 sc1
  buffer_load_dwordx4 v[164:167], v117, s[28:31], s72 offen offset:1024 sc1
  s_mul_i32 s5, s3, 7
  s_lshr_b32 s5, s5, 1
  s_lshl_b32 s5, s5, 13
  s_and_b32 s4, s3, 1
  s_lshl_b32 s4, s4, 10
  s_add_u32 s5, s5, s4
  s_add_u32 s57, s5, 9437184
  s_mul_i32 s4, s4, 6
  s_add_u32 s4, s4, 1024
  s_sub_u32 s5, 8192, s4
  s_add_u32 s58, s57, s4
  s_add_u32 s52, s58, s5
  s_add_u32 s49, s52, s4
  s_add_u32 s50, s49, s5
  s_add_u32 s47, s50, s4
  s_add_u32 s45, s47, s5
  s_mul_i32 s4, s51, 114688
  v_add_u32 v9, s4, v1
  s_xor_b32 s4, s51, 1
  s_mul_i32 s4, s4, 114688
  v_add_u32 v10, s4, v1
  v_add_u32 v2, 4096, v9
  v_add_u32 v13, 4096, v10
  v_accvgpr_write_b32 a224, v104
  v_accvgpr_write_b32 a225, v105
  v_accvgpr_write_b32 a226, v106
  v_accvgpr_write_b32 a227, v107
  v_accvgpr_write_b32 a228, v108
  v_accvgpr_write_b32 a229, v109
  v_accvgpr_write_b32 a230, v110
  v_accvgpr_write_b32 a231, v111
  s_waitcnt vmcnt(12)
  v_max3_u32 v24, v129, v131, v133
  v_cmp_u_f32 vcc, v24, v135
  s_cbranch_vccnz rel_61
ok_60:
  s_waitcnt lgkmcnt(4)
  v_mfma_f32_32x32x16_bf16 v[32:47], v[64:67], v[128:131], 0
  ds_read_b64_tr_b16 v[76:77], v8 offset:2048
  ds_read_b64_tr_b16 v[78:79], v8 offset:3072
  buffer_load_dwordx2 v[88:89], v20, s[28:31], s73 offen offset:2048 sc1
  s_waitcnt lgkmcnt(4)
  v_mfma_f32_32x32x16_bf16 v[48:63], v[68:71], v[128:131], 0
  ds_read_b64_tr_b16 v[64:65], v7 offset:4096
  ds_read_b64_tr_b16 v[66:67], v7 offset:5120
  s_waitcnt lgkmcnt(4)
  v_mfma_f32_32x32x16_bf16 v[32:47], v[72:75], v[132:135], v[32:47]
  ds_read_b64_tr_b16 v[68:69], v8 offset:4096
  ds_read_b64_tr_b16 v[70:71], v8 offset:5120
  buffer_load_dwordx4 v[168:171], v117, s[28:31], s72 offen offset:2048 sc1
  buffer_load_dwordx4 v[172:175], v117, s[28:31], s72 offen offset:3072 sc1
  s_waitcnt vmcnt(12)
  v_max3_u32 v24, v137, v139, v141
  v_cmp_u_f32 vcc, v24, v143
  s_waitcnt lgkmcnt(4)
  v_mfma_f32_32x32x16_bf16 v[48:63], v[76:79], v[132:135], v[48:63]
  ds_read_b64_tr_b16 v[72:73], v7 offset:6144
  ds_read_b64_tr_b16 v[74:75], v7 offset:7168
  s_cbranch_vccnz rel_63
ok_62:
  s_waitcnt lgkmcnt(4)
  v_mfma_f32_32x32x16_bf16 v[32:47], v[64:67], v[136:139], v[32:47]
  ds_read_b64_tr_b16 v[76:77], v8 offset:6144
  ds_read_b64_tr_b16 v[78:79], v8 offset:7168
  buffer_load_dwordx2 v[90:91], v20, s[28:31], s73 offen offset:2560 sc1
  s_waitcnt lgkmcnt(4)
  v_mfma_f32_32x32x16_bf16 v[48:63], v[68:71], v[136:139], v[48:63]
  ds_read_b64_tr_b16 v[64:65], v7 offset:8192
  ds_read_b64_tr_b16 v[66:67], v7 offset:9216
  s_waitcnt lgkmcnt(4)
  v_mfma_f32_32x32x16_bf16 v[32:47], v[72:75], v[140:143], v[32:47]
  ds_read_b64_tr_b16 v[68:69], v8 offset:8192
  ds_read_b64_tr_b16 v[70:71], v8 offset:9216
  buffer_load_dwordx4 v[176:179], v118, s[28:31], s72 offen offset:0 sc1
  buffer_load_dwordx4 v[180:183], v118, s[28:31], s72 offen offset:1024 sc1
  s_waitcnt vmcnt(12)
  v_max3_u32 v24, v145, v147, v149
  v_cmp_u_f32 vcc, v24, v151
  s_waitcnt lgkmcnt(4)
  v_mfma_f32_32x32x16_bf16 v[48:63], v[76:79], v[140:143], v[48:63]
  ds_read_b64_tr_b16 v[72:73], v7 offset:10240
  ds_read_b64_tr_b16 v[74:75], v7 offset:11264
  s_cbranch_vccnz rel_65
ok_64:
  s_waitcnt lgkmcnt(4)
  v_mfma_f32_32x32x16_bf16 v[32:47], v[64:67], v[144:147], v[32:47]
  ds_read_b64_tr_b16 v[76:77], v8 offset:10240
  ds_read_b64_tr_b16 v[78:79], v8 offset:11264
  buffer_load_dwordx2 v[92:93], v20, s[28:31], s73 offen offset:3072 sc1
  s_waitcnt lgkmcnt(4)
  v_mfma_f32_32x32x16_bf16 v[48:63], v[68:71], v[144:147], v[48:63]
  ds_read_b64_tr_b16 v[64:65], v7 offset:12288
  ds_read_b64_tr_b16 v[66:67], v7 offset:13312
  s_waitcnt lgkmcnt(4)
  v_mfma_f32_32x32x16_bf16 v[32:47], v[72:75], v[148:151], v[32:47]
  ds_read_b64_tr_b16 v[68:69], v8 offset:12288
  ds_read_b64_tr_b16 v[70:71], v8 offset:13312
  buffer_load_dwordx4 v[184:187], v118, s[28:31], s72 offen offset:2048 sc1
  buffer_load_dwordx4 v[188:191], v118, s[28:31], s72 offen offset:3072 sc1
  s_waitcnt vmcnt(12)
  v_max3_u32 v24, v153, v155, v157
  v_cmp_u_f32 vcc, v24, v159
  s_waitcnt lgkmcnt(4)
  v_mfma_f32_32x32x16_bf16 v[48:63], v[76:79], v[148:151], v[48:63]
  ds_read_b64_tr_b16 v[72:73], v7 offset:14336
  ds_read_b64_tr_b16 v[74:75], v7 offset:15360
  s_cbranch_vccnz rel_67
ok_66:
  s_waitcnt lgkmcnt(4)
  v_mfma_f32_32x32x16_bf16 v[32:47], v[64:67], v[152:155], v[32:47]
  ds_read_b64_tr_b16 v[76:77], v8 offset:14336
  ds_read_b64_tr_b16 v[78:79], v8 offset:15360
  buffer_load_dwordx4 v[192:195], v119, s[28:31], s72 offen offset:0 sc1
  s_waitcnt lgkmcnt(4)
  v_mfma_f32_32x32x16_bf16 v[48:63], v[68:71], v[152:155], v[48:63]
  ds_read_b64_tr_b16 v[64:65], v7 offset:16384
  ds_read_b64_tr_b16 v[66:67], v7 offset:17408
  s_waitcnt lgkmcnt(4)
  v_mfma_f32_32x32x16_bf16 v[32:47], v[72:75], v[156:159], v[32:47]
  ds_read_b64_tr_b16 v[68:69], v8 offset:16384
  ds_read_b64_tr_b16 v[70:71], v8 offset:17408
  buffer_load_dwordx4 v[196:199], v119, s[28:31], s72 offen offset:1024 sc1
  buffer_load_dwordx4 v[200:203], v119, s[28:31], s72 offen offset:2048 sc1
  s_waitcnt vmcnt(12)
  v_max3_u32 v24, v161, v163, v165
  v_cmp_u_f32 vcc, v24, v167
  s_waitcnt lgkmcnt(4)
  v_mfma_f32_32x32x16_bf16 v[48:63], v[76:79], v[156:159], v[48:63]
  ds_read_b64_tr_b16 v[72:73], v7 offset:18432
  ds_read_b64_tr_b16 v[74:75], v7 offset:19456
  s_cbranch_vccnz rel_69
ok_68:
  s_waitcnt lgkmcnt(4)
  v_mfma_f32_32x32x16_bf16 v[32:47], v[64:67], v[160:163], v[32:47]
  ds_read_b64_tr_b16 v[76:77], v8 offset:18432
  ds_read_b64_tr_b16 v[78:79], v8 offset:19456
  buffer_load_dwordx4 v[204:207], v119, s[28:31], s72 offen offset:3072 sc1
  s_waitcnt lgkmcnt(4)
  v_mfma_f32_32x32x16_bf16 v[48:63], v[68:71], v[160:163], v[48:63]
  ds_read_b64_tr_b16 v[64:65], v7 offset:20480
  ds_read_b64_tr_b16 v[66:67], v7 offset:21504
  s_waitcnt lgkmcnt(4)
  v_mfma_f32_32x32x16_bf16 v[32:47], v[72:75], v[164:167], v[32:47]
  ds_read_b64_tr_b16 v[68:69], v8 offset:20480
  ds_read_b64_tr_b16 v[70:71], v8 offset:21504
  buffer_load_dwordx4 v[208:211], v120, s[28:31], s72 offen offset:0 sc1
  buffer_load_dwordx4 v[212:215], v120, s[28:31], s72 offen offset:1024 sc1
  s_waitcnt vmcnt(12)
  v_max3_u32 v24, v169, v171, v173
  v_cmp_u_f32 vcc, v24, v175
  s_waitcnt lgkmcnt(4)
  v_mfma_f32_32x32x16_bf16 v[48:63], v[76:79], v[164:167], v[48:63]
  ds_read_b64_tr_b16 v[72:73], v7 offset:22528
  ds_read_b64_tr_b16 v[74:75], v7 offset:23552
  s_cbranch_vccnz rel_71
ok_70:
  s_waitcnt lgkmcnt(4)
  v_mfma_f32_32x32x16_bf16 v[32:47], v[64:67], v[168:171], v[32:47]
  ds_read_b64_tr_b16 v[76:77], v8 offset:22528
  ds_read_b64_tr_b16 v[78:79], v8 offset:23552
  buffer_load_dwordx4 v[216:219], v120, s[28:31], s72 offen offset:2048 sc1
  s_waitcnt lgkmcnt(4)
  v_mfma_f32_32x32x16_bf16 v[48:63], v[68:71], v[168:171], v[48:63]
  ds_read_b64_tr_b16 v[64:65], v7 offset:24576
  ds_read_b64_tr_b16 v[66:67], v7 offset:25600
  s_waitcnt lgkmcnt(4)
  v_mfma_f32_32x32x16_bf16 v[32:47], v[72:75], v[172:175], v[32:47]
  ds_read_b64_tr_b16 v[68:69], v8 offset:24576
  ds_read_b64_tr_b16 v[70:71], v8 offset:25600
  buffer_load_dwordx4 v[220:223], v120, s[28:31], s72 offen offset:3072 sc1
  buffer_load_dwordx4 v[224:227], v121, s[28:31], s72 offen offset:0 sc1
  s_waitcnt vmcnt(12)
  v_max3_u32 v24, v177, v179, v181
  v_cmp_u_f32 vcc, v24, v183
  s_waitcnt lgkmcnt(4)
  v_mfma_f32_32x32x16_bf16 v[48:63], v[76:79], v[172:175], v[48:63]
  ds_read_b64_tr_b16 v[72:73], v7 offset:26624
  ds_read_b64_tr_b16 v[74:75], v7 offset:27648
  s_cbranch_vccnz rel_73
ok_72:
  s_waitcnt lgkmcnt(4)
  v_mfma_f32_32x32x16_bf16 v[32:47], v[64:67], v[176:179], v[32:47]
  ds_read_b64_tr_b16 v[76:77], v8 offset:26624
  ds_read_b64_tr_b16 v[78:79], v8 offset:27648
  buffer_load_dwordx4 v[228:231], v121, s[28:31], s72 offen offset:1024 sc1
  s_waitcnt lgkmcnt(4)
  v_mfma_f32_32x32x16_bf16 v[48:63], v[68:71], v[176:179], v[48:63]
  ds_read_b64_tr_b16 v[64:65], v7 offset:28672
  ds_read_b64_tr_b16 v[66:67], v7 offset:29696
  s_waitcnt lgkmcnt(4)
  v_mfma_f32_32x32x16_bf16 v[32:47], v[72:75], v[180:183], v[32:47]
  ds_read_b64_tr_b16 v[68:69], v8 offset:28672
  ds_read_b64_tr_b16 v[70:71], v8 offset:29696
  buffer_load_dwordx4 v[232:235], v121, s[28:31], s72 offen offset:2048 sc1
  buffer_load_dwordx4 v[236:239], v121, s[28:31], s72 offen offset:3072 sc1
  s_waitcnt vmcnt(12)
  v_max3_u32 v24, v185, v187, v189
  v_cmp_u_f32 vcc, v24, v191
  s_waitcnt lgkmcnt(4)
  v_mfma_f32_32x32x16_bf16 v[48:63], v[76:79], v[180:183], v[48:63]
  ds_read_b64_tr_b16 v[72:73], v7 offset:30720
  ds_read_b64_tr_b16 v[74:75], v7 offset:31744
  s_cbranch_vccnz rel_75
ok_74:
  s_waitcnt lgkmcnt(4)
  v_mfma_f32_32x32x16_bf16 v[32:47], v[64:67], v[184:187], v[32:47]
  ds_read_b64_tr_b16 v[76:77], v8 offset:30720
  ds_read_b64_tr_b16 v[78:79], v8 offset:31744
  s_waitcnt lgkmcnt(4)
  v_mfma_f32_32x32x16_bf16 v[48:63], v[68:71], v[184:187], v[48:63]
  ds_read_b64_tr_b16 v[64:65], v7 offset:32768
  ds_read_b64_tr_b16 v[66:67], v7 offset:33792
  s_waitcnt lgkmcnt(4)
  v_mfma_f32_32x32x16_bf16 v[32:47], v[72:75], v[188:191], v[32:47]
  ds_read_b64_tr_b16 v[68:69], v8 offset:32768
  ds_read_b64_tr_b16 v[70:71], v8 offset:33792
  s_waitcnt vmcnt(10)
  v_max3_u32 v24, v193, v195, v197
  v_cmp_u_f32 vcc, v24, v199
  s_waitcnt lgkmcnt(4)
  v_mfma_f32_32x32x16_bf16 v[48:63], v[76:79], v[188:191], v[48:63]
  ds_read_b64_tr_b16 v[72:73], v7 offset:34816
  ds_read_b64_tr_b16 v[74:75], v7 offset:35840
  s_cbranch_vccnz rel_77
ok_76:
  s_waitcnt lgkmcnt(4)
  v_mfma_f32_32x32x16_bf16 v[32:47], v[64:67], v[192:195], v[32:47]
  ds_read_b64_tr_b16 v[76:77], v8 offset:34816
  ds_read_b64_tr_b16 v[78:79], v8 offset:35840
  s_waitcnt lgkmcnt(4)
  v_mfma_f32_32x32x16_bf16 v[48:63], v[68:71], v[192:195], v[48:63]
  ds_read_b64_tr_b16 v[64:65], v7 offset:36864
  ds_read_b64_tr_b16 v[66:67], v7 offset:37888
  s_waitcnt lgkmcnt(4)
  v_mfma_f32_32x32x16_bf16 v[32:47], v[72:75], v[196:199], v[32:47]
  ds_read_b64_tr_b16 v[68:69], v8 offset:36864
  ds_read_b64_tr_b16 v[70:71], v8 offset:37888
  s_waitcnt vmcnt(8)
  v_max3_u32 v24, v201, v203, v205
  v_cmp_u_f32 vcc, v24, v207
  s_waitcnt lgkmcnt(4)
  v_mfma_f32_32x32x16_bf16 v[48:63], v[76:79], v[196:199], v[48:63]
  ds_read_b64_tr_b16 v[72:73], v7 offset:38912
  ds_read_b64_tr_b16 v[74:75], v7 offset:39936
  s_cbranch_vccnz rel_79
ok_78:
  s_waitcnt lgkmcnt(4)
  v_mfma_f32_32x32x16_bf16 v[32:47], v[64:67], v[200:203], v[32:47]
  ds_read_b64_tr_b16 v[76:77], v8 offset:38912
  ds_read_b64_tr_b16 v[78:79], v8 offset:39936
  v_add_f32 v80, v80, v82
  v_add_f32 v81, v81, v83
  s_waitcnt lgkmcnt(4)
  v_mfma_f32_32x32x16_bf16 v[48:63], v[68:71], v[200:203], v[48:63]
  ds_read_b64_tr_b16 v[64:65], v7 offset:40960
  ds_read_b64_tr_b16 v[66:67], v7 offset:41984
  v_add_f32 v80, v80, v84
  v_add_f32 v81, v81, v85
  s_waitcnt lgkmcnt(4)
  v_mfma_f32_32x32x16_bf16 v[32:47], v[72:75], v[204:207], v[32:47]
  ds_read_b64_tr_b16 v[68:69], v8 offset:40960
  ds_read_b64_tr_b16 v[70:71], v8 offset:41984
  v_add_f32 v80, v80, v86
  v_add_f32 v81, v81, v87
  v_add_f32 v80, v80, v88
  s_waitcnt vmcnt(6)
  v_max3_u32 v24, v209, v211, v213
  v_cmp_u_f32 vcc, v24, v215
  s_waitcnt lgkmcnt(4)
  v_mfma_f32_32x32x16_bf16 v[48:63], v[76:79], v[204:207], v[48:63]
  ds_read_b64_tr_b16 v[72:73], v7 offset:43008
  ds_read_b64_tr_b16 v[74:75], v7 offset:44032
  s_cbranch_vccnz rel_81
ok_80:
  v_add_f32 v81, v81, v89
  v_add_f32 v80, v80, v90
  s_waitcnt lgkmcnt(4)
  v_mfma_f32_32x32x16_bf16 v[32:47], v[64:67], v[208:211], v[32:47]
  ds_read_b64_tr_b16 v[76:77], v8 offset:43008
  ds_read_b64_tr_b16 v[78:79], v8 offset:44032
  v_add_f32 v81, v81, v91
  v_add_f32 v80, v80, v92
  v_add_f32 v81, v81, v93
  s_waitcnt lgkmcnt(4)
  v_mfma_f32_32x32x16_bf16 v[48:63], v[68:71], v[208:211], v[48:63]
  ds_read_b64_tr_b16 v[64:65], v7 offset:45056
  ds_read_b64_tr_b16 v[66:67], v7 offset:46080
  v_cmp_u_f32 vcc, v80, v81
  s_cbranch_vccnz rel_83
ok_82:
  v_mov_b32 v82, v80
  s_waitcnt lgkmcnt(4)
  v_mfma_f32_32x32x16_bf16 v[32:47], v[72:75], v[212:215], v[32:47]
  ds_read_b64_tr_b16 v[68:69], v8 offset:45056
  ds_read_b64_tr_b16 v[70:71], v8 offset:46080
  v_mov_b32 v83, v81
  v_permlane32_swap_b32 v80, v82
  s_nop 0
  v_permlane32_swap_b32 v81, v83
  s_waitcnt vmcnt(4)
  v_max3_u32 v24, v217, v219, v221
  v_cmp_u_f32 vcc, v24, v223
  s_waitcnt lgkmcnt(4)
  v_mfma_f32_32x32x16_bf16 v[48:63], v[76:79], v[212:215], v[48:63]
  ds_read_b64_tr_b16 v[72:73], v7 offset:47104
  ds_read_b64_tr_b16 v[74:75], v7 offset:48128
  s_cbranch_vccnz rel_85
ok_84:
  v_add_f32 v80, v80, v82
  v_add_f32 v81, v81, v83
  s_waitcnt lgkmcnt(4)
  v_mfma_f32_32x32x16_bf16 v[32:47], v[64:67], v[216:219], v[32:47]
  ds_read_b64_tr_b16 v[76:77], v8 offset:47104
  ds_read_b64_tr_b16 v[78:79], v8 offset:48128
  v_mul_f32 v80, 0xbb124925, v80
  v_mul_f32 v81, 0x3b124925, v81
  s_waitcnt lgkmcnt(4)
  v_mfma_f32_32x32x16_bf16 v[48:63], v[68:71], v[216:219], v[48:63]
  ds_read_b64_tr_b16 v[64:65], v7 offset:49152
  ds_read_b64_tr_b16 v[66:67], v7 offset:50176
  v_fma_f32 v81, -v80, v80, v81
  v_max_f32 v81, 0, v81
  v_add_f32 v81, 0x3727c5ac, v81
  s_waitcnt lgkmcnt(4)
  v_mfma_f32_32x32x16_bf16 v[32:47], v[72:75], v[220:223], v[32:47]
  ds_read_b64_tr_b16 v[68:69], v8 offset:49152
  ds_read_b64_tr_b16 v[70:71], v8 offset:50176
  v_rsq_f32 v82, v81
  v_sqrt_f32 v23, v81
  s_waitcnt vmcnt(2)
  v_max3_u32 v24, v225, v227, v229
  v_cmp_u_f32 vcc, v24, v231
  s_waitcnt lgkmcnt(4)
  v_mfma_f32_32x32x16_bf16 v[48:63], v[76:79], v[220:223], v[48:63]
  ds_read_b64_tr_b16 v[72:73], v7 offset:51200
  ds_read_b64_tr_b16 v[74:75], v7 offset:52224
  s_cbranch_vccnz rel_87
ok_86:
  v_cvt_pk_bf16_f32 v112, v80, v80
  v_and_b32 v83, 0xffff0000, v112
  v_sub_f32 v83, v80, v83
  s_waitcnt lgkmcnt(4)
  v_mfma_f32_32x32x16_bf16 v[32:47], v[64:67], v[224:227], v[32:47]
  ds_read_b64_tr_b16 v[76:77], v8 offset:51200
  ds_read_b64_tr_b16 v[78:79], v8 offset:52224
  v_cvt_pk_bf16_f32 v112, v80, v83
  v_mov_b32 v113, v112
  s_waitcnt lgkmcnt(4)
  v_mfma_f32_32x32x16_bf16 v[48:63], v[68:71], v[224:227], v[48:63]
  ds_read_b64_tr_b16 v[64:65], v7 offset:53248
  ds_read_b64_tr_b16 v[66:67], v7 offset:54272
  v_cvt_pk_bf16_f32 v114, v23, v23
  v_and_b32 v83, 0xffff0000, v114
  v_sub_f32 v83, v23, v83
  s_waitcnt lgkmcnt(4)
  v_mfma_f32_32x32x16_bf16 v[32:47], v[72:75], v[228:231], v[32:47]
  ds_read_b64_tr_b16 v[68:69], v8 offset:53248
  ds_read_b64_tr_b16 v[70:71], v8 offset:54272
  v_cvt_pk_bf16_f32 v114, v23, v83
  v_mul_f32 v21, 0xc0135761, v82
  s_waitcnt vmcnt(0)
  v_max3_u32 v24, v233, v235, v237
  v_cmp_u_f32 vcc, v24, v239
  s_waitcnt lgkmcnt(4)
  v_mfma_f32_32x32x16_bf16 v[48:63], v[76:79], v[228:231], v[48:63]
  ds_read_b64_tr_b16 v[72:73], v7 offset:55296
  ds_read_b64_tr_b16 v[74:75], v7 offset:56320
  s_cbranch_vccnz rel_89
ok_88:
  v_mul_f32 v83, v82, v82
  v_mul_f32 v22, 0x3d372713, v21
  v_mul_f32 v22, v22, v83
  s_waitcnt lgkmcnt(4)
  v_mfma_f32_32x32x16_bf16 v[32:47], v[64:67], v[232:235], v[32:47]
  ds_read_b64_tr_b16 v[76:77], v8 offset:55296
  ds_read_b64_tr_b16 v[78:79], v8 offset:56320
  v_add_u32 v7, 57344, v7
  s_waitcnt lgkmcnt(4)
  v_mfma_f32_32x32x16_bf16 v[48:63], v[68:71], v[232:235], v[48:63]
  ds_read_b64_tr_b16 v[64:65], v7 offset:0
  ds_read_b64_tr_b16 v[66:67], v7 offset:1024
  s_waitcnt lgkmcnt(4)
  v_mfma_f32_32x32x16_bf16 v[32:47], v[72:75], v[236:239], v[32:47]
  ds_read_b64_tr_b16 v[68:69], v7 offset:2048
  ds_read_b64_tr_b16 v[70:71], v7 offset:3072
  s_waitcnt lgkmcnt(4)
  v_mfma_f32_32x32x16_bf16 v[48:63], v[76:79], v[236:239], v[48:63]
  ds_read_b64_tr_b16 v[72:73], v7 offset:4096
  ds_read_b64_tr_b16 v[74:75], v7 offset:5120
  v_mfma_f32_32x32x16_bf16 v[32:47], v[96:99], v[112:115], v[32:47]
  v_mfma_f32_32x32x16_bf16 v[48:63], v[100:103], v[112:115], v[48:63]
  s_waitcnt lgkmcnt(4)
  v_mfma_f32_32x32x16_bf16 v[96:111], v[64:67], v[128:131], 0
  ds_read_b64_tr_b16 v[76:77], v7 offset:6144
  ds_read_b64_tr_b16 v[78:79], v7 offset:7168
  s_mov_b32 m0, s62
  s_add_u32 s24, s24, s60
  s_addc_u32 s25, s25, 0
  global_load_lds_dwordx4 v3, s[24:25] offset:0
  global_load_lds_dwordx4 v4, s[24:25] offset:1024
  global_load_lds_dwordx4 v5, s[24:25] offset:2048
  global_load_lds_dwordx4 v6, s[24:25] offset:3072
  s_waitcnt lgkmcnt(4)
  v_mfma_f32_32x32x16_bf16 v[96:111], v[68:71], v[132:135], v[96:111]
  ds_read_b64_tr_b16 v[64:65], v7 offset:8192
  ds_read_b64_tr_b16 v[66:67], v7 offset:9216
  s_add_u32 m0, s62, 4096
  s_add_u32 s24, s24, s61
  s_addc_u32 s25, s25, 0
  global_load_lds_dwordx4 v3, s[24:25] offset:0
  global_load_lds_dwordx4 v4, s[24:25] offset:1024
  global_load_lds_dwordx4 v5, s[24:25] offset:2048
  global_load_lds_dwordx4 v6, s[24:25] offset:3072
  v_mul_f32 v116, v32, v32
  v_mul_f32 v117, v33, v33
  v_mul_f32 v118, v34, v34
  v_mul_f32 v119, v35, v35
  v_mul_f32 v120, v36, v36
  v_mul_f32 v121, v37, v37
  v_mul_f32 v122, v38, v38
  v_mul_f32 v123, v39, v39
  v_fma_f32 v116, v116, v22, v21
  v_fma_f32 v117, v117, v22, v21
  v_fma_f32 v118, v118, v22, v21
  v_fma_f32 v119, v119, v22, v21
  v_fma_f32 v120, v120, v22, v21
  s_waitcnt lgkmcnt(4)
  v_mfma_f32_32x32x16_bf16 v[96:111], v[72:75], v[136:139], v[96:111]
  ds_read_b64_tr_b16 v[68:69], v7 offset:10240
  ds_read_b64_tr_b16 v[70:71], v7 offset:11264
  s_add_u32 m0, s62, 8192
  s_add_u32 s24, s24, s60
  s_addc_u32 s25, s25, 0
  global_load_lds_dwordx4 v3, s[24:25] offset:0
  global_load_lds_dwordx4 v4, s[24:25] offset:1024
  global_load_lds_dwordx4 v5, s[24:25] offset:2048
  global_load_lds_dwordx4 v6, s[24:25] offset:3072
  v_fma_f32 v121, v121, v22, v21
  v_fma_f32 v122, v122, v22, v21
  v_fma_f32 v123, v123, v22, v21
  v_mul_f32 v116, v116, v32
  v_mul_f32 v117, v117, v33
  v_mul_f32 v118, v118, v34
  v_mul_f32 v119, v119, v35
  v_mul_f32 v120, v120, v36
  v_mul_f32 v121, v121, v37
  v_mul_f32 v122, v122, v38
  v_mul_f32 v123, v123, v39
  v_exp_f32 v116, v116
  v_exp_f32 v117, v117
  s_waitcnt lgkmcnt(4)
  v_mfma_f32_32x32x16_bf16 v[96:111], v[76:79], v[140:143], v[96:111]
  ds_read_b64_tr_b16 v[72:73], v7 offset:12288
  ds_read_b64_tr_b16 v[74:75], v7 offset:13312
  v_exp_f32 v118, v118
  v_exp_f32 v119, v119
  v_exp_f32 v120, v120
  v_exp_f32 v121, v121
  v_exp_f32 v122, v122
  v_exp_f32 v123, v123
  v_fma_f32 v116, v116, v23, v23
  v_fma_f32 v117, v117, v23, v23
  v_fma_f32 v118, v118, v23, v23
  v_fma_f32 v119, v119, v23, v23
  v_fma_f32 v120, v120, v23, v23
  v_fma_f32 v121, v121, v23, v23
  v_fma_f32 v122, v122, v23, v23
  v_fma_f32 v123, v123, v23, v23
  s_waitcnt lgkmcnt(4)
  v_mfma_f32_32x32x16_bf16 v[96:111], v[64:67], v[144:147], v[96:111]
  ds_read_b64_tr_b16 v[76:77], v7 offset:14336
  ds_read_b64_tr_b16 v[78:79], v7 offset:15360
  v_rcp_f32 v116, v116
  v_rcp_f32 v117, v117
  v_rcp_f32 v118, v118
  v_rcp_f32 v119, v119
  v_rcp_f32 v120, v120
  v_rcp_f32 v121, v121
  v_rcp_f32 v122, v122
  v_rcp_f32 v123, v123
  v_mul_f32 v32, v32, v116
  v_mul_f32 v33, v33, v117
  v_mul_f32 v34, v34, v118
  v_mul_f32 v35, v35, v119
  v_mul_f32 v36, v36, v120
  s_waitcnt lgkmcnt(4)
  v_mfma_f32_32x32x16_bf16 v[96:111], v[68:71], v[148:151], v[96:111]
  ds_read_b64_tr_b16 v[64:65], v7 offset:16384
  ds_read_b64_tr_b16 v[66:67], v7 offset:17408
  v_mul_f32 v37, v37, v121
  v_mul_f32 v38, v38, v122
  v_mul_f32 v39, v39, v123
  v_cvt_pk_bf16_f32 v80, v32, v33
  v_cvt_pk_bf16_f32 v81, v34, v35
  v_cvt_pk_bf16_f32 v82, v36, v37
  v_cvt_pk_bf16_f32 v83, v38, v39
  v_mul_f32 v116, v40, v40
  v_mul_f32 v117, v41, v41
  v_mul_f32 v118, v42, v42
  v_mul_f32 v119, v43, v43
  v_mul_f32 v120, v44, v44
  v_mul_f32 v121, v45, v45
  s_waitcnt lgkmcnt(4)
  v_mfma_f32_32x32x16_bf16 v[96:111], v[72:75], v[152:155], v[96:111]
  ds_read_b64_tr_b16 v[68:69], v7 offset:18432
  ds_read_b64_tr_b16 v[70:71], v7 offset:19456
  v_mul_f32 v122, v46, v46
  v_mul_f32 v123, v47, v47
  v_fma_f32 v116, v116, v22, v21
  v_fma_f32 v117, v117, v22, v21
  v_fma_f32 v118, v118, v22, v21
  v_fma_f32 v119, v119, v22, v21
  v_fma_f32 v120, v120, v22, v21
  v_fma_f32 v121, v121, v22, v21
  v_fma_f32 v122, v122, v22, v21
  v_fma_f32 v123, v123, v22, v21
  v_mul_f32 v116, v116, v40
  v_mul_f32 v117, v117, v41
  v_mul_f32 v118, v118, v42
  v_mul_f32 v119, v119, v43
  s_waitcnt lgkmcnt(4)
  v_mfma_f32_32x32x16_bf16 v[96:111], v[76:79], v[156:159], v[96:111]
  ds_read_b64_tr_b16 v[72:73], v7 offset:20480
  ds_read_b64_tr_b16 v[74:75], v7 offset:21504
  v_mul_f32 v120, v120, v44
  v_mul_f32 v121, v121, v45
  v_mul_f32 v122, v122, v46
  v_mul_f32 v123, v123, v47
  v_exp_f32 v116, v116
  v_exp_f32 v117, v117
  v_exp_f32 v118, v118
  v_exp_f32 v119, v119
  v_exp_f32 v120, v120
  v_exp_f32 v121, v121
  v_exp_f32 v122, v122
  v_exp_f32 v123, v123
  v_fma_f32 v116, v116, v23, v23
  s_waitcnt lgkmcnt(4)
  v_mfma_f32_32x32x16_bf16 v[96:111], v[64:67], v[160:163], v[96:111]
  ds_read_b64_tr_b16 v[76:77], v7 offset:22528
  ds_read_b64_tr_b16 v[78:79], v7 offset:23552
  v_fma_f32 v117, v117, v23, v23
  v_fma_f32 v118, v118, v23, v23
  v_fma_f32 v119, v119, v23, v23
  v_fma_f32 v120, v120, v23, v23
  v_fma_f32 v121, v121, v23, v23
  v_fma_f32 v122, v122, v23, v23
  v_fma_f32 v123, v123, v23, v23
  v_rcp_f32 v116, v116
  v_rcp_f32 v117, v117
  v_rcp_f32 v118, v118
  v_rcp_f32 v119, v119
  v_rcp_f32 v120, v120
  v_rcp_f32 v121, v121
  s_waitcnt lgkmcnt(4)
  v_mfma_f32_32x32x16_bf16 v[96:111], v[68:71], v[164:167], v[96:111]
  ds_read_b64_tr_b16 v[64:65], v7 offset:24576
  ds_read_b64_tr_b16 v[66:67], v7 offset:25600
  v_rcp_f32 v122, v122
  v_rcp_f32 v123, v123
  v_mul_f32 v40, v40, v116
  v_mul_f32 v41, v41, v117
  v_mul_f32 v42, v42, v118
  v_mul_f32 v43, v43, v119
  v_mul_f32 v44, v44, v120
  v_mul_f32 v45, v45, v121
  v_mul_f32 v46, v46, v122
  v_mul_f32 v47, v47, v123
  v_cvt_pk_bf16_f32 v84, v40, v41
  v_cvt_pk_bf16_f32 v85, v42, v43
  v_cvt_pk_bf16_f32 v86, v44, v45
  v_cvt_pk_bf16_f32 v87, v46, v47
  buffer_store_dwordx4 v[80:83], v1, s[28:31], s67 offen offset:0 sc1
  buffer_store_dwordx4 v[84:87], v1, s[28:31], s67 offen offset:1024 sc1
  s_waitcnt lgkmcnt(4)
  v_mfma_f32_32x32x16_bf16 v[96:111], v[72:75], v[168:171], v[96:111]
  ds_read_b64_tr_b16 v[68:69], v7 offset:26624
  ds_read_b64_tr_b16 v[70:71], v7 offset:27648
  v_mul_f32 v116, v48, v48
  v_mul_f32 v117, v49, v49
  v_mul_f32 v118, v50, v50
  v_mul_f32 v119, v51, v51
  v_mul_f32 v120, v52, v52
  v_mul_f32 v121, v53, v53
  s_waitcnt lgkmcnt(4)
  v_mfma_f32_32x32x16_bf16 v[96:111], v[76:79], v[172:175], v[96:111]
  ds_read_b64_tr_b16 v[72:73], v7 offset:28672
  ds_read_b64_tr_b16 v[74:75], v7 offset:29696
  v_mul_f32 v122, v54, v54
  v_mul_f32 v123, v55, v55
  v_fma_f32 v116, v116, v22, v21
  v_fma_f32 v117, v117, v22, v21
  v_fma_f32 v118, v118, v22, v21
  v_fma_f32 v119, v119, v22, v21
  v_fma_f32 v120, v120, v22, v21
  s_waitcnt lgkmcnt(4)
  v_mfma_f32_32x32x16_bf16 v[96:111], v[64:67], v[176:179], v[96:111]
  ds_read_b64_tr_b16 v[76:77], v7 offset:30720
  ds_read_b64_tr_b16 v[78:79], v7 offset:31744
  v_fma_f32 v121, v121, v22, v21
  v_fma_f32 v122, v122, v22, v21
  v_fma_f32 v123, v123, v22, v21
  v_mul_f32 v116, v116, v48
  v_mul_f32 v117, v117, v49
  v_mul_f32 v118, v118, v50
  v_mul_f32 v119, v119, v51
  s_waitcnt lgkmcnt(4)
  v_mfma_f32_32x32x16_bf16 v[96:111], v[68:71], v[180:183], v[96:111]
  ds_read_b64_tr_b16 v[64:65], v7 offset:32768
  ds_read_b64_tr_b16 v[66:67], v7 offset:33792
  v_mul_f32 v120, v120, v52
  v_mul_f32 v121, v121, v53
  v_mul_f32 v122, v122, v54
  v_mul_f32 v123, v123, v55
  v_exp_f32 v116, v116
  v_exp_f32 v117, v117
  s_waitcnt lgkmcnt(4)
  v_mfma_f32_32x32x16_bf16 v[96:111], v[72:75], v[184:187], v[96:111]
  ds_read_b64_tr_b16 v[68:69], v7 offset:34816
  ds_read_b64_tr_b16 v[70:71], v7 offset:35840
  v_exp_f32 v118, v118
  v_exp_f32 v119, v119
  v_exp_f32 v120, v120
  v_exp_f32 v121, v121
  v_exp_f32 v122, v122
  v_exp_f32 v123, v123
  v_fma_f32 v116, v116, v23, v23
  s_waitcnt lgkmcnt(4)
  v_mfma_f32_32x32x16_bf16 v[96:111], v[76:79], v[188:191], v[96:111]
  ds_read_b64_tr_b16 v[72:73], v7 offset:36864
  ds_read_b64_tr_b16 v[74:75], v7 offset:37888
  v_fma_f32 v117, v117, v23, v23
  v_fma_f32 v118, v118, v23, v23
  v_fma_f32 v119, v119, v23, v23
  v_fma_f32 v120, v120, v23, v23
  v_fma_f32 v121, v121, v23, v23
  v_fma_f32 v122, v122, v23, v23
  v_fma_f32 v123, v123, v23, v23
  s_waitcnt lgkmcnt(4)
  v_mfma_f32_32x32x16_bf16 v[96:111], v[64:67], v[192:195], v[96:111]
  ds_read_b64_tr_b16 v[76:77], v7 offset:38912
  ds_read_b64_tr_b16 v[78:79], v7 offset:39936
  s_waitcnt vmcnt(10)
  ds_read_b64_tr_b16 a[138:139], v11 offset:1024
  ds_read_b64_tr_b16 a[136:137], v11 offset:0
  v_rcp_f32 v116, v116
  v_rcp_f32 v117, v117
  v_rcp_f32 v118, v118
  v_rcp_f32 v119, v119
  v_rcp_f32 v120, v120
  v_rcp_f32 v121, v121
  s_waitcnt lgkmcnt(6)
  v_mfma_f32_32x32x16_bf16 v[96:111], v[68:71], v[196:199], v[96:111]
  ds_read_b64_tr_b16 v[64:65], v7 offset:40960
  ds_read_b64_tr_b16 v[66:67], v7 offset:41984
  ds_read_b64_tr_b16 a[142:143], v12 offset:1024
  ds_read_b64_tr_b16 a[140:141], v12 offset:0
  v_rcp_f32 v122, v122
  v_rcp_f32 v123, v123
  v_mul_f32 v48, v48, v116
  v_mul_f32 v49, v49, v117
  v_mul_f32 v50, v50, v118
  v_mul_f32 v51, v51, v119
  v_mul_f32 v52, v52, v120
  s_waitcnt lgkmcnt(8)
  v_mfma_f32_32x32x16_bf16 v[96:111], v[72:75], v[200:203], v[96:111]
  ds_read_b64_tr_b16 v[68:69], v7 offset:43008
  ds_read_b64_tr_b16 v[70:71], v7 offset:44032
  ds_read_b64_tr_b16 a[194:195], v11 offset:3072
  ds_read_b64_tr_b16 a[192:193], v11 offset:2048
  v_mul_f32 v53, v53, v121
  v_mul_f32 v54, v54, v122
  v_mul_f32 v55, v55, v123
  v_cvt_pk_bf16_f32 v88, v48, v49
  v_cvt_pk_bf16_f32 v89, v50, v51
  v_cvt_pk_bf16_f32 v90, v52, v53
  v_cvt_pk_bf16_f32 v91, v54, v55
  s_waitcnt lgkmcnt(10)
  v_mfma_f32_32x32x16_bf16 v[96:111], v[76:79], v[204:207], v[96:111]
  ds_read_b64_tr_b16 v[72:73], v7 offset:45056
  ds_read_b64_tr_b16 v[74:75], v7 offset:46080
  ds_read_b64_tr_b16 a[198:199], v12 offset:3072
  ds_read_b64_tr_b16 a[196:197], v12 offset:2048
  v_mul_f32 v116, v56, v56
  v_mul_f32 v117, v57, v57
  v_mul_f32 v118, v58, v58
  v_mul_f32 v119, v59, v59
  v_mul_f32 v120, v60, v60
  v_mul_f32 v121, v61, v61
  s_waitcnt lgkmcnt(10)
  v_mfma_f32_32x32x16_bf16 v[96:111], v[64:67], v[208:211], v[96:111]
  ds_read_b64_tr_b16 v[76:77], v7 offset:47104
  ds_read_b64_tr_b16 v[78:79], v7 offset:48128
  v_mul_f32 v122, v62, v62
  v_mul_f32 v123, v63, v63
  v_fma_f32 v116, v116, v22, v21
  v_fma_f32 v117, v117, v22, v21
  v_fma_f32 v118, v118, v22, v21
  v_fma_f32 v119, v119, v22, v21
  v_fma_f32 v120, v120, v22, v21
  s_waitcnt lgkmcnt(8)
  v_mfma_f32_32x32x16_bf16 v[96:111], v[68:71], v[212:215], v[96:111]
  ds_read_b64_tr_b16 v[64:65], v7 offset:49152
  ds_read_b64_tr_b16 v[66:67], v7 offset:50176
  v_fma_f32 v121, v121, v22, v21
  v_fma_f32 v122, v122, v22, v21
  v_fma_f32 v123, v123, v22, v21
  v_mul_f32 v116, v116, v56
  v_mul_f32 v117, v117, v57
  v_mul_f32 v118, v118, v58
  v_mul_f32 v119, v119, v59
  s_waitcnt lgkmcnt(6)
  v_mfma_f32_32x32x16_bf16 v[96:111], v[72:75], v[216:219], v[96:111]
  ds_read_b64_tr_b16 v[68:69], v7 offset:51200
  ds_read_b64_tr_b16 v[70:71], v7 offset:52224
  v_mul_f32 v120, v120, v60
  v_mul_f32 v121, v121, v61
  v_mul_f32 v122, v122, v62
  v_mul_f32 v123, v123, v63
  v_exp_f32 v116, v116
  v_exp_f32 v117, v117
  s_waitcnt lgkmcnt(4)
  v_mfma_f32_32x32x16_bf16 v[96:111], v[76:79], v[220:223], v[96:111]
  ds_read_b64_tr_b16 v[72:73], v7 offset:53248
  ds_read_b64_tr_b16 v[74:75], v7 offset:54272
  v_exp_f32 v118, v118
  v_exp_f32 v119, v119
  v_exp_f32 v120, v120
  v_exp_f32 v121, v121
  v_exp_f32 v122, v122
  v_exp_f32 v123, v123
  v_fma_f32 v116, v116, v23, v23
  s_waitcnt lgkmcnt(4)
  v_mfma_f32_32x32x16_bf16 v[96:111], v[64:67], v[224:227], v[96:111]
  ds_read_b64_tr_b16 v[76:77], v7 offset:55296
  ds_read_b64_tr_b16 v[78:79], v7 offset:56320
  s_mov_b32 m0, s62
  s_add_u32 s24, s24, s61
  s_addc_u32 s25, s25, 0
  global_load_lds_dwordx4 v3, s[24:25] offset:0
  global_load_lds_dwordx4 v4, s[24:25] offset:1024
  global_load_lds_dwordx4 v5, s[24:25] offset:2048
  global_load_lds_dwordx4 v6, s[24:25] offset:3072
  v_fma_f32 v117, v117, v23, v23
  v_fma_f32 v118, v118, v23, v23
  v_fma_f32 v119, v119, v23, v23
  v_fma_f32 v120, v120, v23, v23
  v_fma_f32 v121, v121, v23, v23
  v_fma_f32 v122, v122, v23, v23
  v_fma_f32 v123, v123, v23, v23
  v_add_u32 v8, 57344, v8
  s_waitcnt lgkmcnt(4)
  v_mfma_f32_32x32x16_bf16 v[96:111], v[68:71], v[228:231], v[96:111]
  ds_read_b64_tr_b16 v[64:65], v8 offset:0
  ds_read_b64_tr_b16 v[66:67], v8 offset:1024
  v_rcp_f32 v116, v116
  v_rcp_f32 v117, v117
  v_rcp_f32 v118, v118
  v_rcp_f32 v119, v119
  v_rcp_f32 v120, v120
  v_rcp_f32 v121, v121
  s_waitcnt lgkmcnt(4)
  v_mfma_f32_32x32x16_bf16 v[96:111], v[72:75], v[232:235], v[96:111]
  ds_read_b64_tr_b16 v[68:69], v8 offset:2048
  ds_read_b64_tr_b16 v[70:71], v8 offset:3072
  v_rcp_f32 v122, v122
  v_rcp_f32 v123, v123
  v_mul_f32 v56, v56, v116
  v_mul_f32 v57, v57, v117
  v_mul_f32 v58, v58, v118
  v_mul_f32 v59, v59, v119
  v_mul_f32 v60, v60, v120
  s_waitcnt lgkmcnt(4)
  v_mfma_f32_32x32x16_bf16 v[96:111], v[76:79], v[236:239], v[96:111]
  ds_read_b64_tr_b16 v[72:73], v8 offset:4096
  ds_read_b64_tr_b16 v[74:75], v8 offset:5120
  v_mul_f32 v61, v61, v121
  v_mul_f32 v62, v62, v122
  v_mul_f32 v63, v63, v123
  v_cvt_pk_bf16_f32 v92, v56, v57
  v_cvt_pk_bf16_f32 v93, v58, v59
  v_cvt_pk_bf16_f32 v94, v60, v61
  v_cvt_pk_bf16_f32 v95, v62, v63
  buffer_store_dwordx4 v[88:91], v1, s[28:31], s67 offen offset:2048 sc1
  buffer_store_dwordx4 v[92:95], v1, s[28:31], s67 offen offset:3072 sc1
  v_mfma_f32_32x32x16_bf16 v[96:111], a[224:227], v[112:115], v[96:111]
  s_waitcnt lgkmcnt(4)
  v_mfma_f32_32x32x16_bf16 v[48:63], v[64:67], v[128:131], 0
  ds_read_b64_tr_b16 v[76:77], v8 offset:6144
  ds_read_b64_tr_b16 v[78:79], v8 offset:7168
  s_waitcnt lgkmcnt(4)
  v_mfma_f32_32x32x16_bf16 v[48:63], v[68:71], v[132:135], v[48:63]
  ds_read_b64_tr_b16 v[64:65], v8 offset:8192
  ds_read_b64_tr_b16 v[66:67], v8 offset:9216
  s_waitcnt lgkmcnt(4)
  v_mfma_f32_32x32x16_bf16 v[48:63], v[72:75], v[136:139], v[48:63]
  ds_read_b64_tr_b16 v[68:69], v8 offset:10240
  ds_read_b64_tr_b16 v[70:71], v8 offset:11264
  v_mul_f32 v116, v96, v96
  v_mul_f32 v117, v97, v97
  v_mul_f32 v118, v98, v98
  v_mul_f32 v119, v99, v99
  v_mul_f32 v120, v100, v100
  v_mul_f32 v121, v101, v101
  s_waitcnt lgkmcnt(4)
  v_mfma_f32_32x32x16_bf16 v[48:63], v[76:79], v[140:143], v[48:63]
  ds_read_b64_tr_b16 v[72:73], v8 offset:12288
  ds_read_b64_tr_b16 v[74:75], v8 offset:13312
  v_mul_f32 v122, v102, v102
  v_mul_f32 v123, v103, v103
  v_fma_f32 v116, v116, v22, v21
  v_fma_f32 v117, v117, v22, v21
  v_fma_f32 v118, v118, v22, v21
  v_fma_f32 v119, v119, v22, v21
  s_waitcnt lgkmcnt(4)
  v_mfma_f32_32x32x16_bf16 v[48:63], v[64:67], v[144:147], v[48:63]
  ds_read_b64_tr_b16 v[76:77], v8 offset:14336
  ds_read_b64_tr_b16 v[78:79], v8 offset:15360
  v_fma_f32 v120, v120, v22, v21
  v_fma_f32 v121, v121, v22, v21
  v_fma_f32 v122, v122, v22, v21
  v_fma_f32 v123, v123, v22, v21
  v_mul_f32 v116, v116, v96
  v_mul_f32 v117, v117, v97
  s_waitcnt lgkmcnt(4)
  v_mfma_f32_32x32x16_bf16 v[48:63], v[68:71], v[148:151], v[48:63]
  ds_read_b64_tr_b16 v[64:65], v8 offset:16384
  ds_read_b64_tr_b16 v[66:67], v8 offset:17408
  v_mul_f32 v118, v118, v98
  v_mul_f32 v119, v119, v99
  v_mul_f32 v120, v120, v100
  v_mul_f32 v121, v121, v101
  v_mul_f32 v122, v122, v102
  v_mul_f32 v123, v123, v103
  s_waitcnt lgkmcnt(4)
  v_mfma_f32_32x32x16_bf16 v[48:63], v[72:75], v[152:155], v[48:63]
  ds_read_b64_tr_b16 v[68:69], v8 offset:18432
  ds_read_b64_tr_b16 v[70:71], v8 offset:19456
  v_exp_f32 v116, v116
  v_exp_f32 v117, v117
  v_exp_f32 v118, v118
  v_exp_f32 v119, v119
  v_exp_f32 v120, v120
  v_exp_f32 v121, v121
  s_waitcnt lgkmcnt(4)
  v_mfma_f32_32x32x16_bf16 v[48:63], v[76:79], v[156:159], v[48:63]
  ds_read_b64_tr_b16 v[72:73], v8 offset:20480
  ds_read_b64_tr_b16 v[74:75], v8 offset:21504
  v_exp_f32 v122, v122
  v_exp_f32 v123, v123
  v_fma_f32 v116, v116, v23, v23
  v_fma_f32 v117, v117, v23, v23
  v_fma_f32 v118, v118, v23, v23
  v_fma_f32 v119, v119, v23, v23
  s_waitcnt lgkmcnt(4)
  v_mfma_f32_32x32x16_bf16 v[48:63], v[64:67], v[160:163], v[48:63]
  ds_read_b64_tr_b16 v[76:77], v8 offset:22528
  ds_read_b64_tr_b16 v[78:79], v8 offset:23552
  buffer_load_dwordx4 v[132:135], v10, s[28:31], s57 offen offset:0 sc1
  v_fma_f32 v120, v120, v23, v23
  v_fma_f32 v121, v121, v23, v23
  v_fma_f32 v122, v122, v23, v23
  v_fma_f32 v123, v123, v23, v23
  v_rcp_f32 v116, v116
  v_rcp_f32 v117, v117
  s_waitcnt lgkmcnt(4)
  v_mfma_f32_32x32x16_bf16 v[48:63], v[68:71], v[164:167], v[48:63]
  ds_read_b64_tr_b16 v[64:65], v8 offset:24576
  ds_read_b64_tr_b16 v[66:67], v8 offset:25600
  buffer_load_dwordx4 v[128:131], v9, s[28:31], s57 offen offset:0 sc1
  v_rcp_f32 v118, v118
  v_rcp_f32 v119, v119
  v_rcp_f32 v120, v120
  v_rcp_f32 v121, v121
  v_rcp_f32 v122, v122
  v_rcp_f32 v123, v123
  s_waitcnt lgkmcnt(4)
  v_mfma_f32_32x32x16_bf16 v[48:63], v[72:75], v[168:171], v[48:63]
  ds_read_b64_tr_b16 v[68:69], v8 offset:26624
  ds_read_b64_tr_b16 v[70:71], v8 offset:27648
  buffer_load_dwordx4 v[140:143], v10, s[28:31], s58 offen offset:0 sc1
  v_mul_f32 v96, v96, v116
  v_mul_f32 v97, v97, v117
  v_mul_f32 v98, v98, v118
  v_mul_f32 v99, v99, v119
  v_mul_f32 v100, v100, v120
  v_mul_f32 v101, v101, v121
  s_waitcnt lgkmcnt(4)
  v_mfma_f32_32x32x16_bf16 v[48:63], v[76:79], v[172:175], v[48:63]
  ds_read_b64_tr_b16 v[72:73], v8 offset:28672
  ds_read_b64_tr_b16 v[74:75], v8 offset:29696
  v_mul_f32 v102, v102, v122
  v_mul_f32 v103, v103, v123
  v_cvt_pk_bf16_f32 v80, v96, v97
  v_cvt_pk_bf16_f32 v81, v98, v99
  v_cvt_pk_bf16_f32 v82, v100, v101
  v_cvt_pk_bf16_f32 v83, v102, v103
  s_waitcnt lgkmcnt(4)
  v_mfma_f32_32x32x16_bf16 v[48:63], v[64:67], v[176:179], v[48:63]
  ds_read_b64_tr_b16 v[76:77], v8 offset:30720
  ds_read_b64_tr_b16 v[78:79], v8 offset:31744
  buffer_load_dwordx4 v[136:139], v9, s[28:31], s58 offen offset:0 sc1
  v_mul_f32 v116, v104, v104
  v_mul_f32 v117, v105, v105
  v_mul_f32 v118, v106, v106
  v_mul_f32 v119, v107, v107
  v_mul_f32 v120, v108, v108
  v_mul_f32 v121, v109, v109
  s_waitcnt lgkmcnt(4)
  v_mfma_f32_32x32x16_bf16 v[48:63], v[68:71], v[180:183], v[48:63]
  ds_read_b64_tr_b16 v[64:65], v8 offset:32768
  ds_read_b64_tr_b16 v[66:67], v8 offset:33792
  buffer_load_dwordx4 v[148:151], v10, s[28:31], s52 offen offset:0 sc1
  v_mul_f32 v122, v110, v110
  v_mul_f32 v123, v111, v111
  v_fma_f32 v116, v116, v22, v21
  v_fma_f32 v117, v117, v22, v21
  v_fma_f32 v118, v118, v22, v21
  v_fma_f32 v119, v119, v22, v21
  s_waitcnt lgkmcnt(4)
  v_mfma_f32_32x32x16_bf16 v[48:63], v[72:75], v[184:187], v[48:63]
  ds_read_b64_tr_b16 v[68:69], v8 offset:34816
  ds_read_b64_tr_b16 v[70:71], v8 offset:35840
  buffer_load_dwordx4 v[144:147], v9, s[28:31], s52 offen offset:0 sc1
  v_fma_f32 v120, v120, v22, v21
  v_fma_f32 v121, v121, v22, v21
  v_fma_f32 v122, v122, v22, v21
  v_fma_f32 v123, v123, v22, v21
  v_mul_f32 v116, v116, v104
  v_mul_f32 v117, v117, v105
  s_waitcnt lgkmcnt(4)
  v_mfma_f32_32x32x16_bf16 v[48:63], v[76:79], v[188:191], v[48:63]
  ds_read_b64_tr_b16 v[72:73], v8 offset:36864
  ds_read_b64_tr_b16 v[74:75], v8 offset:37888
  buffer_load_dwordx4 v[156:159], v10, s[28:31], s49 offen offset:0 sc1
  v_mul_f32 v118, v118, v106
  v_mul_f32 v119, v119, v107
  v_mul_f32 v120, v120, v108
  v_mul_f32 v121, v121, v109
  v_mul_f32 v122, v122, v110
  v_mul_f32 v123, v123, v111
  s_waitcnt lgkmcnt(4)
  v_mfma_f32_32x32x16_bf16 v[48:63], v[64:67], v[192:195], v[48:63]
  ds_read_b64_tr_b16 v[76:77], v8 offset:38912
  ds_read_b64_tr_b16 v[78:79], v8 offset:39936
  v_exp_f32 v116, v116
  v_exp_f32 v117, v117
  v_exp_f32 v118, v118
  v_exp_f32 v119, v119
  v_exp_f32 v120, v120
  v_exp_f32 v121, v121
  s_waitcnt lgkmcnt(4)
  v_mfma_f32_32x32x16_bf16 v[48:63], v[68:71], v[196:199], v[48:63]
  ds_read_b64_tr_b16 v[64:65], v8 offset:40960
  ds_read_b64_tr_b16 v[66:67], v8 offset:41984
  buffer_load_dwordx4 v[152:155], v9, s[28:31], s49 offen offset:0 sc1
  v_exp_f32 v122, v122
  v_exp_f32 v123, v123
  v_fma_f32 v116, v116, v23, v23
  v_fma_f32 v117, v117, v23, v23
  v_fma_f32 v118, v118, v23, v23
  v_fma_f32 v119, v119, v23, v23
  s_waitcnt lgkmcnt(4)
  v_mfma_f32_32x32x16_bf16 v[48:63], v[72:75], v[200:203], v[48:63]
  ds_read_b64_tr_b16 v[68:69], v8 offset:43008
  ds_read_b64_tr_b16 v[70:71], v8 offset:44032
  buffer_load_dwordx4 v[164:167], v10, s[28:31], s50 offen offset:0 sc1
  v_fma_f32 v120, v120, v23, v23
  v_fma_f32 v121, v121, v23, v23
  v_fma_f32 v122, v122, v23, v23
  v_fma_f32 v123, v123, v23, v23
  v_rcp_f32 v116, v116
  v_rcp_f32 v117, v117
  s_waitcnt lgkmcnt(4)
  v_mfma_f32_32x32x16_bf16 v[48:63], v[76:79], v[204:207], v[48:63]
  ds_read_b64_tr_b16 v[72:73], v8 offset:45056
  ds_read_b64_tr_b16 v[74:75], v8 offset:46080
  buffer_load_dwordx4 v[160:163], v9, s[28:31], s50 offen offset:0 sc1
  v_rcp_f32 v118, v118
  v_rcp_f32 v119, v119
  v_rcp_f32 v120, v120
  v_rcp_f32 v121, v121
  v_rcp_f32 v122, v122
  v_rcp_f32 v123, v123
  s_waitcnt lgkmcnt(4)
  v_mfma_f32_32x32x16_bf16 v[48:63], v[64:67], v[208:211], v[48:63]
  ds_read_b64_tr_b16 v[76:77], v8 offset:47104
  ds_read_b64_tr_b16 v[78:79], v8 offset:48128
  buffer_load_dwordx4 v[172:175], v10, s[28:31], s47 offen offset:0 sc1
  v_mul_f32 v104, v104, v116
  v_mul_f32 v105, v105, v117
  v_mul_f32 v106, v106, v118
  v_mul_f32 v107, v107, v119
  v_mul_f32 v108, v108, v120
  v_mul_f32 v109, v109, v121
  s_waitcnt lgkmcnt(4)
  v_mfma_f32_32x32x16_bf16 v[48:63], v[68:71], v[212:215], v[48:63]
  ds_read_b64_tr_b16 v[64:65], v8 offset:49152
  ds_read_b64_tr_b16 v[66:67], v8 offset:50176
  v_mul_f32 v110, v110, v122
  v_mul_f32 v111, v111, v123
  v_cvt_pk_bf16_f32 v84, v104, v105
  v_cvt_pk_bf16_f32 v85, v106, v107
  v_cvt_pk_bf16_f32 v86, v108, v109
  v_cvt_pk_bf16_f32 v87, v110, v111
  s_waitcnt lgkmcnt(4)
  v_mfma_f32_32x32x16_bf16 v[48:63], v[72:75], v[216:219], v[48:63]
  ds_read_b64_tr_b16 v[68:69], v8 offset:51200
  ds_read_b64_tr_b16 v[70:71], v8 offset:52224
  buffer_load_dwordx4 v[168:171], v9, s[28:31], s47 offen offset:0 sc1
  buffer_store_dwordx4 v[80:83], v1, s[28:31], s68 offen offset:0 sc1
  buffer_store_dwordx4 v[84:87], v1, s[28:31], s68 offen offset:1024 sc1
  s_waitcnt lgkmcnt(4)
  v_mfma_f32_32x32x16_bf16 v[48:63], v[76:79], v[220:223], v[48:63]
  ds_read_b64_tr_b16 v[72:73], v8 offset:53248
  ds_read_b64_tr_b16 v[74:75], v8 offset:54272
  buffer_load_dwordx4 v[180:183], v10, s[28:31], s45 offen offset:0 sc1
  s_waitcnt lgkmcnt(4)
  v_mfma_f32_32x32x16_bf16 v[48:63], v[64:67], v[224:227], v[48:63]
  ds_read_b64_tr_b16 v[76:77], v8 offset:55296
  ds_read_b64_tr_b16 v[78:79], v8 offset:56320
  buffer_load_dwordx4 v[176:179], v9, s[28:31], s45 offen offset:0 sc1
  s_waitcnt lgkmcnt(4)
  v_mfma_f32_32x32x16_bf16 v[48:63], v[68:71], v[228:231], v[48:63]
  s_waitcnt lgkmcnt(2)
  v_mfma_f32_32x32x16_bf16 v[48:63], v[72:75], v[232:235], v[48:63]
  s_waitcnt lgkmcnt(0)
  v_mfma_f32_32x32x16_bf16 v[48:63], v[76:79], v[236:239], v[48:63]
  s_waitcnt vmcnt(14)
  v_max3_u32 v24, v133, v135, v129
  v_cmp_u_f32 vcc, v24, v131
  v_mfma_f32_32x32x16_bf16 v[48:63], a[228:231], v[112:115], v[48:63]
  s_cbranch_vccnz rel_97
ok_96:
  v_mfma_f32_32x32x16_bf16 v[240:255], a[0:3], v[128:131], v[240:255]
  v_mfma_f32_32x32x16_bf16 v[64:79], a[0:3], v[132:135], 0
  v_mfma_f32_32x32x16_bf16 v[96:111], a[4:7], v[132:135], 0
  buffer_load_dwordx4 v[188:191], v10, s[28:31], s57 offen offset:2048 sc1
  s_nop 6
  v_mul_f32 v116, v48, v48
  v_mul_f32 v117, v49, v49
  v_mul_f32 v118, v50, v50
  v_mul_f32 v119, v51, v51
  s_waitcnt vmcnt(13)
  v_max3_u32 v24, v141, v143, v137
  v_cmp_u_f32 vcc, v24, v139
  v_mfma_f32_32x32x16_bf16 v[32:47], a[4:7], v[128:131], 0
  v_mul_f32 v120, v52, v52
  v_mul_f32 v121, v53, v53
  v_mul_f32 v122, v54, v54
  v_mul_f32 v123, v55, v55
  v_fma_f32 v116, v116, v22, v21
  s_cbranch_vccnz rel_99
ok_98:
  v_mfma_f32_32x32x16_bf16 v[240:255], a[8:11], v[136:139], v[240:255]
  buffer_load_dwordx4 v[184:187], v9, s[28:31], s57 offen offset:2048 sc1
  v_fma_f32 v117, v117, v22, v21
  v_fma_f32 v118, v118, v22, v21
  v_fma_f32 v119, v119, v22, v21
  v_fma_f32 v120, v120, v22, v21
  v_mfma_f32_32x32x16_bf16 v[64:79], a[8:11], v[140:143], v[64:79]
  v_fma_f32 v121, v121, v22, v21
  v_fma_f32 v122, v122, v22, v21
  v_fma_f32 v123, v123, v22, v21
  v_mul_f32 v116, v116, v48
  v_mul_f32 v117, v117, v49
  v_mfma_f32_32x32x16_bf16 v[96:111], a[12:15], v[140:143], v[96:111]
  buffer_load_dwordx4 v[196:199], v10, s[28:31], s58 offen offset:2048 sc1
  v_mul_f32 v118, v118, v50
  v_mul_f32 v119, v119, v51
  v_mul_f32 v120, v120, v52
  v_mul_f32 v121, v121, v53
  v_mul_f32 v122, v122, v54
  s_waitcnt vmcnt(13)
  v_max3_u32 v24, v149, v151, v145
  v_cmp_u_f32 vcc, v24, v147
  v_mfma_f32_32x32x16_bf16 v[32:47], a[12:15], v[136:139], v[32:47]
  v_mul_f32 v123, v123, v55
  v_exp_f32 v116, v116
  v_exp_f32 v117, v117
  v_exp_f32 v118, v118
  s_cbranch_vccnz rel_101
ok_100:
  v_mfma_f32_32x32x16_bf16 v[240:255], a[16:19], v[144:147], v[240:255]
  buffer_load_dwordx4 v[192:195], v9, s[28:31], s58 offen offset:2048 sc1
  v_exp_f32 v119, v119
  v_exp_f32 v120, v120
  v_exp_f32 v121, v121
  v_exp_f32 v122, v122
  v_exp_f32 v123, v123
  v_mfma_f32_32x32x16_bf16 v[64:79], a[16:19], v[148:151], v[64:79]
  v_fma_f32 v116, v116, v23, v23
  v_fma_f32 v117, v117, v23, v23
  v_fma_f32 v118, v118, v23, v23
  v_fma_f32 v119, v119, v23, v23
  v_mfma_f32_32x32x16_bf16 v[96:111], a[20:23], v[148:151], v[96:111]
  buffer_load_dwordx4 v[204:207], v10, s[28:31], s52 offen offset:2048 sc1
  v_fma_f32 v120, v120, v23, v23
  v_fma_f32 v121, v121, v23, v23
  v_fma_f32 v122, v122, v23, v23
  v_fma_f32 v123, v123, v23, v23
  v_rcp_f32 v116, v116
  s_waitcnt vmcnt(13)
  v_max3_u32 v24, v157, v159, v153
  v_cmp_u_f32 vcc, v24, v155
  v_mfma_f32_32x32x16_bf16 v[32:47], a[20:23], v[144:147], v[32:47]
  v_rcp_f32 v117, v117
  v_rcp_f32 v118, v118
  v_rcp_f32 v119, v119
  v_rcp_f32 v120, v120
  v_rcp_f32 v121, v121
  s_cbranch_vccnz rel_103
ok_102:
  v_mfma_f32_32x32x16_bf16 v[240:255], a[24:27], v[152:155], v[240:255]
  buffer_load_dwordx4 v[200:203], v9, s[28:31], s52 offen offset:2048 sc1
  v_rcp_f32 v122, v122
  v_rcp_f32 v123, v123
  v_mul_f32 v48, v48, v116
  v_mul_f32 v49, v49, v117
  v_mfma_f32_32x32x16_bf16 v[64:79], a[24:27], v[156:159], v[64:79]
  v_mul_f32 v50, v50, v118
  v_mul_f32 v51, v51, v119
  v_mul_f32 v52, v52, v120
  v_mul_f32 v53, v53, v121
  v_mul_f32 v54, v54, v122
  v_mfma_f32_32x32x16_bf16 v[96:111], a[28:31], v[156:159], v[96:111]
  buffer_load_dwordx4 v[212:215], v10, s[28:31], s49 offen offset:2048 sc1
  v_mul_f32 v55, v55, v123
  v_cvt_pk_bf16_f32 v88, v48, v49
  v_cvt_pk_bf16_f32 v89, v50, v51
  v_cvt_pk_bf16_f32 v90, v52, v53
  v_cvt_pk_bf16_f32 v91, v54, v55
  s_waitcnt vmcnt(13)
  v_max3_u32 v24, v165, v167, v161
  v_cmp_u_f32 vcc, v24, v163
  v_mfma_f32_32x32x16_bf16 v[32:47], a[28:31], v[152:155], v[32:47]
  v_mul_f32 v116, v56, v56
  v_mul_f32 v117, v57, v57
  v_mul_f32 v118, v58, v58
  v_mul_f32 v119, v59, v59
  s_cbranch_vccnz rel_105
ok_104:
  v_mfma_f32_32x32x16_bf16 v[240:255], a[32:35], v[160:163], v[240:255]
  buffer_load_dwordx4 v[208:211], v9, s[28:31], s49 offen offset:2048 sc1
  v_mul_f32 v120, v60, v60
  v_mul_f32 v121, v61, v61
  v_mul_f32 v122, v62, v62
  v_mul_f32 v123, v63, v63
  v_fma_f32 v116, v116, v22, v21
  v_mfma_f32_32x32x16_bf16 v[64:79], a[32:35], v[164:167], v[64:79]
  v_fma_f32 v117, v117, v22, v21
  v_fma_f32 v118, v118, v22, v21
  v_fma_f32 v119, v119, v22, v21
  v_fma_f32 v120, v120, v22, v21
  v_mfma_f32_32x32x16_bf16 v[96:111], a[36:39], v[164:167], v[96:111]
  buffer_load_dwordx4 v[220:223], v10, s[28:31], s50 offen offset:2048 sc1
  v_fma_f32 v121, v121, v22, v21
  v_fma_f32 v122, v122, v22, v21
  v_fma_f32 v123, v123, v22, v21
  v_mul_f32 v116, v116, v56
  v_mul_f32 v117, v117, v57
  s_waitcnt vmcnt(13)
  v_max3_u32 v24, v173, v175, v169
  v_cmp_u_f32 vcc, v24, v171
  v_mfma_f32_32x32x16_bf16 v[32:47], a[36:39], v[160:163], v[32:47]
  v_mul_f32 v118, v118, v58
  v_mul_f32 v119, v119, v59
  v_mul_f32 v120, v120, v60
  v_mul_f32 v121, v121, v61
  v_mul_f32 v122, v122, v62
  s_cbranch_vccnz rel_107
ok_106:
  v_mfma_f32_32x32x16_bf16 v[240:255], a[40:43], v[168:171], v[240:255]
  buffer_load_dwordx4 v[216:219], v9, s[28:31], s50 offen offset:2048 sc1
  v_mul_f32 v123, v123, v63
  v_exp_f32 v116, v116
  v_exp_f32 v117, v117
  v_exp_f32 v118, v118
  v_mfma_f32_32x32x16_bf16 v[64:79], a[40:43], v[172:175], v[64:79]
  v_exp_f32 v119, v119
  v_exp_f32 v120, v120
  v_exp_f32 v121, v121
  v_exp_f32 v122, v122
  v_exp_f32 v123, v123
  v_mfma_f32_32x32x16_bf16 v[96:111], a[44:47], v[172:175], v[96:111]
  buffer_load_dwordx4 v[228:231], v10, s[28:31], s47 offen offset:2048 sc1
  v_fma_f32 v116, v116, v23, v23
  v_fma_f32 v117, v117, v23, v23
  v_fma_f32 v118, v118, v23, v23
  v_fma_f32 v119, v119, v23, v23
  s_waitcnt vmcnt(11)
  v_max3_u32 v24, v181, v183, v177
  v_cmp_u_f32 vcc, v24, v179
  v_mfma_f32_32x32x16_bf16 v[32:47], a[44:47], v[168:171], v[32:47]
  v_fma_f32 v120, v120, v23, v23
  v_fma_f32 v121, v121, v23, v23
  v_fma_f32 v122, v122, v23, v23
  v_fma_f32 v123, v123, v23, v23
  v_rcp_f32 v116, v116
  s_cbranch_vccnz rel_109
ok_108:
  v_mfma_f32_32x32x16_bf16 v[240:255], a[48:51], v[176:179], v[240:255]
  buffer_load_dwordx4 v[224:227], v9, s[28:31], s47 offen offset:2048 sc1
  v_rcp_f32 v117, v117
  v_rcp_f32 v118, v118
  v_rcp_f32 v119, v119
  v_rcp_f32 v120, v120
  v_rcp_f32 v121, v121
  v_mfma_f32_32x32x16_bf16 v[64:79], a[48:51], v[180:183], v[64:79]
  v_rcp_f32 v122, v122
  v_rcp_f32 v123, v123
  v_mul_f32 v56, v56, v116
  v_mul_f32 v57, v57, v117
  v_mfma_f32_32x32x16_bf16 v[96:111], a[52:55], v[180:183], v[96:111]
  buffer_load_dwordx4 v[236:239], v10, s[28:31], s45 offen offset:2048 sc1
  v_mul_f32 v58, v58, v118
  v_mul_f32 v59, v59, v119
  v_mul_f32 v60, v60, v120
  v_mul_f32 v61, v61, v121
  v_mul_f32 v62, v62, v122
  s_waitcnt vmcnt(11)
  v_max3_u32 v24, v189, v191, v185
  v_cmp_u_f32 vcc, v24, v187
  v_mfma_f32_32x32x16_bf16 v[32:47], a[52:55], v[176:179], v[32:47]
  v_mul_f32 v63, v63, v123
  v_cvt_pk_bf16_f32 v92, v56, v57
  v_cvt_pk_bf16_f32 v93, v58, v59
  v_cvt_pk_bf16_f32 v94, v60, v61
  v_cvt_pk_bf16_f32 v95, v62, v63
  s_cbranch_vccnz rel_111
ok_110:
  v_mfma_f32_32x32x16_bf16 v[240:255], a[56:59], v[184:187], v[240:255]
  buffer_load_dwordx4 v[232:235], v9, s[28:31], s45 offen offset:2048 sc1
  s_cmp_eq_u32 s69, 0
  s_cbranch_scc1 far_113
  buffer_store_dwordx4 v[88:91], v1, s[28:31], s68 offen offset:2048
  buffer_store_dwordx4 v[92:95], v1, s[28:31], s68 offen offset:3072
ok_112:
  v_mfma_f32_32x32x16_bf16 v[64:79], a[56:59], v[188:191], v[64:79]
  v_and_b32 v21, 31, v0
  v_mul_u32_u24 v21, 896, v21
  v_lshl_add_u32 v20, v14, 1, v21
  v_mfma_f32_32x32x16_bf16 v[96:111], a[60:63], v[188:191], v[96:111]
  buffer_load_dwordx4 v[132:135], v13, s[28:31], s57 offen offset:0 sc1
  s_waitcnt vmcnt(13)
  v_max3_u32 v24, v197, v199, v193
  v_cmp_u_f32 vcc, v24, v195
  v_mfma_f32_32x32x16_bf16 v[32:47], a[60:63], v[184:187], v[32:47]
  s_cbranch_vccnz rel_115
ok_114:
  v_mfma_f32_32x32x16_bf16 v[240:255], a[64:67], v[192:195], v[240:255]
  buffer_load_dwordx4 v[128:131], v2, s[28:31], s57 offen offset:0 sc1
  ds_read_b64_tr_b16 a[144:145], v11 offset:4096
  v_mfma_f32_32x32x16_bf16 v[64:79], a[64:67], v[196:199], v[64:79]
  ds_read_b64_tr_b16 a[146:147], v11 offset:5120
  v_mfma_f32_32x32x16_bf16 v[96:111], a[68:71], v[196:199], v[96:111]
  buffer_load_dwordx4 v[140:143], v13, s[28:31], s58 offen offset:0 sc1
  ds_read_b64_tr_b16 a[148:149], v12 offset:4096
  s_waitcnt vmcnt(13)
  v_max3_u32 v24, v205, v207, v201
  v_cmp_u_f32 vcc, v24, v203
  v_mfma_f32_32x32x16_bf16 v[32:47], a[68:71], v[192:195], v[32:47]
  ds_read_b64_tr_b16 a[150:151], v12 offset:5120
  s_cbranch_vccnz rel_117
ok_116:
  v_mfma_f32_32x32x16_bf16 v[240:255], a[72:75], v[200:203], v[240:255]
  buffer_load_dwordx4 v[136:139], v2, s[28:31], s58 offen offset:0 sc1
  ds_read_b64_tr_b16 a[200:201], v11 offset:6144
  v_mfma_f32_32x32x16_bf16 v[64:79], a[72:75], v[204:207], v[64:79]
  ds_read_b64_tr_b16 a[202:203], v11 offset:7168
  v_mfma_f32_32x32x16_bf16 v[96:111], a[76:79], v[204:207], v[96:111]
  buffer_load_dwordx4 v[148:151], v13, s[28:31], s52 offen offset:0 sc1
  ds_read_b64_tr_b16 a[204:205], v12 offset:6144
  s_waitcnt vmcnt(13)
  v_max3_u32 v24, v213, v215, v209
  v_cmp_u_f32 vcc, v24, v211
  v_mfma_f32_32x32x16_bf16 v[32:47], a[76:79], v[200:203], v[32:47]
  ds_read_b64_tr_b16 a[206:207], v12 offset:7168
  s_cbranch_vccnz rel_119
ok_118:
  v_mfma_f32_32x32x16_bf16 v[240:255], a[80:83], v[208:211], v[240:255]
  buffer_load_dwordx4 v[144:147], v2, s[28:31], s52 offen offset:0 sc1
  ds_read_b64_tr_b16 a[152:153], v11 offset:8192
  v_mfma_f32_32x32x16_bf16 v[64:79], a[80:83], v[212:215], v[64:79]
  ds_read_b64_tr_b16 a[154:155], v11 offset:9216
  v_mfma_f32_32x32x16_bf16 v[96:111], a[84:87], v[212:215], v[96:111]
  buffer_load_dwordx4 v[156:159], v13, s[28:31], s49 offen offset:0 sc1
  ds_read_b64_tr_b16 a[156:157], v12 offset:8192
  s_waitcnt vmcnt(13)
  v_max3_u32 v24, v221, v223, v217
  v_cmp_u_f32 vcc, v24, v219
  v_mfma_f32_32x32x16_bf16 v[32:47], a[84:87], v[208:211], v[32:47]
  ds_read_b64_tr_b16 a[158:159], v12 offset:9216
  s_cbranch_vccnz rel_121
ok_120:
  v_mfma_f32_32x32x16_bf16 v[240:255], a[88:91], v[216:219], v[240:255]
  buffer_load_dwordx4 v[152:155], v2, s[28:31], s49 offen offset:0 sc1
  ds_read_b64_tr_b16 a[208:209], v11 offset:10240
  v_mfma_f32_32x32x16_bf16 v[64:79], a[88:91], v[220:223], v[64:79]
  ds_read_b64_tr_b16 a[210:211], v11 offset:11264
  v_mfma_f32_32x32x16_bf16 v[96:111], a[92:95], v[220:223], v[96:111]
  buffer_load_dwordx4 v[164:167], v13, s[28:31], s50 offen offset:0 sc1
  ds_read_b64_tr_b16 a[212:213], v12 offset:10240
  s_waitcnt vmcnt(13)
  v_max3_u32 v24, v229, v231, v225
  v_cmp_u_f32 vcc, v24, v227
  v_mfma_f32_32x32x16_bf16 v[32:47], a[92:95], v[216:219], v[32:47]
  ds_read_b64_tr_b16 a[214:215], v12 offset:11264
  s_cbranch_vccnz rel_123
ok_122:
  v_mfma_f32_32x32x16_bf16 v[240:255], a[96:99], v[224:227], v[240:255]
  buffer_load_dwordx4 v[160:163], v2, s[28:31], s50 offen offset:0 sc1
  ds_read_b64_tr_b16 a[160:161], v11 offset:0
  v_mfma_f32_32x32x16_bf16 v[64:79], a[96:99], v[228:231], v[64:79]
  ds_read_b64_tr_b16 a[162:163], v11 offset:1024
  v_mfma_f32_32x32x16_bf16 v[96:111], a[100:103], v[228:231], v[96:111]
  buffer_load_dwordx4 v[172:175], v13, s[28:31], s47 offen offset:0 sc1
  ds_read_b64_tr_b16 a[164:165], v12 offset:0
  s_waitcnt vmcnt(13)
  v_max3_u32 v24, v237, v239, v233
  v_cmp_u_f32 vcc, v24, v235
  v_mfma_f32_32x32x16_bf16 v[32:47], a[100:103], v[224:227], v[32:47]
  ds_read_b64_tr_b16 a[166:167], v12 offset:1024
  s_cbranch_vccnz rel_125
ok_124:
  v_mfma_f32_32x32x16_bf16 v[240:255], a[104:107], v[232:235], v[240:255]
  buffer_load_dwordx4 v[168:171], v2, s[28:31], s47 offen offset:0 sc1
  ds_read_b64_tr_b16 a[216:217], v11 offset:2048
  v_mfma_f32_32x32x16_bf16 v[64:79], a[104:107], v[236:239], v[64:79]
  ds_read_b64_tr_b16 a[218:219], v11 offset:3072
  v_mfma_f32_32x32x16_bf16 v[96:111], a[108:111], v[236:239], v[96:111]
  buffer_load_dwordx4 v[180:183], v13, s[28:31], s45 offen offset:0 sc1
  ds_read_b64_tr_b16 a[220:221], v12 offset:2048
  s_waitcnt vmcnt(11)
  v_max3_u32 v24, v133, v135, v129
  v_cmp_u_f32 vcc, v24, v131
  v_mfma_f32_32x32x16_bf16 v[32:47], a[108:111], v[232:235], v[32:47]
  ds_read_b64_tr_b16 a[222:223], v12 offset:3072
  s_cbranch_vccnz rel_127
ok_126:
  v_mfma_f32_32x32x16_bf16 v[240:255], a[112:115], v[128:131], v[240:255]
  buffer_load_dwordx4 v[176:179], v2, s[28:31], s45 offen offset:0 sc1
  v_mfma_f32_32x32x16_bf16 v[64:79], a[112:115], v[132:135], v[64:79]
  v_mfma_f32_32x32x16_bf16 v[96:111], a[116:119], v[132:135], v[96:111]
  buffer_load_dwordx4 v[188:191], v13, s[28:31], s57 offen offset:2048 sc1
  s_waitcnt vmcnt(11)
  v_max3_u32 v24, v141, v143, v137
  v_cmp_u_f32 vcc, v24, v139
  v_mfma_f32_32x32x16_bf16 v[32:47], a[116:119], v[128:131], v[32:47]
  s_cbranch_vccnz rel_129
ok_128:
  v_mfma_f32_32x32x16_bf16 v[240:255], a[120:123], v[136:139], v[240:255]
  buffer_load_dwordx4 v[196:199], v13, s[28:31], s58 offen offset:2048 sc1
  v_mfma_f32_32x32x16_bf16 v[64:79], a[120:123], v[140:143], v[64:79]
  v_mfma_f32_32x32x16_bf16 v[96:111], a[124:127], v[140:143], v[96:111]
  s_waitcnt vmcnt(10)
  v_max3_u32 v24, v149, v151, v145
  v_cmp_u_f32 vcc, v24, v147
  v_mfma_f32_32x32x16_bf16 v[32:47], a[124:127], v[136:139], v[32:47]
  buffer_load_dwordx4 v[204:207], v13, s[28:31], s52 offen offset:2048 sc1
  s_cbranch_vccnz rel_131
ok_130:
  v_mfma_f32_32x32x16_bf16 v[240:255], a[128:131], v[144:147], v[240:255]
  v_mfma_f32_32x32x16_bf16 v[64:79], a[128:131], v[148:151], v[64:79]
  buffer_load_dwordx4 v[212:215], v13, s[28:31], s49 offen offset:2048 sc1
  v_mfma_f32_32x32x16_bf16 v[96:111], a[132:135], v[148:151], v[96:111]
  s_waitcnt lgkmcnt(0)
  s_waitcnt vmcnt(10)
  v_max3_u32 v24, v157, v159, v153
  v_cmp_u_f32 vcc, v24, v155
  v_mfma_f32_32x32x16_bf16 v[32:47], a[132:135], v[144:147], v[32:47]
  s_cbranch_vccnz rel_133
ok_132:
  v_mfma_f32_32x32x16_bf16 v[240:255], a[136:139], v[152:155], v[240:255]
  buffer_load_dwordx4 v[220:223], v13, s[28:31], s50 offen offset:2048 sc1
  v_mfma_f32_32x32x16_bf16 v[64:79], a[136:139], v[156:159], v[64:79]
  v_mfma_f32_32x32x16_bf16 v[96:111], a[140:143], v[156:159], v[96:111]
  buffer_load_dwordx4 v[228:231], v13, s[28:31], s47 offen offset:2048 sc1
  s_waitcnt vmcnt(10)
  v_max3_u32 v24, v165, v167, v161
  v_cmp_u_f32 vcc, v24, v163
  v_mfma_f32_32x32x16_bf16 v[32:47], a[140:143], v[152:155], v[32:47]
  s_cbranch_vccnz rel_135
ok_134:
  v_mfma_f32_32x32x16_bf16 v[240:255], a[144:147], v[160:163], v[240:255]
  v_mfma_f32_32x32x16_bf16 v[64:79], a[144:147], v[164:167], v[64:79]
  buffer_load_dwordx4 v[236:239], v13, s[28:31], s45 offen offset:2048 sc1
  v_mfma_f32_32x32x16_bf16 v[96:111], a[148:151], v[164:167], v[96:111]
  s_waitcnt vmcnt(9)
  v_max3_u32 v24, v173, v175, v169
  v_cmp_u_f32 vcc, v24, v171
  v_mfma_f32_32x32x16_bf16 v[32:47], a[148:151], v[160:163], v[32:47]
  buffer_load_dwordx4 v[184:187], v2, s[28:31], s57 offen offset:2048 sc1
  s_cbranch_vccnz rel_137
ok_136:
  v_mfma_f32_32x32x16_bf16 v[240:255], a[152:155], v[168:171], v[240:255]
  v_mfma_f32_32x32x16_bf16 v[64:79], a[152:155], v[172:175], v[64:79]
  v_mfma_f32_32x32x16_bf16 v[96:111], a[156:159], v[172:175], v[96:111]
  buffer_load_dwordx4 v[192:195], v2, s[28:31], s58 offen offset:2048 sc1
  s_waitcnt vmcnt(9)
  v_max3_u32 v24, v181, v183, v177
  v_cmp_u_f32 vcc, v24, v179
  v_mfma_f32_32x32x16_bf16 v[32:47], a[156:159], v[168:171], v[32:47]
  s_cbranch_vccnz rel_139
ok_138:
  v_mfma_f32_32x32x16_bf16 v[240:255], a[160:163], v[176:179], v[240:255]
  buffer_load_dwordx4 v[200:203], v2, s[28:31], s52 offen offset:2048 sc1
  v_mfma_f32_32x32x16_bf16 v[64:79], a[160:163], v[180:183], v[64:79]
  v_mfma_f32_32x32x16_bf16 v[96:111], a[164:167], v[180:183], v[96:111]
  s_waitcnt vmcnt(9)
  v_cmp_u_f32 vcc, v189, v191
  v_mfma_f32_32x32x16_bf16 v[32:47], a[164:167], v[176:179], v[32:47]
  buffer_load_dwordx4 v[208:211], v2, s[28:31], s49 offen offset:2048 sc1
  s_cbranch_vccnz rel_141
ok_140:
  v_mfma_f32_32x32x16_bf16 v[64:79], a[168:171], v[188:191], v[64:79]
  s_waitcnt vmcnt(9)
  v_cmp_u_f32 vcc, v197, v199
  v_mfma_f32_32x32x16_bf16 v[96:111], a[172:175], v[188:191], v[96:111]
  buffer_load_dwordx4 v[216:219], v2, s[28:31], s50 offen offset:2048 sc1
  s_cbranch_vccnz rel_143
ok_142:
  v_mfma_f32_32x32x16_bf16 v[64:79], a[176:179], v[196:199], v[64:79]
  s_waitcnt vmcnt(9)
  v_cmp_u_f32 vcc, v205, v207
  v_mfma_f32_32x32x16_bf16 v[96:111], a[180:183], v[196:199], v[96:111]
  s_cbranch_vccnz rel_145
ok_144:
  v_mfma_f32_32x32x16_bf16 v[64:79], a[184:187], v[204:207], v[64:79]
  buffer_load_dwordx4 v[224:227], v2, s[28:31], s47 offen offset:2048 sc1
  s_waitcnt vmcnt(9)
  v_cmp_u_f32 vcc, v213, v215
  v_mfma_f32_32x32x16_bf16 v[96:111], a[188:191], v[204:207], v[96:111]
  s_cbranch_vccnz rel_147
ok_146:
  v_mfma_f32_32x32x16_bf16 v[64:79], a[192:195], v[212:215], v[64:79]
  buffer_load_dwordx4 v[232:235], v2, s[28:31], s45 offen offset:2048 sc1
  s_waitcnt vmcnt(9)
  v_cmp_u_f32 vcc, v221, v223
  v_mfma_f32_32x32x16_bf16 v[96:111], a[196:199], v[212:215], v[96:111]
  s_cbranch_vccnz rel_149
ok_148:
  v_mfma_f32_32x32x16_bf16 v[64:79], a[200:203], v[220:223], v[64:79]
  s_waitcnt vmcnt(8)
  v_cmp_u_f32 vcc, v229, v231
  v_mfma_f32_32x32x16_bf16 v[96:111], a[204:207], v[220:223], v[96:111]
  s_cbranch_vccnz rel_151
ok_150:
  v_mfma_f32_32x32x16_bf16 v[64:79], a[208:211], v[228:231], v[64:79]
  s_waitcnt vmcnt(7)
  v_cmp_u_f32 vcc, v237, v239
  v_mfma_f32_32x32x16_bf16 v[96:111], a[212:215], v[228:231], v[96:111]
  s_cbranch_vccnz rel_153
ok_152:
  v_mfma_f32_32x32x16_bf16 v[64:79], a[216:219], v[236:239], v[64:79]
  s_waitcnt vmcnt(5)
  v_max3_u32 v24, v185, v187, v193
  v_cmp_u_f32 vcc, v24, v195
  v_mfma_f32_32x32x16_bf16 v[96:111], a[220:223], v[236:239], v[96:111]
  s_cbranch_vccnz rel_155
ok_154:
  v_mfma_f32_32x32x16_bf16 v[32:47], a[172:175], v[184:187], v[32:47]
  s_waitcnt vmcnt(3)
  v_max3_u32 v24, v201, v203, v209
  v_cmp_u_f32 vcc, v24, v211
  v_mfma_f32_32x32x16_bf16 v[32:47], a[180:183], v[192:195], v[32:47]
  s_nop 1
  ds_write_b128 v25, v[64:67] offset:4096
  ds_write_b128 v25, v[68:71] offset:5120
  s_cbranch_vccnz rel_157
ok_156:
  v_mfma_f32_32x32x16_bf16 v[32:47], a[188:191], v[200:203], v[32:47]
  ds_write_b128 v25, v[72:75] offset:6144
  ds_write_b128 v25, v[76:79] offset:7168
  s_waitcnt vmcnt(1)
  v_max3_u32 v24, v217, v219, v225
  v_cmp_u_f32 vcc, v24, v227
  v_mfma_f32_32x32x16_bf16 v[32:47], a[196:199], v[208:211], v[32:47]
  ds_write_b128 v25, v[96:99] offset:8192
  ds_write_b128 v25, v[100:103] offset:9216
  s_cbranch_vccnz rel_159
ok_158:
  v_mfma_f32_32x32x16_bf16 v[32:47], a[204:207], v[216:219], v[32:47]
  ds_write_b128 v25, v[104:107] offset:10240
  ds_write_b128 v25, v[108:111] offset:11264
  s_waitcnt vmcnt(0)
  v_cmp_u_f32 vcc, v233, v235
  v_mfma_f32_32x32x16_bf16 v[32:47], a[212:215], v[224:227], v[32:47]
  s_cbranch_vccnz rel_161
ok_160:
  v_mfma_f32_32x32x16_bf16 v[32:47], a[220:223], v[232:235], v[32:47]
  s_waitcnt lgkmcnt(0)
  s_barrier
  v_mfma_f32_32x32x16_bf16 v[240:255], a[168:171], v[184:187], v[240:255]
  ds_read_b128 v[144:147], v30 offset:0
  ds_read_b128 v[148:151], v30 offset:1024
  v_mfma_f32_32x32x16_bf16 v[240:255], a[176:179], v[192:195], v[240:255]
  ds_read_b128 v[152:155], v30 offset:2048
  ds_read_b128 v[156:159], v30 offset:3072
  v_mfma_f32_32x32x16_bf16 v[240:255], a[184:187], v[200:203], v[240:255]
  s_nop 2
  ds_write_b128 v25, v[32:35] offset:0
  ds_write_b128 v25, v[36:39] offset:1024
  v_mfma_f32_32x32x16_bf16 v[240:255], a[192:195], v[208:211], v[240:255]
  ds_write_b128 v25, v[40:43] offset:2048
  ds_write_b128 v25, v[44:47] offset:3072
  v_mfma_f32_32x32x16_bf16 v[240:255], a[200:203], v[216:219], v[240:255]
  ds_read_b128 v[160:163], v31 offset:0
  ds_read_b128 v[164:167], v31 offset:1024
  v_mfma_f32_32x32x16_bf16 v[240:255], a[208:211], v[224:227], v[240:255]
  ds_read_b128 v[168:171], v31 offset:2048
  ds_read_b128 v[172:175], v31 offset:3072
  v_mfma_f32_32x32x16_bf16 v[240:255], a[216:219], v[232:235], v[240:255]
  s_waitcnt lgkmcnt(4)
  s_barrier
  ds_read_b128 v[128:131], v29 offset:0
  ds_read_b128 v[132:135], v29 offset:1024
  ds_read_b128 v[136:139], v29 offset:2048
  ds_read_b128 v[140:143], v29 offset:3072
  s_nop 5
  v_pk_add_f32 v[240:241], v[240:241], v[144:145]
  v_pk_add_f32 v[242:243], v[242:243], v[146:147]
  v_pk_add_f32 v[244:245], v[244:245], v[148:149]
  v_pk_add_f32 v[246:247], v[246:247], v[150:151]
  v_pk_add_f32 v[248:249], v[248:249], v[152:153]
  v_pk_add_f32 v[250:251], v[250:251], v[154:155]
  v_pk_add_f32 v[252:253], v[252:253], v[156:157]
  v_pk_add_f32 v[254:255], v[254:255], v[158:159]
  s_waitcnt lgkmcnt(4)
  v_pk_add_f32 v[240:241], v[240:241], v[160:161]
  v_pk_add_f32 v[242:243], v[242:243], v[162:163]
  v_pk_add_f32 v[244:245], v[244:245], v[164:165]
  v_pk_add_f32 v[246:247], v[246:247], v[166:167]
  v_pk_add_f32 v[248:249], v[248:249], v[168:169]
  v_pk_add_f32 v[250:251], v[250:251], v[170:171]
  v_pk_add_f32 v[252:253], v[252:253], v[172:173]
  v_pk_add_f32 v[254:255], v[254:255], v[174:175]
  s_waitcnt lgkmcnt(0)
  v_pk_add_f32 v[240:241], v[240:241], v[128:129]
  v_pk_add_f32 v[242:243], v[242:243], v[130:131]
  v_pk_add_f32 v[244:245], v[244:245], v[132:133]
  v_pk_add_f32 v[246:247], v[246:247], v[134:135]
  v_pk_add_f32 v[248:249], v[248:249], v[136:137]
  v_pk_add_f32 v[250:251], v[250:251], v[138:139]
  v_pk_add_f32 v[252:253], v[252:253], v[140:141]
  v_pk_add_f32 v[254:255], v[254:255], v[142:143]
  v_cvt_pk_bf16_f32 v80, v240, v241
  v_cvt_pk_bf16_f32 v81, v242, v243
  v_cvt_pk_bf16_f32 v82, v244, v245
  v_cvt_pk_bf16_f32 v83, v246, v247
  v_cvt_pk_bf16_f32 v84, v248, v249
  v_cvt_pk_bf16_f32 v85, v250, v251
  v_cvt_pk_bf16_f32 v86, v252, v253
  v_cvt_pk_bf16_f32 v87, v254, v255
  v_permlane32_swap_b32 v80, v82
  v_permlane32_swap_b32 v81, v83
  v_permlane32_swap_b32 v84, v86
  v_permlane32_swap_b32 v85, v87
  buffer_store_dwordx4 v[80:83], v20, s[32:35], s44 offen offset:0 nt
  buffer_store_dwordx4 v[84:87], v20, s[32:35], s44 offen offset:32 nt
  s_or_b32 s4, s2, s3
  s_cmp_lg_u32 s4, 0
  s_cbranch_scc1 L_fin
  v_mov_b32 v18, s48
  s_mov_b64 exec, 1
  buffer_store_dword v18, off, s[28:31], 0 offset:0
  s_mov_b64 exec, -1
L_fin:
L_exit:
  s_endpgm
md_2:
  buffer_load_dwordx2 v[224:225], v27, s[28:31], s70 offen sc1
  s_waitcnt vmcnt(0)
  s_add_u32 s4, s48, 16
  v_subrev_u32 v224, s4, v224
  v_subrev_u32 v225, s4, v225
  v_max_u32 v226, v224, v225
  v_cmp_lt_u32 vcc, 31, v226
  s_cbranch_vccz ok_1
  s_cmp_eq_u32 s63, 0
  s_cbranch_scc1 ok_1
  s_sub_u32 s63, s63, 1
  s_branch md_2
far_4:
  global_store_dwordx4 v2, v[112:115], s[12:13] offset:0 sc1
  global_store_dwordx4 v2, v[116:119], s[12:13] offset:1024 sc1
  global_store_dwordx4 v2, v[120:123], s[12:13] offset:2048 sc1
  global_store_dwordx4 v2, v[124:127], s[12:13] offset:3072 sc1
  s_branch ok_3
far_6:
  buffer_store_dwordx2 v[16:17], off, s[28:31], s50 sc1
  s_branch ok_5
late_8:
  s_andn2_b32 exec_lo, 1048575, s42
  s_mov_b32 exec_hi, 0
  buffer_load_dwordx2 v[240:241], v15, s[28:31], 0 offen sc1
  s_mov_b64 exec, -1
  s_waitcnt vmcnt(0)
  v_cmp_eq_u32 s[42:43], s48, v240
  s_andn2_b32 s4, 2, s42
  s_cbranch_scc0 ok_7
  s_cmp_eq_u32 s63, 0
  s_cbranch_scc1 ok_7
  s_sub_u32 s63, s63, 1
  s_branch late_8
late_10:
  s_andn2_b32 exec_lo, 1048575, s42
  s_mov_b32 exec_hi, 0
  buffer_load_dwordx2 v[240:241], v15, s[28:31], 0 offen sc1
  s_mov_b64 exec, -1
  s_waitcnt vmcnt(0)
  v_cmp_eq_u32 s[42:43], s48, v240
  s_andn2_b32 s4, 4, s42
  s_cbranch_scc0 ok_9
  s_cmp_eq_u32 s63, 0
  s_cbranch_scc1 ok_9
  s_sub_u32 s63, s63, 1
  s_branch late_10
late_12:
  s_andn2_b32 exec_lo, 1048575, s42
  s_mov_b32 exec_hi, 0
  buffer_load_dwordx2 v[240:241], v15, s[28:31], 0 offen sc1
  s_mov_b64 exec, -1
  s_waitcnt vmcnt(0)
  v_cmp_eq_u32 s[42:43], s48, v240
  s_andn2_b32 s4, 8, s42
  s_cbranch_scc0 ok_11
  s_cmp_eq_u32 s63, 0
  s_cbranch_scc1 ok_11
  s_sub_u32 s63, s63, 1
  s_branch late_12
late_14:
  s_andn2_b32 exec_lo, 1048575, s42
  s_mov_b32 exec_hi, 0
  buffer_load_dwordx2 v[240:241], v15, s[28:31], 0 offen sc1
  s_mov_b64 exec, -1
  s_waitcnt vmcnt(0)
  v_cmp_eq_u32 s[42:43], s48, v240
  s_andn2_b32 s4, 16, s42
  s_cbranch_scc0 ok_13
  s_cmp_eq_u32 s63, 0
  s_cbranch_scc1 ok_13
  s_sub_u32 s63, s63, 1
  s_branch late_14
late_16:
  s_andn2_b32 exec_lo, 1048575, s42
  s_mov_b32 exec_hi, 0
  buffer_load_dwordx2 v[240:241], v15, s[28:31], 0 offen sc1
  s_mov_b64 exec, -1
  s_waitcnt vmcnt(0)
  v_cmp_eq_u32 s[42:43], s48, v240
  s_andn2_b32 s4, 32, s42
  s_cbranch_scc0 ok_15
  s_cmp_eq_u32 s63, 0
  s_cbranch_scc1 ok_15
  s_sub_u32 s63, s63, 1
  s_branch late_16
far_18:
  global_store_dwordx4 v1, v[252:255], s[22:23] offset:-3072 sc1
  global_store_dwordx4 v1, v[252:255], s[22:23] offset:-2048 sc1
  global_store_dwordx4 v1, v[252:255], s[22:23] offset:-1024 sc1
  s_branch ok_17
late_20:
  s_andn2_b32 exec_lo, 1048575, s42
  s_mov_b32 exec_hi, 0
  buffer_load_dwordx2 v[240:241], v15, s[28:31], 0 offen sc1
  s_mov_b64 exec, -1
  s_waitcnt vmcnt(0)
  v_cmp_eq_u32 s[42:43], s48, v240
  s_andn2_b32 s4, 64, s42
  s_cbranch_scc0 ok_19
  s_cmp_eq_u32 s63, 0
  s_cbranch_scc1 ok_19
  s_sub_u32 s63, s63, 1
  s_branch late_20
late_22:
  s_andn2_b32 exec_lo, 1048575, s42
  s_mov_b32 exec_hi, 0
  buffer_load_dwordx2 v[240:241], v15, s[28:31], 0 offen sc1
  s_mov_b64 exec, -1
  s_waitcnt vmcnt(0)
  v_cmp_eq_u32 s[42:43], s48, v240
  s_andn2_b32 s4, 1048449, s42
  s_cbranch_scc0 ok_21
  s_cmp_eq_u32 s63, 0
  s_cbranch_scc1 ok_21
  s_sub_u32 s63, s63, 1
  s_branch late_22
far_24:
  global_store_dwordx4 v1, v[252:255], s[22:23] offset:0 sc1
  global_store_dwordx4 v1, v[252:255], s[22:23] offset:1024 sc1
  global_store_dwordx4 v1, v[252:255], s[22:23] offset:2048 sc1
  global_store_dwordx4 v1, v[252:255], s[22:23] offset:3072 sc1
  s_branch ok_23
far_26:
  global_store_dwordx4 v1, v[252:255], s[26:27] offset:0 sc1
  global_store_dwordx4 v1, v[252:255], s[26:27] offset:1024 sc1
  s_branch ok_25
fx_28:
  buffer_load_dword v16, v26, s[28:31], 0 offen sc1
  s_waitcnt vmcnt(0)
  v_cmp_ne_u32 vcc, s48, v16
  s_cmp_lg_u64 vcc, 0
  s_cbranch_scc0 ok_27
  s_cmp_eq_u32 s63, 0
  s_cbranch_scc1 ok_27
  s_sub_u32 s63, s63, 1
  s_branch fx_28
L_po_e0:
L_po_e1:
L_po_e2:
L_po_e3:
L_po_e4:
L_po_e5:
L_po_e6:
L_po_e7:
  v_cmp_u_f32 s[4:5], v65, v67
  v_cmp_u_f32 vcc, v69, v71
  s_or_b64 exec, s[4:5], vcc
  buffer_load_dwordx4 v[64:67], v1, s[28:31], s57 offen offset:0 sc1
  buffer_load_dwordx4 v[68:71], v1, s[28:31], s57 offen offset:1024 sc1
  s_mov_b64 exec, -1
  v_cmp_u_f32 s[4:5], v73, v75
  v_cmp_u_f32 vcc, v77, v79
  s_or_b64 exec, s[4:5], vcc
  buffer_load_dwordx4 v[72:75], v1, s[28:31], s57 offen offset:2048 sc1
  buffer_load_dwordx4 v[76:79], v1, s[28:31], s57 offen offset:3072 sc1
  s_mov_b64 exec, -1
  v_cmp_u_f32 s[4:5], v81, v83
  v_cmp_u_f32 vcc, v85, v87
  s_or_b64 exec, s[4:5], vcc
  buffer_load_dwordx4 v[80:83], v23, s[28:31], s57 offen offset:0 sc1
  buffer_load_dwordx4 v[84:87], v23, s[28:31], s57 offen offset:1024 sc1
  s_mov_b64 exec, -1
  v_cmp_u_f32 s[4:5], v89, v91
  v_cmp_u_f32 vcc, v93, v95
  s_or_b64 exec, s[4:5], vcc
  buffer_load_dwordx4 v[88:91], v23, s[28:31], s57 offen offset:2048 sc1
  buffer_load_dwordx4 v[92:95], v23, s[28:31], s57 offen offset:3072 sc1
  s_mov_b64 exec, -1
  v_cmp_u_f32 s[4:5], v33, v35
  v_cmp_u_f32 vcc, v37, v39
  s_or_b64 exec, s[4:5], vcc
  buffer_load_dwordx4 v[32:35], v1, s[28:31], s58 offen offset:0 sc1
  buffer_load_dwordx4 v[36:39], v1, s[28:31], s58 offen offset:1024 sc1
  s_mov_b64 exec, -1
  v_cmp_u_f32 s[4:5], v41, v43
  v_cmp_u_f32 vcc, v45, v47
  s_or_b64 exec, s[4:5], vcc
  buffer_load_dwordx4 v[40:43], v1, s[28:31], s58 offen offset:2048 sc1
  buffer_load_dwordx4 v[44:47], v1, s[28:31], s58 offen offset:3072 sc1
  s_mov_b64 exec, -1
  v_cmp_u_f32 s[4:5], v49, v51
  v_cmp_u_f32 vcc, v53, v55
  s_or_b64 exec, s[4:5], vcc
  buffer_load_dwordx4 v[48:51], v23, s[28:31], s58 offen offset:0 sc1
  buffer_load_dwordx4 v[52:55], v23, s[28:31], s58 offen offset:1024 sc1
  s_mov_b64 exec, -1
  v_cmp_u_f32 s[4:5], v57, v59
  v_cmp_u_f32 vcc, v61, v63
  s_or_b64 exec, s[4:5], vcc
  buffer_load_dwordx4 v[56:59], v23, s[28:31], s58 offen offset:2048 sc1
  buffer_load_dwordx4 v[60:63], v23, s[28:31], s58 offen offset:3072 sc1
  s_mov_b64 exec, -1
  s_waitcnt vmcnt(16)
  s_setpc_b64 s[6:7]
rp_31:
  s_call_b64 s[6:7], L_po_e0
  s_cmp_eq_u32 s63, 0
  s_cbranch_scc1 ok_30
  s_sub_u32 s63, s63, 1
  s_branch ck_29
rp_33:
  s_call_b64 s[6:7], L_po_e0
  v_cmp_u_f32 vcc, v69, v71
  s_cbranch_vccz ok_32
  s_cmp_eq_u32 s63, 0
  s_cbranch_scc1 ok_32
  s_sub_u32 s63, s63, 1
  s_branch rp_33
rp_35:
  s_call_b64 s[6:7], L_po_e1
  v_cmp_u_f32 vcc, v73, v75
  s_cbranch_vccz ok_34
  s_cmp_eq_u32 s63, 0
  s_cbranch_scc1 ok_34
  s_sub_u32 s63, s63, 1
  s_branch rp_35
rp_37:
  s_call_b64 s[6:7], L_po_e1
  v_cmp_u_f32 vcc, v77, v79
  s_cbranch_vccz ok_36
  s_cmp_eq_u32 s63, 0
  s_cbranch_scc1 ok_36
  s_sub_u32 s63, s63, 1
  s_branch rp_37
rp_39:
  s_call_b64 s[6:7], L_po_e2
  v_cmp_u_f32 vcc, v81, v83
  s_cbranch_vccz ok_38
  s_cmp_eq_u32 s63, 0
  s_cbranch_scc1 ok_38
  s_sub_u32 s63, s63, 1
  s_branch rp_39
rp_41:
  s_call_b64 s[6:7], L_po_e2
  v_cmp_u_f32 vcc, v85, v87
  s_cbranch_vccz ok_40
  s_cmp_eq_u32 s63, 0
  s_cbranch_scc1 ok_40
  s_sub_u32 s63, s63, 1
  s_branch rp_41
rp_43:
  s_call_b64 s[6:7], L_po_e3
  v_cmp_u_f32 vcc, v89, v91
  s_cbranch_vccz ok_42
  s_cmp_eq_u32 s63, 0
  s_cbranch_scc1 ok_42
  s_sub_u32 s63, s63, 1
  s_branch rp_43
rp_45:
  s_call_b64 s[6:7], L_po_e3
  v_cmp_u_f32 vcc, v93, v95
  s_cbranch_vccz ok_44
  s_cmp_eq_u32 s63, 0
  s_cbranch_scc1 ok_44
  s_sub_u32 s63, s63, 1
  s_branch rp_45
rp_47:
  s_call_b64 s[6:7], L_po_e4
  v_max3_u32 v24, v33, v35, v37
  v_cmp_u_f32 vcc, v24, v39
  s_cbranch_vccz ok_46
  s_cmp_eq_u32 s63, 0
  s_cbranch_scc1 ok_46
  s_sub_u32 s63, s63, 1
  s_branch rp_47
rp_49:
  s_call_b64 s[6:7], L_po_e5
  v_max3_u32 v24, v41, v43, v45
  v_cmp_u_f32 vcc, v24, v47
  s_cbranch_vccz ok_48
  s_cmp_eq_u32 s63, 0
  s_cbranch_scc1 ok_48
  s_sub_u32 s63, s63, 1
  s_branch rp_49
rp_51:
  s_call_b64 s[6:7], L_po_e6
  v_max3_u32 v24, v49, v51, v53
  v_cmp_u_f32 vcc, v24, v55
  s_cbranch_vccz ok_50
  s_cmp_eq_u32 s63, 0
  s_cbranch_scc1 ok_50
  s_sub_u32 s63, s63, 1
  s_branch rp_51
rp_53:
  s_call_b64 s[6:7], L_po_e7
  v_max3_u32 v24, v57, v59, v61
  v_cmp_u_f32 vcc, v24, v63
  s_cbranch_vccz ok_52
  s_cmp_eq_u32 s63, 0
  s_cbranch_scc1 ok_52
  s_sub_u32 s63, s63, 1
  s_branch rp_53
far_55:
  buffer_store_dwordx4 v[176:179], v1, s[28:31], s65 offen offset:0 sc1
  buffer_store_dwordx4 v[180:183], v1, s[28:31], s65 offen offset:1024 sc1
  s_branch ok_54
far_57:
  buffer_store_dwordx2 v[18:19], v27, s[28:31], s66 offen sc1
  s_branch ok_56
spin_59:
  buffer_load_dword v16, v15, s[28:31], 0 offen sc1
  s_waitcnt vmcnt(0)
  v_cmp_eq_u32 vcc, -1, v16
  s_cbranch_vccz ok_58
  s_cmp_eq_u32 s63, 0
  s_cbranch_scc1 ok_58
  s_sub_u32 s63, s63, 1
  s_branch spin_59
rel_61:
  buffer_load_dwordx4 v[128:131], v1, s[28:31], s72 offen offset:0 sc1
  buffer_load_dwordx4 v[132:135], v1, s[28:31], s72 offen offset:1024 sc1
  s_waitcnt vmcnt(0)
  v_cmp_u_f32 vcc, v129, v131
  s_cbranch_vccnz ag_162
  v_cmp_u_f32 vcc, v133, v135
  s_cbranch_vccnz ag_162
go_163:
  s_branch ok_60
ag_162:
  s_cmp_eq_u32 s63, 0
  s_cbranch_scc1 go_163
  s_sub_u32 s63, s63, 1
  s_branch rel_61
rel_63:
  buffer_load_dwordx4 v[136:139], v1, s[28:31], s72 offen offset:2048 sc1
  buffer_load_dwordx4 v[140:143], v1, s[28:31], s72 offen offset:3072 sc1
  s_waitcnt vmcnt(0)
  v_cmp_u_f32 vcc, v137, v139
  s_cbranch_vccnz ag_164
  v_cmp_u_f32 vcc, v141, v143
  s_cbranch_vccnz ag_164
go_165:
  s_branch ok_62
ag_164:
  s_cmp_eq_u32 s63, 0
  s_cbranch_scc1 go_165
  s_sub_u32 s63, s63, 1
  s_branch rel_63
rel_65:
  buffer_load_dwordx4 v[144:147], v116, s[28:31], s72 offen offset:0 sc1
  buffer_load_dwordx4 v[148:151], v116, s[28:31], s72 offen offset:1024 sc1
  s_waitcnt vmcnt(0)
  v_cmp_u_f32 vcc, v145, v147
  s_cbranch_vccnz ag_166
  v_cmp_u_f32 vcc, v149, v151
  s_cbranch_vccnz ag_166
go_167:
  s_branch ok_64
ag_166:
  s_cmp_eq_u32 s63, 0
  s_cbranch_scc1 go_167
  s_sub_u32 s63, s63, 1
  s_branch rel_65
rel_67:
  buffer_load_dwordx4 v[152:155], v116, s[28:31], s72 offen offset:2048 sc1
  buffer_load_dwordx4 v[156:159], v116, s[28:31], s72 offen offset:3072 sc1
  s_waitcnt vmcnt(0)
  v_cmp_u_f32 vcc, v153, v155
  s_cbranch_vccnz ag_168
  v_cmp_u_f32 vcc, v157, v159
  s_cbranch_vccnz ag_168
go_169:
  s_branch ok_66
ag_168:
  s_cmp_eq_u32 s63, 0
  s_cbranch_scc1 go_169
  s_sub_u32 s63, s63, 1
  s_branch rel_67
rel_69:
  buffer_load_dwordx4 v[160:163], v117, s[28:31], s72 offen offset:0 sc1
  buffer_load_dwordx4 v[164:167], v117, s[28:31], s72 offen offset:1024 sc1
  s_waitcnt vmcnt(0)
  v_cmp_u_f32 vcc, v161, v163
  s_cbranch_vccnz ag_170
  v_cmp_u_f32 vcc, v165, v167
  s_cbranch_vccnz ag_170
go_171:
  s_branch ok_68
ag_170:
  s_cmp_eq_u32 s63, 0
  s_cbranch_scc1 go_171
  s_sub_u32 s63, s63, 1
  s_branch rel_69
rel_71:
  buffer_load_dwordx4 v[168:171], v117, s[28:31], s72 offen offset:2048 sc1
  buffer_load_dwordx4 v[172:175], v117, s[28:31], s72 offen offset:3072 sc1
  s_waitcnt vmcnt(0)
  v_cmp_u_f32 vcc, v169, v171
  s_cbranch_vccnz ag_172
  v_cmp_u_f32 vcc, v173, v175
  s_cbranch_vccnz ag_172
go_173:
  s_branch ok_70
ag_172:
  s_cmp_eq_u32 s63, 0
  s_cbranch_scc1 go_173
  s_sub_u32 s63, s63, 1
  s_branch rel_71
rel_73:
  buffer_load_dwordx4 v[176:179], v118, s[28:31], s72 offen offset:0 sc1
  buffer_load_dwordx4 v[180:183], v118, s[28:31], s72 offen offset:1024 sc1
  s_waitcnt vmcnt(0)
  v_cmp_u_f32 vcc, v177, v179
  s_cbranch_vccnz ag_174
  v_cmp_u_f32 vcc, v181, v183
  s_cbranch_vccnz ag_174
go_175:
  s_branch ok_72
ag_174:
  s_cmp_eq_u32 s63, 0
  s_cbranch_scc1 go_175
  s_sub_u32 s63, s63, 1
  s_branch rel_73
rel_75:
  buffer_load_dwordx4 v[184:187], v118, s[28:31], s72 offen offset:2048 sc1
  buffer_load_dwordx4 v[188:191], v118, s[28:31], s72 offen offset:3072 sc1
  s_waitcnt vmcnt(0)
  v_cmp_u_f32 vcc, v185, v187
  s_cbranch_vccnz ag_176
  v_cmp_u_f32 vcc, v189, v191
  s_cbranch_vccnz ag_176
go_177:
  s_branch ok_74
ag_176:
  s_cmp_eq_u32 s63, 0
  s_cbranch_scc1 go_177
  s_sub_u32 s63, s63, 1
  s_branch rel_75
rel_77:
  buffer_load_dwordx4 v[192:195], v119, s[28:31], s72 offen offset:0 sc1
  buffer_load_dwordx4 v[196:199], v119, s[28:31], s72 offen offset:1024 sc1
  s_waitcnt vmcnt(0)
  v_cmp_u_f32 vcc, v193, v195
  s_cbranch_vccnz ag_178
  v_cmp_u_f32 vcc, v197, v199
  s_cbranch_vccnz ag_178
go_179:
  s_branch ok_76
ag_178:
  s_cmp_eq_u32 s63, 0
  s_cbranch_scc1 go_179
  s_sub_u32 s63, s63, 1
  s_branch rel_77
rel_79:
  buffer_load_dwordx4 v[200:203], v119, s[28:31], s72 offen offset:2048 sc1
  buffer_load_dwordx4 v[204:207], v119, s[28:31], s72 offen offset:3072 sc1
  s_waitcnt vmcnt(0)
  v_cmp_u_f32 vcc, v201, v203
  s_cbranch_vccnz ag_180
  v_cmp_u_f32 vcc, v205, v207
  s_cbranch_vccnz ag_180
go_181:
  s_branch ok_78
ag_180:
  s_cmp_eq_u32 s63, 0
  s_cbranch_scc1 go_181
  s_sub_u32 s63, s63, 1
  s_branch rel_79
rel_81:
  buffer_load_dwordx4 v[208:211], v120, s[28:31], s72 offen offset:0 sc1
  buffer_load_dwordx4 v[212:215], v120, s[28:31], s72 offen offset:1024 sc1
  s_waitcnt vmcnt(0)
  v_cmp_u_f32 vcc, v209, v211
  s_cbranch_vccnz ag_182
  v_cmp_u_f32 vcc, v213, v215
  s_cbranch_vccnz ag_182
go_183:
  s_branch ok_80
ag_182:
  s_cmp_eq_u32 s63, 0
  s_cbranch_scc1 go_183
  s_sub_u32 s63, s63, 1
  s_branch rel_81
rel_83:
  buffer_load_dwordx2 v[80:81], v20, s[28:31], s73 offen offset:0 sc1
  buffer_load_dwordx2 v[82:83], v20, s[28:31], s73 offen offset:512 sc1
  buffer_load_dwordx2 v[84:85], v20, s[28:31], s73 offen offset:1024 sc1
  buffer_load_dwordx2 v[86:87], v20, s[28:31], s73 offen offset:1536 sc1
  buffer_load_dwordx2 v[88:89], v20, s[28:31], s73 offen offset:2048 sc1
  buffer_load_dwordx2 v[90:91], v20, s[28:31], s73 offen offset:2560 sc1
  buffer_load_dwordx2 v[92:93], v20, s[28:31], s73 offen offset:3072 sc1
  s_waitcnt vmcnt(0)
  v_add_f32 v80, v80, v82
  v_add_f32 v81, v81, v83
  v_add_f32 v80, v80, v84
  v_add_f32 v81, v81, v85
  v_add_f32 v80, v80, v86
  v_add_f32 v81, v81, v87
  v_add_f32 v80, v80, v88
  v_add_f32 v81, v81, v89
  v_add_f32 v80, v80, v90
  v_add_f32 v81, v81, v91
  v_add_f32 v80, v80, v92
  v_add_f32 v81, v81, v93
  v_cmp_u_f32 vcc, v80, v81
  s_cbranch_vccnz ag_184
go_185:
  s_branch ok_82
ag_184:
  s_cmp_eq_u32 s63, 0
  s_cbranch_scc1 go_185
  s_sub_u32 s63, s63, 1
  s_branch rel_83
rel_85:
  buffer_load_dwordx4 v[216:219], v120, s[28:31], s72 offen offset:2048 sc1
  buffer_load_dwordx4 v[220:223], v120, s[28:31], s72 offen offset:3072 sc1
  s_waitcnt vmcnt(0)
  v_cmp_u_f32 vcc, v217, v219
  s_cbranch_vccnz ag_186
  v_cmp_u_f32 vcc, v221, v223
  s_cbranch_vccnz ag_186
go_187:
  s_branch ok_84
ag_186:
  s_cmp_eq_u32 s63, 0
  s_cbranch_scc1 go_187
  s_sub_u32 s63, s63, 1
  s_branch rel_85
rel_87:
  buffer_load_dwordx4 v[224:227], v121, s[28:31], s72 offen offset:0 sc1
  buffer_load_dwordx4 v[228:231], v121, s[28:31], s72 offen offset:1024 sc1
  s_waitcnt vmcnt(0)
  v_cmp_u_f32 vcc, v225, v227
  s_cbranch_vccnz ag_188
  v_cmp_u_f32 vcc, v229, v231
  s_cbranch_vccnz ag_188
go_189:
  s_branch ok_86
ag_188:
  s_cmp_eq_u32 s63, 0
  s_cbranch_scc1 go_189
  s_sub_u32 s63, s63, 1
  s_branch rel_87
rel_89:
  buffer_load_dwordx4 v[232:235], v121, s[28:31], s72 offen offset:2048 sc1
  buffer_load_dwordx4 v[236:239], v121, s[28:31], s72 offen offset:3072 sc1
  s_waitcnt vmcnt(0)
  v_cmp_u_f32 vcc, v233, v235
  s_cbranch_vccnz ag_190
  v_cmp_u_f32 vcc, v237, v239
  s_cbranch_vccnz ag_190
go_191:
  s_branch ok_88
ag_190:
  s_cmp_eq_u32 s63, 0
  s_cbranch_scc1 go_191
  s_sub_u32 s63, s63, 1
  s_branch rel_89
rel_97:
  buffer_load_dwordx4 v[132:135], v10, s[28:31], s57 offen offset:0 sc1
  buffer_load_dwordx4 v[128:131], v9, s[28:31], s57 offen offset:0 sc1
  s_waitcnt vmcnt(0)
  v_cmp_u_f32 vcc, v133, v135
  s_cbranch_vccnz ag_192
  v_cmp_u_f32 vcc, v129, v131
  s_cbranch_vccnz ag_192
go_193:
  buffer_load_dwordx4 v[140:143], v10, s[28:31], s58 offen offset:0 sc1
  buffer_load_dwordx4 v[136:139], v9, s[28:31], s58 offen offset:0 sc1
  buffer_load_dwordx4 v[148:151], v10, s[28:31], s52 offen offset:0 sc1
  buffer_load_dwordx4 v[144:147], v9, s[28:31], s52 offen offset:0 sc1
  buffer_load_dwordx4 v[156:159], v10, s[28:31], s49 offen offset:0 sc1
  buffer_load_dwordx4 v[152:155], v9, s[28:31], s49 offen offset:0 sc1
  buffer_load_dwordx4 v[164:167], v10, s[28:31], s50 offen offset:0 sc1
  buffer_load_dwordx4 v[160:163], v9, s[28:31], s50 offen offset:0 sc1
  buffer_load_dwordx4 v[172:175], v10, s[28:31], s47 offen offset:0 sc1
  buffer_load_dwordx4 v[168:171], v9, s[28:31], s47 offen offset:0 sc1
  buffer_load_dwordx4 v[180:183], v10, s[28:31], s45 offen offset:0 sc1
  buffer_load_dwordx4 v[176:179], v9, s[28:31], s45 offen offset:0 sc1
  s_waitcnt vmcnt(0)
  s_branch ok_96
ag_192:
  s_cmp_eq_u32 s63, 0
  s_cbranch_scc1 go_193
  s_sub_u32 s63, s63, 1
  s_branch rel_97
rel_99:
  buffer_load_dwordx4 v[140:143], v10, s[28:31], s58 offen offset:0 sc1
  buffer_load_dwordx4 v[136:139], v9, s[28:31], s58 offen offset:0 sc1
  s_waitcnt vmcnt(0)
  v_cmp_u_f32 vcc, v141, v143
  s_cbranch_vccnz ag_194
  v_cmp_u_f32 vcc, v137, v139
  s_cbranch_vccnz ag_194
go_195:
  buffer_load_dwordx4 v[148:151], v10, s[28:31], s52 offen offset:0 sc1
  buffer_load_dwordx4 v[144:147], v9, s[28:31], s52 offen offset:0 sc1
  buffer_load_dwordx4 v[156:159], v10, s[28:31], s49 offen offset:0 sc1
  buffer_load_dwordx4 v[152:155], v9, s[28:31], s49 offen offset:0 sc1
  buffer_load_dwordx4 v[164:167], v10, s[28:31], s50 offen offset:0 sc1
  buffer_load_dwordx4 v[160:163], v9, s[28:31], s50 offen offset:0 sc1
  buffer_load_dwordx4 v[172:175], v10, s[28:31], s47 offen offset:0 sc1
  buffer_load_dwordx4 v[168:171], v9, s[28:31], s47 offen offset:0 sc1
  buffer_load_dwordx4 v[180:183], v10, s[28:31], s45 offen offset:0 sc1
  buffer_load_dwordx4 v[176:179], v9, s[28:31], s45 offen offset:0 sc1
  buffer_load_dwordx4 v[188:191], v10, s[28:31], s57 offen offset:2048 sc1
  s_waitcnt vmcnt(0)
  s_branch ok_98
ag_194:
  s_cmp_eq_u32 s63, 0
  s_cbranch_scc1 go_195
  s_sub_u32 s63, s63, 1
  s_branch rel_99
rel_101:
  buffer_load_dwordx4 v[148:151], v10, s[28:31], s52 offen offset:0 sc1
  buffer_load_dwordx4 v[144:147], v9, s[28:31], s52 offen offset:0 sc1
  s_waitcnt vmcnt(0)
  v_cmp_u_f32 vcc, v149, v151
  s_cbranch_vccnz ag_196
  v_cmp_u_f32 vcc, v145, v147
  s_cbranch_vccnz ag_196
go_197:
  buffer_load_dwordx4 v[156:159], v10, s[28:31], s49 offen offset:0 sc1
  buffer_load_dwordx4 v[152:155], v9, s[28:31], s49 offen offset:0 sc1
  buffer_load_dwordx4 v[164:167], v10, s[28:31], s50 offen offset:0 sc1
  buffer_load_dwordx4 v[160:163], v9, s[28:31], s50 offen offset:0 sc1
  buffer_load_dwordx4 v[172:175], v10, s[28:31], s47 offen offset:0 sc1
  buffer_load_dwordx4 v[168:171], v9, s[28:31], s47 offen offset:0 sc1
  buffer_load_dwordx4 v[180:183], v10, s[28:31], s45 offen offset:0 sc1
  buffer_load_dwordx4 v[176:179], v9, s[28:31], s45 offen offset:0 sc1
  buffer_load_dwordx4 v[188:191], v10, s[28:31], s57 offen offset:2048 sc1
  buffer_load_dwordx4 v[184:187], v9, s[28:31], s57 offen offset:2048 sc1
  buffer_load_dwordx4 v[196:199], v10, s[28:31], s58 offen offset:2048 sc1
  s_waitcnt vmcnt(0)
  s_branch ok_100
ag_196:
  s_cmp_eq_u32 s63, 0
  s_cbranch_scc1 go_197
  s_sub_u32 s63, s63, 1
  s_branch rel_101
rel_103:
  buffer_load_dwordx4 v[156:159], v10, s[28:31], s49 offen offset:0 sc1
  buffer_load_dwordx4 v[152:155], v9, s[28:31], s49 offen offset:0 sc1
  s_waitcnt vmcnt(0)
  v_cmp_u_f32 vcc, v157, v159
  s_cbranch_vccnz ag_198
  v_cmp_u_f32 vcc, v153, v155
  s_cbranch_vccnz ag_198
go_199:
  buffer_load_dwordx4 v[164:167], v10, s[28:31], s50 offen offset:0 sc1
  buffer_load_dwordx4 v[160:163], v9, s[28:31], s50 offen offset:0 sc1
  buffer_load_dwordx4 v[172:175], v10, s[28:31], s47 offen offset:0 sc1
  buffer_load_dwordx4 v[168:171], v9, s[28:31], s47 offen offset:0 sc1
  buffer_load_dwordx4 v[180:183], v10, s[28:31], s45 offen offset:0 sc1
  buffer_load_dwordx4 v[176:179], v9, s[28:31], s45 offen offset:0 sc1
  buffer_load_dwordx4 v[188:191], v10, s[28:31], s57 offen offset:2048 sc1
  buffer_load_dwordx4 v[184:187], v9, s[28:31], s57 offen offset:2048 sc1
  buffer_load_dwordx4 v[196:199], v10, s[28:31], s58 offen offset:2048 sc1
  buffer_load_dwordx4 v[192:195], v9, s[28:31], s58 offen offset:2048 sc1
  buffer_load_dwordx4 v[204:207], v10, s[28:31], s52 offen offset:2048 sc1
  s_waitcnt vmcnt(0)
  s_branch ok_102
ag_198:
  s_cmp_eq_u32 s63, 0
  s_cbranch_scc1 go_199
  s_sub_u32 s63, s63, 1
  s_branch rel_103
rel_105:
  buffer_load_dwordx4 v[164:167], v10, s[28:31], s50 offen offset:0 sc1
  buffer_load_dwordx4 v[160:163], v9, s[28:31], s50 offen offset:0 sc1
  s_waitcnt vmcnt(0)
  v_cmp_u_f32 vcc, v165, v167
  s_cbranch_vccnz ag_200
  v_cmp_u_f32 vcc, v161, v163
  s_cbranch_vccnz ag_200
go_201:
  buffer_load_dwordx4 v[172:175], v10, s[28:31], s47 offen offset:0 sc1
  buffer_load_dwordx4 v[168:171], v9, s[28:31], s47 offen offset:0 sc1
  buffer_load_dwordx4 v[180:183], v10, s[28:31], s45 offen offset:0 sc1
  buffer_load_dwordx4 v[176:179], v9, s[28:31], s45 offen offset:0 sc1
  buffer_load_dwordx4 v[188:191], v10, s[28:31], s57 offen offset:2048 sc1
  buffer_load_dwordx4 v[184:187], v9, s[28:31], s57 offen offset:2048 sc1
  buffer_load_dwordx4 v[196:199], v10, s[28:31], s58 offen offset:2048 sc1
  buffer_load_dwordx4 v[192:195], v9, s[28:31], s58 offen offset:2048 sc1
  buffer_load_dwordx4 v[204:207], v10, s[28:31], s52 offen offset:2048 sc1
  buffer_load_dwordx4 v[200:203], v9, s[28:31], s52 offen offset:2048 sc1
  buffer_load_dwordx4 v[212:215], v10, s[28:31], s49 offen offset:2048 sc1
  s_waitcnt vmcnt(0)
  s_branch ok_104
ag_200:
  s_cmp_eq_u32 s63, 0
  s_cbranch_scc1 go_201
  s_sub_u32 s63, s63, 1
  s_branch rel_105
rel_107:
  buffer_load_dwordx4 v[172:175], v10, s[28:31], s47 offen offset:0 sc1
  buffer_load_dwordx4 v[168:171], v9, s[28:31], s47 offen offset:0 sc1
  s_waitcnt vmcnt(0)
  v_cmp_u_f32 vcc, v173, v175
  s_cbranch_vccnz ag_202
  v_cmp_u_f32 vcc, v169, v171
  s_cbranch_vccnz ag_202
go_203:
  buffer_load_dwordx4 v[180:183], v10, s[28:31], s45 offen offset:0 sc1
  buffer_load_dwordx4 v[176:179], v9, s[28:31], s45 offen offset:0 sc1
  buffer_load_dwordx4 v[188:191], v10, s[28:31], s57 offen offset:2048 sc1
  buffer_load_dwordx4 v[184:187], v9, s[28:31], s57 offen offset:2048 sc1
  buffer_load_dwordx4 v[196:199], v10, s[28:31], s58 offen offset:2048 sc1
  buffer_load_dwordx4 v[192:195], v9, s[28:31], s58 offen offset:2048 sc1
  buffer_load_dwordx4 v[204:207], v10, s[28:31], s52 offen offset:2048 sc1
  buffer_load_dwordx4 v[200:203], v9, s[28:31], s52 offen offset:2048 sc1
  buffer_load_dwordx4 v[212:215], v10, s[28:31], s49 offen offset:2048 sc1
  buffer_load_dwordx4 v[208:211], v9, s[28:31], s49 offen offset:2048 sc1
  buffer_load_dwordx4 v[220:223], v10, s[28:31], s50 offen offset:2048 sc1
  s_waitcnt vmcnt(0)
  s_branch ok_106
ag_202:
  s_cmp_eq_u32 s63, 0
  s_cbranch_scc1 go_203
  s_sub_u32 s63, s63, 1
  s_branch rel_107
rel_109:
  buffer_load_dwordx4 v[180:183], v10, s[28:31], s45 offen offset:0 sc1
  buffer_load_dwordx4 v[176:179], v9, s[28:31], s45 offen offset:0 sc1
  s_waitcnt vmcnt(0)
  v_cmp_u_f32 vcc, v181, v183
  s_cbranch_vccnz ag_204
  v_cmp_u_f32 vcc, v177, v179
  s_cbranch_vccnz ag_204
go_205:
  buffer_load_dwordx4 v[188:191], v10, s[28:31], s57 offen offset:2048 sc1
  buffer_load_dwordx4 v[184:187], v9, s[28:31], s57 offen offset:2048 sc1
  buffer_load_dwordx4 v[196:199], v10, s[28:31], s58 offen offset:2048 sc1
  buffer_load_dwordx4 v[192:195], v9, s[28:31], s58 offen offset:2048 sc1
  buffer_load_dwordx4 v[204:207], v10, s[28:31], s52 offen offset:2048 sc1
  buffer_load_dwordx4 v[200:203], v9, s[28:31], s52 offen offset:2048 sc1
  buffer_load_dwordx4 v[212:215], v10, s[28:31], s49 offen offset:2048 sc1
  buffer_load_dwordx4 v[208:211], v9, s[28:31], s49 offen offset:2048 sc1
  buffer_load_dwordx4 v[220:223], v10, s[28:31], s50 offen offset:2048 sc1
  buffer_load_dwordx4 v[216:219], v9, s[28:31], s50 offen offset:2048 sc1
  buffer_load_dwordx4 v[228:231], v10, s[28:31], s47 offen offset:2048 sc1
  s_branch ok_108
ag_204:
  s_cmp_eq_u32 s63, 0
  s_cbranch_scc1 go_205
  s_sub_u32 s63, s63, 1
  s_branch rel_109
rel_111:
  buffer_load_dwordx4 v[188:191], v10, s[28:31], s57 offen offset:2048 sc1
  buffer_load_dwordx4 v[184:187], v9, s[28:31], s57 offen offset:2048 sc1
  s_waitcnt vmcnt(0)
  v_cmp_u_f32 vcc, v189, v191
  s_cbranch_vccnz ag_206
  v_cmp_u_f32 vcc, v185, v187
  s_cbranch_vccnz ag_206
go_207:
  buffer_load_dwordx4 v[196:199], v10, s[28:31], s58 offen offset:2048 sc1
  buffer_load_dwordx4 v[192:195], v9, s[28:31], s58 offen offset:2048 sc1
  buffer_load_dwordx4 v[204:207], v10, s[28:31], s52 offen offset:2048 sc1
  buffer_load_dwordx4 v[200:203], v9, s[28:31], s52 offen offset:2048 sc1
  buffer_load_dwordx4 v[212:215], v10, s[28:31], s49 offen offset:2048 sc1
  buffer_load_dwordx4 v[208:211], v9, s[28:31], s49 offen offset:2048 sc1
  buffer_load_dwordx4 v[220:223], v10, s[28:31], s50 offen offset:2048 sc1
  buffer_load_dwordx4 v[216:219], v9, s[28:31], s50 offen offset:2048 sc1
  buffer_load_dwordx4 v[228:231], v10, s[28:31], s47 offen offset:2048 sc1
  buffer_load_dwordx4 v[224:227], v9, s[28:31], s47 offen offset:2048 sc1
  buffer_load_dwordx4 v[236:239], v10, s[28:31], s45 offen offset:2048 sc1
  s_branch ok_110
ag_206:
  s_cmp_eq_u32 s63, 0
  s_cbranch_scc1 go_207
  s_sub_u32 s63, s63, 1
  s_branch rel_111
far_113:
  buffer_store_dwordx4 v[88:91], v1, s[28:31], s68 offen offset:2048 sc1
  buffer_store_dwordx4 v[92:95], v1, s[28:31], s68 offen offset:3072 sc1
  s_branch ok_112
rel_115:
  buffer_load_dwordx4 v[196:199], v10, s[28:31], s58 offen offset:2048 sc1
  buffer_load_dwordx4 v[192:195], v9, s[28:31], s58 offen offset:2048 sc1
  s_waitcnt vmcnt(0)
  v_cmp_u_f32 vcc, v197, v199
  s_cbranch_vccnz ag_208
  v_cmp_u_f32 vcc, v193, v195
  s_cbranch_vccnz ag_208
go_209:
  buffer_load_dwordx4 v[204:207], v10, s[28:31], s52 offen offset:2048 sc1
  buffer_load_dwordx4 v[200:203], v9, s[28:31], s52 offen offset:2048 sc1
  buffer_load_dwordx4 v[212:215], v10, s[28:31], s49 offen offset:2048 sc1
  buffer_load_dwordx4 v[208:211], v9, s[28:31], s49 offen offset:2048 sc1
  buffer_load_dwordx4 v[220:223], v10, s[28:31], s50 offen offset:2048 sc1
  buffer_load_dwordx4 v[216:219], v9, s[28:31], s50 offen offset:2048 sc1
  buffer_load_dwordx4 v[228:231], v10, s[28:31], s47 offen offset:2048 sc1
  buffer_load_dwordx4 v[224:227], v9, s[28:31], s47 offen offset:2048 sc1
  buffer_load_dwordx4 v[236:239], v10, s[28:31], s45 offen offset:2048 sc1
  buffer_load_dwordx4 v[232:235], v9, s[28:31], s45 offen offset:2048 sc1
  buffer_load_dwordx4 v[132:135], v13, s[28:31], s57 offen offset:0 sc1
  s_waitcnt vmcnt(0)
  s_branch ok_114
ag_208:
  s_cmp_eq_u32 s63, 0
  s_cbranch_scc1 go_209
  s_sub_u32 s63, s63, 1
  s_branch rel_115
rel_117:
  buffer_load_dwordx4 v[204:207], v10, s[28:31], s52 offen offset:2048 sc1
  buffer_load_dwordx4 v[200:203], v9, s[28:31], s52 offen offset:2048 sc1
  s_waitcnt vmcnt(0)
  v_cmp_u_f32 vcc, v205, v207
  s_cbranch_vccnz ag_210
  v_cmp_u_f32 vcc, v201, v203
  s_cbranch_vccnz ag_210
go_211:
  buffer_load_dwordx4 v[212:215], v10, s[28:31], s49 offen offset:2048 sc1
  buffer_load_dwordx4 v[208:211], v9, s[28:31], s49 offen offset:2048 sc1
  buffer_load_dwordx4 v[220:223], v10, s[28:31], s50 offen offset:2048 sc1
  buffer_load_dwordx4 v[216:219], v9, s[28:31], s50 offen offset:2048 sc1
  buffer_load_dwordx4 v[228:231], v10, s[28:31], s47 offen offset:2048 sc1
  buffer_load_dwordx4 v[224:227], v9, s[28:31], s47 offen offset:2048 sc1
  buffer_load_dwordx4 v[236:239], v10, s[28:31], s45 offen offset:2048 sc1
  buffer_load_dwordx4 v[232:235], v9, s[28:31], s45 offen offset:2048 sc1
  buffer_load_dwordx4 v[132:135], v13, s[28:31], s57 offen offset:0 sc1
  buffer_load_dwordx4 v[128:131], v2, s[28:31], s57 offen offset:0 sc1
  buffer_load_dwordx4 v[140:143], v13, s[28:31], s58 offen offset:0 sc1
  s_waitcnt vmcnt(0)
  s_branch ok_116
ag_210:
  s_cmp_eq_u32 s63, 0
  s_cbranch_scc1 go_211
  s_sub_u32 s63, s63, 1
  s_branch rel_117
rel_119:
  buffer_load_dwordx4 v[212:215], v10, s[28:31], s49 offen offset:2048 sc1
  buffer_load_dwordx4 v[208:211], v9, s[28:31], s49 offen offset:2048 sc1
  s_waitcnt vmcnt(0)
  v_cmp_u_f32 vcc, v213, v215
  s_cbranch_vccnz ag_212
  v_cmp_u_f32 vcc, v209, v211
  s_cbranch_vccnz ag_212
go_213:
  buffer_load_dwordx4 v[220:223], v10, s[28:31], s50 offen offset:2048 sc1
  buffer_load_dwordx4 v[216:219], v9, s[28:31], s50 offen offset:2048 sc1
  buffer_load_dwordx4 v[228:231], v10, s[28:31], s47 offen offset:2048 sc1
  buffer_load_dwordx4 v[224:227], v9, s[28:31], s47 offen offset:2048 sc1
  buffer_load_dwordx4 v[236:239], v10, s[28:31], s45 offen offset:2048 sc1
  buffer_load_dwordx4 v[232:235], v9, s[28:31], s45 offen offset:2048 sc1
  buffer_load_dwordx4 v[132:135], v13, s[28:31], s57 offen offset:0 sc1
  buffer_load_dwordx4 v[128:131], v2, s[28:31], s57 offen offset:0 sc1
  buffer_load_dwordx4 v[140:143], v13, s[28:31], s58 offen offset:0 sc1
  buffer_load_dwordx4 v[136:139], v2, s[28:31], s58 offen offset:0 sc1
  buffer_load_dwordx4 v[148:151], v13, s[28:31], s52 offen offset:0 sc1
  s_waitcnt vmcnt(0)
  s_branch ok_118
ag_212:
  s_cmp_eq_u32 s63, 0
  s_cbranch_scc1 go_213
  s_sub_u32 s63, s63, 1
  s_branch rel_119
rel_121:
  buffer_load_dwordx4 v[220:223], v10, s[28:31], s50 offen offset:2048 sc1
  buffer_load_dwordx4 v[216:219], v9, s[28:31], s50 offen offset:2048 sc1
  s_waitcnt vmcnt(0)
  v_cmp_u_f32 vcc, v221, v223
  s_cbranch_vccnz ag_214
  v_cmp_u_f32 vcc, v217, v219
  s_cbranch_vccnz ag_214
go_215:
  buffer_load_dwordx4 v[228:231], v10, s[28:31], s47 offen offset:2048 sc1
  buffer_load_dwordx4 v[224:227], v9, s[28:31], s47 offen offset:2048 sc1
  buffer_load_dwordx4 v[236:239], v10, s[28:31], s45 offen offset:2048 sc1
  buffer_load_dwordx4 v[232:235], v9, s[28:31], s45 offen offset:2048 sc1
  buffer_load_dwordx4 v[132:135], v13, s[28:31], s57 offen offset:0 sc1
  buffer_load_dwordx4 v[128:131], v2, s[28:31], s57 offen offset:0 sc1
  buffer_load_dwordx4 v[140:143], v13, s[28:31], s58 offen offset:0 sc1
  buffer_load_dwordx4 v[136:139], v2, s[28:31], s58 offen offset:0 sc1
  buffer_load_dwordx4 v[148:151], v13, s[28:31], s52 offen offset:0 sc1
  buffer_load_dwordx4 v[144:147], v2, s[28:31], s52 offen offset:0 sc1
  buffer_load_dwordx4 v[156:159], v13, s[28:31], s49 offen offset:0 sc1
  s_waitcnt vmcnt(0)
  s_branch ok_120
ag_214:
  s_cmp_eq_u32 s63, 0
  s_cbranch_scc1 go_215
  s_sub_u32 s63, s63, 1
  s_branch rel_121
rel_123:
  buffer_load_dwordx4 v[228:231], v10, s[28:31], s47 offen offset:2048 sc1
  buffer_load_dwordx4 v[224:227], v9, s[28:31], s47 offen offset:2048 sc1
  s_waitcnt vmcnt(0)
  v_cmp_u_f32 vcc, v229, v231
  s_cbranch_vccnz ag_216
  v_cmp_u_f32 vcc, v225, v227
  s_cbranch_vccnz ag_216
go_217:
  buffer_load_dwordx4 v[236:239], v10, s[28:31], s45 offen offset:2048 sc1
  buffer_load_dwordx4 v[232:235], v9, s[28:31], s45 offen offset:2048 sc1
  buffer_load_dwordx4 v[132:135], v13, s[28:31], s57 offen offset:0 sc1
  buffer_load_dwordx4 v[128:131], v2, s[28:31], s57 offen offset:0 sc1
  buffer_load_dwordx4 v[140:143], v13, s[28:31], s58 offen offset:0 sc1
  buffer_load_dwordx4 v[136:139], v2, s[28:31], s58 offen offset:0 sc1
  buffer_load_dwordx4 v[148:151], v13, s[28:31], s52 offen offset:0 sc1
  buffer_load_dwordx4 v[144:147], v2, s[28:31], s52 offen offset:0 sc1
  buffer_load_dwordx4 v[156:159], v13, s[28:31], s49 offen offset:0 sc1
  buffer_load_dwordx4 v[152:155], v2, s[28:31], s49 offen offset:0 sc1
  buffer_load_dwordx4 v[164:167], v13, s[28:31], s50 offen offset:0 sc1
  s_waitcnt vmcnt(0)
  s_branch ok_122
ag_216:
  s_cmp_eq_u32 s63, 0
  s_cbranch_scc1 go_217
  s_sub_u32 s63, s63, 1
  s_branch rel_123
rel_125:
  buffer_load_dwordx4 v[236:239], v10, s[28:31], s45 offen offset:2048 sc1
  buffer_load_dwordx4 v[232:235], v9, s[28:31], s45 offen offset:2048 sc1
  s_waitcnt vmcnt(0)
  v_cmp_u_f32 vcc, v237, v239
  s_cbranch_vccnz ag_218
  v_cmp_u_f32 vcc, v233, v235
  s_cbranch_vccnz ag_218
go_219:
  buffer_load_dwordx4 v[132:135], v13, s[28:31], s57 offen offset:0 sc1
  buffer_load_dwordx4 v[128:131], v2, s[28:31], s57 offen offset:0 sc1
  buffer_load_dwordx4 v[140:143], v13, s[28:31], s58 offen offset:0 sc1
  buffer_load_dwordx4 v[136:139], v2, s[28:31], s58 offen offset:0 sc1
  buffer_load_dwordx4 v[148:151], v13, s[28:31], s52 offen offset:0 sc1
  buffer_load_dwordx4 v[144:147], v2, s[28:31], s52 offen offset:0 sc1
  buffer_load_dwordx4 v[156:159], v13, s[28:31], s49 offen offset:0 sc1
  buffer_load_dwordx4 v[152:155], v2, s[28:31], s49 offen offset:0 sc1
  buffer_load_dwordx4 v[164:167], v13, s[28:31], s50 offen offset:0 sc1
  buffer_load_dwordx4 v[160:163], v2, s[28:31], s50 offen offset:0 sc1
  buffer_load_dwordx4 v[172:175], v13, s[28:31], s47 offen offset:0 sc1
  s_waitcnt vmcnt(0)
  s_branch ok_124
ag_218:
  s_cmp_eq_u32 s63, 0
  s_cbranch_scc1 go_219
  s_sub_u32 s63, s63, 1
  s_branch rel_125
rel_127:
  buffer_load_dwordx4 v[132:135], v13, s[28:31], s57 offen offset:0 sc1
  buffer_load_dwordx4 v[128:131], v2, s[28:31], s57 offen offset:0 sc1
  s_waitcnt vmcnt(0)
  v_cmp_u_f32 vcc, v133, v135
  s_cbranch_vccnz ag_220
  v_cmp_u_f32 vcc, v129, v131
  s_cbranch_vccnz ag_220
go_221:
  buffer_load_dwordx4 v[140:143], v13, s[28:31], s58 offen offset:0 sc1
  buffer_load_dwordx4 v[136:139], v2, s[28:31], s58 offen offset:0 sc1
  buffer_load_dwordx4 v[148:151], v13, s[28:31], s52 offen offset:0 sc1
  buffer_load_dwordx4 v[144:147], v2, s[28:31], s52 offen offset:0 sc1
  buffer_load_dwordx4 v[156:159], v13, s[28:31], s49 offen offset:0 sc1
  buffer_load_dwordx4 v[152:155], v2, s[28:31], s49 offen offset:0 sc1
  buffer_load_dwordx4 v[164:167], v13, s[28:31], s50 offen offset:0 sc1
  buffer_load_dwordx4 v[160:163], v2, s[28:31], s50 offen offset:0 sc1
  buffer_load_dwordx4 v[172:175], v13, s[28:31], s47 offen offset:0 sc1
  buffer_load_dwordx4 v[168:171], v2, s[28:31], s47 offen offset:0 sc1
  buffer_load_dwordx4 v[180:183], v13, s[28:31], s45 offen offset:0 sc1
  s_branch ok_126
ag_220:
  s_cmp_eq_u32 s63, 0
  s_cbranch_scc1 go_221
  s_sub_u32 s63, s63, 1
  s_branch rel_127
rel_129:
  buffer_load_dwordx4 v[140:143], v13, s[28:31], s58 offen offset:0 sc1
  buffer_load_dwordx4 v[136:139], v2, s[28:31], s58 offen offset:0 sc1
  s_waitcnt vmcnt(0)
  v_cmp_u_f32 vcc, v141, v143
  s_cbranch_vccnz ag_222
  v_cmp_u_f32 vcc, v137, v139
  s_cbranch_vccnz ag_222
go_223:
  buffer_load_dwordx4 v[148:151], v13, s[28:31], s52 offen offset:0 sc1
  buffer_load_dwordx4 v[144:147], v2, s[28:31], s52 offen offset:0 sc1
  buffer_load_dwordx4 v[156:159], v13, s[28:31], s49 offen offset:0 sc1
  buffer_load_dwordx4 v[152:155], v2, s[28:31], s49 offen offset:0 sc1
  buffer_load_dwordx4 v[164:167], v13, s[28:31], s50 offen offset:0 sc1
  buffer_load_dwordx4 v[160:163], v2, s[28:31], s50 offen offset:0 sc1
  buffer_load_dwordx4 v[172:175], v13, s[28:31], s47 offen offset:0 sc1
  buffer_load_dwordx4 v[168:171], v2, s[28:31], s47 offen offset:0 sc1
  buffer_load_dwordx4 v[180:183], v13, s[28:31], s45 offen offset:0 sc1
  buffer_load_dwordx4 v[176:179], v2, s[28:31], s45 offen offset:0 sc1
  buffer_load_dwordx4 v[188:191], v13, s[28:31], s57 offen offset:2048 sc1
  s_branch ok_128
ag_222:
  s_cmp_eq_u32 s63, 0
  s_cbranch_scc1 go_223
  s_sub_u32 s63, s63, 1
  s_branch rel_129
rel_131:
  buffer_load_dwordx4 v[148:151], v13, s[28:31], s52 offen offset:0 sc1
  buffer_load_dwordx4 v[144:147], v2, s[28:31], s52 offen offset:0 sc1
  s_waitcnt vmcnt(0)
  v_cmp_u_f32 vcc, v149, v151
  s_cbranch_vccnz ag_224
  v_cmp_u_f32 vcc, v145, v147
  s_cbranch_vccnz ag_224
go_225:
  buffer_load_dwordx4 v[156:159], v13, s[28:31], s49 offen offset:0 sc1
  buffer_load_dwordx4 v[152:155], v2, s[28:31], s49 offen offset:0 sc1
  buffer_load_dwordx4 v[164:167], v13, s[28:31], s50 offen offset:0 sc1
  buffer_load_dwordx4 v[160:163], v2, s[28:31], s50 offen offset:0 sc1
  buffer_load_dwordx4 v[172:175], v13, s[28:31], s47 offen offset:0 sc1
  buffer_load_dwordx4 v[168:171], v2, s[28:31], s47 offen offset:0 sc1
  buffer_load_dwordx4 v[180:183], v13, s[28:31], s45 offen offset:0 sc1
  buffer_load_dwordx4 v[176:179], v2, s[28:31], s45 offen offset:0 sc1
  buffer_load_dwordx4 v[188:191], v13, s[28:31], s57 offen offset:2048 sc1
  buffer_load_dwordx4 v[196:199], v13, s[28:31], s58 offen offset:2048 sc1
  buffer_load_dwordx4 v[204:207], v13, s[28:31], s52 offen offset:2048 sc1
  s_branch ok_130
ag_224:
  s_cmp_eq_u32 s63, 0
  s_cbranch_scc1 go_225
  s_sub_u32 s63, s63, 1
  s_branch rel_131
rel_133:
  buffer_load_dwordx4 v[156:159], v13, s[28:31], s49 offen offset:0 sc1
  buffer_load_dwordx4 v[152:155], v2, s[28:31], s49 offen offset:0 sc1
  s_waitcnt vmcnt(0)
  v_cmp_u_f32 vcc, v157, v159
  s_cbranch_vccnz ag_226
  v_cmp_u_f32 vcc, v153, v155
  s_cbranch_vccnz ag_226
go_227:
  buffer_load_dwordx4 v[164:167], v13, s[28:31], s50 offen offset:0 sc1
  buffer_load_dwordx4 v[160:163], v2, s[28:31], s50 offen offset:0 sc1
  buffer_load_dwordx4 v[172:175], v13, s[28:31], s47 offen offset:0 sc1
  buffer_load_dwordx4 v[168:171], v2, s[28:31], s47 offen offset:0 sc1
  buffer_load_dwordx4 v[180:183], v13, s[28:31], s45 offen offset:0 sc1
  buffer_load_dwordx4 v[176:179], v2, s[28:31], s45 offen offset:0 sc1
  buffer_load_dwordx4 v[188:191], v13, s[28:31], s57 offen offset:2048 sc1
  buffer_load_dwordx4 v[196:199], v13, s[28:31], s58 offen offset:2048 sc1
  buffer_load_dwordx4 v[204:207], v13, s[28:31], s52 offen offset:2048 sc1
  buffer_load_dwordx4 v[212:215], v13, s[28:31], s49 offen offset:2048 sc1
  s_branch ok_132
ag_226:
  s_cmp_eq_u32 s63, 0
  s_cbranch_scc1 go_227
  s_sub_u32 s63, s63, 1
  s_branch rel_133
rel_135:
  buffer_load_dwordx4 v[164:167], v13, s[28:31], s50 offen offset:0 sc1
  buffer_load_dwordx4 v[160:163], v2, s[28:31], s50 offen offset:0 sc1
  s_waitcnt vmcnt(0)
  v_cmp_u_f32 vcc, v165, v167
  s_cbranch_vccnz ag_228
  v_cmp_u_f32 vcc, v161, v163
  s_cbranch_vccnz ag_228
go_229:
  buffer_load_dwordx4 v[172:175], v13, s[28:31], s47 offen offset:0 sc1
  buffer_load_dwordx4 v[168:171], v2, s[28:31], s47 offen offset:0 sc1
  buffer_load_dwordx4 v[180:183], v13, s[28:31], s45 offen offset:0 sc1
  buffer_load_dwordx4 v[176:179], v2, s[28:31], s45 offen offset:0 sc1
  buffer_load_dwordx4 v[188:191], v13, s[28:31], s57 offen offset:2048 sc1
  buffer_load_dwordx4 v[196:199], v13, s[28:31], s58 offen offset:2048 sc1
  buffer_load_dwordx4 v[204:207], v13, s[28:31], s52 offen offset:2048 sc1
  buffer_load_dwordx4 v[212:215], v13, s[28:31], s49 offen offset:2048 sc1
  buffer_load_dwordx4 v[220:223], v13, s[28:31], s50 offen offset:2048 sc1
  buffer_load_dwordx4 v[228:231], v13, s[28:31], s47 offen offset:2048 sc1
  s_branch ok_134
ag_228:
  s_cmp_eq_u32 s63, 0
  s_cbranch_scc1 go_229
  s_sub_u32 s63, s63, 1
  s_branch rel_135
rel_137:
  buffer_load_dwordx4 v[172:175], v13, s[28:31], s47 offen offset:0 sc1
  buffer_load_dwordx4 v[168:171], v2, s[28:31], s47 offen offset:0 sc1
  s_waitcnt vmcnt(0)
  v_cmp_u_f32 vcc, v173, v175
  s_cbranch_vccnz ag_230
  v_cmp_u_f32 vcc, v169, v171
  s_cbranch_vccnz ag_230
go_231:
  buffer_load_dwordx4 v[180:183], v13, s[28:31], s45 offen offset:0 sc1
  buffer_load_dwordx4 v[176:179], v2, s[28:31], s45 offen offset:0 sc1
  buffer_load_dwordx4 v[188:191], v13, s[28:31], s57 offen offset:2048 sc1
  buffer_load_dwordx4 v[196:199], v13, s[28:31], s58 offen offset:2048 sc1
  buffer_load_dwordx4 v[204:207], v13, s[28:31], s52 offen offset:2048 sc1
  buffer_load_dwordx4 v[212:215], v13, s[28:31], s49 offen offset:2048 sc1
  buffer_load_dwordx4 v[220:223], v13, s[28:31], s50 offen offset:2048 sc1
  buffer_load_dwordx4 v[228:231], v13, s[28:31], s47 offen offset:2048 sc1
  buffer_load_dwordx4 v[236:239], v13, s[28:31], s45 offen offset:2048 sc1
  buffer_load_dwordx4 v[184:187], v2, s[28:31], s57 offen offset:2048 sc1
  s_branch ok_136
ag_230:
  s_cmp_eq_u32 s63, 0
  s_cbranch_scc1 go_231
  s_sub_u32 s63, s63, 1
  s_branch rel_137
rel_139:
  buffer_load_dwordx4 v[180:183], v13, s[28:31], s45 offen offset:0 sc1
  buffer_load_dwordx4 v[176:179], v2, s[28:31], s45 offen offset:0 sc1
  s_waitcnt vmcnt(0)
  v_cmp_u_f32 vcc, v181, v183
  s_cbranch_vccnz ag_232
  v_cmp_u_f32 vcc, v177, v179
  s_cbranch_vccnz ag_232
go_233:
  buffer_load_dwordx4 v[188:191], v13, s[28:31], s57 offen offset:2048 sc1
  buffer_load_dwordx4 v[196:199], v13, s[28:31], s58 offen offset:2048 sc1
  buffer_load_dwordx4 v[204:207], v13, s[28:31], s52 offen offset:2048 sc1
  buffer_load_dwordx4 v[212:215], v13, s[28:31], s49 offen offset:2048 sc1
  buffer_load_dwordx4 v[220:223], v13, s[28:31], s50 offen offset:2048 sc1
  buffer_load_dwordx4 v[228:231], v13, s[28:31], s47 offen offset:2048 sc1
  buffer_load_dwordx4 v[236:239], v13, s[28:31], s45 offen offset:2048 sc1
  buffer_load_dwordx4 v[184:187], v2, s[28:31], s57 offen offset:2048 sc1
  buffer_load_dwordx4 v[192:195], v2, s[28:31], s58 offen offset:2048 sc1
  s_branch ok_138
ag_232:
  s_cmp_eq_u32 s63, 0
  s_cbranch_scc1 go_233
  s_sub_u32 s63, s63, 1
  s_branch rel_139
rel_141:
  buffer_load_dwordx4 v[188:191], v13, s[28:31], s57 offen offset:2048 sc1
  s_waitcnt vmcnt(0)
  v_cmp_u_f32 vcc, v189, v191
  s_cbranch_vccnz ag_234
go_235:
  buffer_load_dwordx4 v[196:199], v13, s[28:31], s58 offen offset:2048 sc1
  buffer_load_dwordx4 v[204:207], v13, s[28:31], s52 offen offset:2048 sc1
  buffer_load_dwordx4 v[212:215], v13, s[28:31], s49 offen offset:2048 sc1
  buffer_load_dwordx4 v[220:223], v13, s[28:31], s50 offen offset:2048 sc1
  buffer_load_dwordx4 v[228:231], v13, s[28:31], s47 offen offset:2048 sc1
  buffer_load_dwordx4 v[236:239], v13, s[28:31], s45 offen offset:2048 sc1
  buffer_load_dwordx4 v[184:187], v2, s[28:31], s57 offen offset:2048 sc1
  buffer_load_dwordx4 v[192:195], v2, s[28:31], s58 offen offset:2048 sc1
  buffer_load_dwordx4 v[200:203], v2, s[28:31], s52 offen offset:2048 sc1
  buffer_load_dwordx4 v[208:211], v2, s[28:31], s49 offen offset:2048 sc1
  s_branch ok_140
ag_234:
  s_cmp_eq_u32 s63, 0
  s_cbranch_scc1 go_235
  s_sub_u32 s63, s63, 1
  s_branch rel_141
rel_143:
  buffer_load_dwordx4 v[196:199], v13, s[28:31], s58 offen offset:2048 sc1
  s_waitcnt vmcnt(0)
  v_cmp_u_f32 vcc, v197, v199
  s_cbranch_vccnz ag_236
go_237:
  buffer_load_dwordx4 v[204:207], v13, s[28:31], s52 offen offset:2048 sc1
  buffer_load_dwordx4 v[212:215], v13, s[28:31], s49 offen offset:2048 sc1
  buffer_load_dwordx4 v[220:223], v13, s[28:31], s50 offen offset:2048 sc1
  buffer_load_dwordx4 v[228:231], v13, s[28:31], s47 offen offset:2048 sc1
  buffer_load_dwordx4 v[236:239], v13, s[28:31], s45 offen offset:2048 sc1
  buffer_load_dwordx4 v[184:187], v2, s[28:31], s57 offen offset:2048 sc1
  buffer_load_dwordx4 v[192:195], v2, s[28:31], s58 offen offset:2048 sc1
  buffer_load_dwordx4 v[200:203], v2, s[28:31], s52 offen offset:2048 sc1
  buffer_load_dwordx4 v[208:211], v2, s[28:31], s49 offen offset:2048 sc1
  buffer_load_dwordx4 v[216:219], v2, s[28:31], s50 offen offset:2048 sc1
  s_branch ok_142
ag_236:
  s_cmp_eq_u32 s63, 0
  s_cbranch_scc1 go_237
  s_sub_u32 s63, s63, 1
  s_branch rel_143
rel_145:
  buffer_load_dwordx4 v[204:207], v13, s[28:31], s52 offen offset:2048 sc1
  s_waitcnt vmcnt(0)
  v_cmp_u_f32 vcc, v205, v207
  s_cbranch_vccnz ag_238
go_239:
  buffer_load_dwordx4 v[212:215], v13, s[28:31], s49 offen offset:2048 sc1
  buffer_load_dwordx4 v[220:223], v13, s[28:31], s50 offen offset:2048 sc1
  buffer_load_dwordx4 v[228:231], v13, s[28:31], s47 offen offset:2048 sc1
  buffer_load_dwordx4 v[236:239], v13, s[28:31], s45 offen offset:2048 sc1
  buffer_load_dwordx4 v[184:187], v2, s[28:31], s57 offen offset:2048 sc1
  buffer_load_dwordx4 v[192:195], v2, s[28:31], s58 offen offset:2048 sc1
  buffer_load_dwordx4 v[200:203], v2, s[28:31], s52 offen offset:2048 sc1
  buffer_load_dwordx4 v[208:211], v2, s[28:31], s49 offen offset:2048 sc1
  buffer_load_dwordx4 v[216:219], v2, s[28:31], s50 offen offset:2048 sc1
  s_branch ok_144
ag_238:
  s_cmp_eq_u32 s63, 0
  s_cbranch_scc1 go_239
  s_sub_u32 s63, s63, 1
  s_branch rel_145
rel_147:
  buffer_load_dwordx4 v[212:215], v13, s[28:31], s49 offen offset:2048 sc1
  s_waitcnt vmcnt(0)
  v_cmp_u_f32 vcc, v213, v215
  s_cbranch_vccnz ag_240
go_241:
  buffer_load_dwordx4 v[220:223], v13, s[28:31], s50 offen offset:2048 sc1
  buffer_load_dwordx4 v[228:231], v13, s[28:31], s47 offen offset:2048 sc1
  buffer_load_dwordx4 v[236:239], v13, s[28:31], s45 offen offset:2048 sc1
  buffer_load_dwordx4 v[184:187], v2, s[28:31], s57 offen offset:2048 sc1
  buffer_load_dwordx4 v[192:195], v2, s[28:31], s58 offen offset:2048 sc1
  buffer_load_dwordx4 v[200:203], v2, s[28:31], s52 offen offset:2048 sc1
  buffer_load_dwordx4 v[208:211], v2, s[28:31], s49 offen offset:2048 sc1
  buffer_load_dwordx4 v[216:219], v2, s[28:31], s50 offen offset:2048 sc1
  buffer_load_dwordx4 v[224:227], v2, s[28:31], s47 offen offset:2048 sc1
  s_branch ok_146
ag_240:
  s_cmp_eq_u32 s63, 0
  s_cbranch_scc1 go_241
  s_sub_u32 s63, s63, 1
  s_branch rel_147
rel_149:
  buffer_load_dwordx4 v[220:223], v13, s[28:31], s50 offen offset:2048 sc1
  s_waitcnt vmcnt(0)
  v_cmp_u_f32 vcc, v221, v223
  s_cbranch_vccnz ag_242
go_243:
  buffer_load_dwordx4 v[228:231], v13, s[28:31], s47 offen offset:2048 sc1
  buffer_load_dwordx4 v[236:239], v13, s[28:31], s45 offen offset:2048 sc1
  buffer_load_dwordx4 v[184:187], v2, s[28:31], s57 offen offset:2048 sc1
  buffer_load_dwordx4 v[192:195], v2, s[28:31], s58 offen offset:2048 sc1
  buffer_load_dwordx4 v[200:203], v2, s[28:31], s52 offen offset:2048 sc1
  buffer_load_dwordx4 v[208:211], v2, s[28:31], s49 offen offset:2048 sc1
  buffer_load_dwordx4 v[216:219], v2, s[28:31], s50 offen offset:2048 sc1
  buffer_load_dwordx4 v[224:227], v2, s[28:31], s47 offen offset:2048 sc1
  buffer_load_dwordx4 v[232:235], v2, s[28:31], s45 offen offset:2048 sc1
  s_branch ok_148
ag_242:
  s_cmp_eq_u32 s63, 0
  s_cbranch_scc1 go_243
  s_sub_u32 s63, s63, 1
  s_branch rel_149
rel_151:
  buffer_load_dwordx4 v[228:231], v13, s[28:31], s47 offen offset:2048 sc1
  s_waitcnt vmcnt(0)
  v_cmp_u_f32 vcc, v229, v231
  s_cbranch_vccnz ag_244
go_245:
  buffer_load_dwordx4 v[236:239], v13, s[28:31], s45 offen offset:2048 sc1
  buffer_load_dwordx4 v[184:187], v2, s[28:31], s57 offen offset:2048 sc1
  buffer_load_dwordx4 v[192:195], v2, s[28:31], s58 offen offset:2048 sc1
  buffer_load_dwordx4 v[200:203], v2, s[28:31], s52 offen offset:2048 sc1
  buffer_load_dwordx4 v[208:211], v2, s[28:31], s49 offen offset:2048 sc1
  buffer_load_dwordx4 v[216:219], v2, s[28:31], s50 offen offset:2048 sc1
  buffer_load_dwordx4 v[224:227], v2, s[28:31], s47 offen offset:2048 sc1
  buffer_load_dwordx4 v[232:235], v2, s[28:31], s45 offen offset:2048 sc1
  s_branch ok_150
ag_244:
  s_cmp_eq_u32 s63, 0
  s_cbranch_scc1 go_245
  s_sub_u32 s63, s63, 1
  s_branch rel_151
rel_153:
  buffer_load_dwordx4 v[236:239], v13, s[28:31], s45 offen offset:2048 sc1
  s_waitcnt vmcnt(0)
  v_cmp_u_f32 vcc, v237, v239
  s_cbranch_vccnz ag_246
go_247:
  buffer_load_dwordx4 v[184:187], v2, s[28:31], s57 offen offset:2048 sc1
  buffer_load_dwordx4 v[192:195], v2, s[28:31], s58 offen offset:2048 sc1
  buffer_load_dwordx4 v[200:203], v2, s[28:31], s52 offen offset:2048 sc1
  buffer_load_dwordx4 v[208:211], v2, s[28:31], s49 offen offset:2048 sc1
  buffer_load_dwordx4 v[216:219], v2, s[28:31], s50 offen offset:2048 sc1
  buffer_load_dwordx4 v[224:227], v2, s[28:31], s47 offen offset:2048 sc1
  buffer_load_dwordx4 v[232:235], v2, s[28:31], s45 offen offset:2048 sc1
  s_branch ok_152
ag_246:
  s_cmp_eq_u32 s63, 0
  s_cbranch_scc1 go_247
  s_sub_u32 s63, s63, 1
  s_branch rel_153
rel_155:
  buffer_load_dwordx4 v[184:187], v2, s[28:31], s57 offen offset:2048 sc1
  buffer_load_dwordx4 v[192:195], v2, s[28:31], s58 offen offset:2048 sc1
  s_waitcnt vmcnt(0)
  v_cmp_u_f32 vcc, v185, v187
  s_cbranch_vccnz ag_248
  v_cmp_u_f32 vcc, v193, v195
  s_cbranch_vccnz ag_248
go_249:
  buffer_load_dwordx4 v[200:203], v2, s[28:31], s52 offen offset:2048 sc1
  buffer_load_dwordx4 v[208:211], v2, s[28:31], s49 offen offset:2048 sc1
  buffer_load_dwordx4 v[216:219], v2, s[28:31], s50 offen offset:2048 sc1
  buffer_load_dwordx4 v[224:227], v2, s[28:31], s47 offen offset:2048 sc1
  buffer_load_dwordx4 v[232:235], v2, s[28:31], s45 offen offset:2048 sc1
  s_branch ok_154
ag_248:
  s_cmp_eq_u32 s63, 0
  s_cbranch_scc1 go_249
  s_sub_u32 s63, s63, 1
  s_branch rel_155
rel_157:
  buffer_load_dwordx4 v[200:203], v2, s[28:31], s52 offen offset:2048 sc1
  buffer_load_dwordx4 v[208:211], v2, s[28:31], s49 offen offset:2048 sc1
  s_waitcnt vmcnt(0)
  v_cmp_u_f32 vcc, v201, v203
  s_cbranch_vccnz ag_250
  v_cmp_u_f32 vcc, v209, v211
  s_cbranch_vccnz ag_250
go_251:
  buffer_load_dwordx4 v[216:219], v2, s[28:31], s50 offen offset:2048 sc1
  buffer_load_dwordx4 v[224:227], v2, s[28:31], s47 offen offset:2048 sc1
  buffer_load_dwordx4 v[232:235], v2, s[28:31], s45 offen offset:2048 sc1
  s_branch ok_156
ag_250:
  s_cmp_eq_u32 s63, 0
  s_cbranch_scc1 go_251
  s_sub_u32 s63, s63, 1
  s_branch rel_157
rel_159:
  buffer_load_dwordx4 v[216:219], v2, s[28:31], s50 offen offset:2048 sc1
  buffer_load_dwordx4 v[224:227], v2, s[28:31], s47 offen offset:2048 sc1
  s_waitcnt vmcnt(0)
  v_cmp_u_f32 vcc, v217, v219
  s_cbranch_vccnz ag_252
  v_cmp_u_f32 vcc, v225, v227
  s_cbranch_vccnz ag_252
go_253:
  buffer_load_dwordx4 v[232:235], v2, s[28:31], s45 offen offset:2048 sc1
  s_branch ok_158
ag_252:
  s_cmp_eq_u32 s63, 0
  s_cbranch_scc1 go_253
  s_sub_u32 s63, s63, 1
  s_branch rel_159
rel_161:
  buffer_load_dwordx4 v[232:235], v2, s[28:31], s45 offen offset:2048 sc1
  s_waitcnt vmcnt(0)
  v_cmp_u_f32 vcc, v233, v235
  s_cbranch_vccnz ag_254
go_255:
  s_branch ok_160
ag_254:
  s_cmp_eq_u32 s63, 0
  s_cbranch_scc1 go_255
  s_sub_u32 s63, s63, 1
  s_branch rel_161
L_poison:
  s_not_b64 exec, s[0:1]
  v_mov_b32 v168, -1
  s_mov_b64 exec, -1
  s_nop 1
  s_branch L_pret
L_fallback:
  s_waitcnt vmcnt(0) lgkmcnt(0)
  v_mov_b32 v104, 0xff800000
  s_mov_b32 s4, s49
  s_add_u32 s5, s4, 262144
L_fb1:
  buffer_load_dwordx4 v[112:115], v1, s[28:31], s4 offen offset:0 sc1
  buffer_load_dwordx4 v[116:119], v1, s[28:31], s4 offen offset:1024 sc1
  s_waitcnt vmcnt(0)
  v_mfma_f32_32x32x16_bf16 v[64:79], v[112:115], v[56:59], 0
  v_mfma_f32_32x32x16_bf16 v[64:79], v[116:119], v[60:63], v[64:79]
  s_nop 11
  v_max3_f32 v104, v64, v65, v104
  v_max3_f32 v104, v66, v67, v104
  v_max3_f32 v104, v68, v69, v104
  v_max3_f32 v104, v70, v71, v104
  v_max3_f32 v104, v72, v73, v104
  v_max3_f32 v104, v74, v75, v104
  v_max3_f32 v104, v76, v77, v104
  v_max3_f32 v104, v78, v79, v104
  s_add_u32 s4, s4, 4096
  s_cmp_lt_u32 s4, s5
  s_cbranch_scc1 L_fb1
  v_mov_b32 v107, v104
  s_nop 1
  v_permlane32_swap_b32 v104, v107
  v_max_f32 v104, v104, v107
  s_mov_b32 s4, s49
  v_mov_b32 v224, 0
  v_mov_b32 v225, 0
  v_mov_b32 v226, 0
  v_mov_b32 v227, 0
  v_mov_b32 v228, 0
  v_mov_b32 v229, 0
  v_mov_b32 v230, 0
  v_mov_b32 v231, 0
  v_mov_b32 v232, 0
  v_mov_b32 v233, 0
  v_mov_b32 v234, 0
  v_mov_b32 v235, 0
  v_mov_b32 v236, 0
  v_mov_b32 v237, 0
  v_mov_b32 v238, 0
  v_mov_b32 v239, 0
L_fb2:
  buffer_load_dwordx4 v[112:115], v1, s[28:31], s4 offen offset:0 sc1
  buffer_load_dwordx4 v[116:119], v1, s[28:31], s4 offen offset:1024 sc1
  buffer_load_dwordx4 v[120:123], v1, s[28:31], s4 offen offset:2048 sc1
  buffer_load_dwordx4 v[124:127], v1, s[28:31], s4 offen offset:3072 sc1
  s_waitcnt vmcnt(0)
  v_mfma_f32_32x32x16_bf16 v[64:79], v[112:115], v[56:59], 0
  v_mfma_f32_32x32x16_bf16 v[64:79], v[116:119], v[60:63], v[64:79]
  s_nop 11
  v_sub_f32 v64, v64, v104
  v_sub_f32 v65, v65, v104
  v_sub_f32 v66, v66, v104
  v_sub_f32 v67, v67, v104
  v_sub_f32 v68, v68, v104
  v_sub_f32 v69, v69, v104
  v_sub_f32 v70, v70, v104
  v_sub_f32 v71, v71, v104
  v_sub_f32 v72, v72, v104
  v_sub_f32 v73, v73, v104
  v_sub_f32 v74, v74, v104
  v_sub_f32 v75, v75, v104
  v_sub_f32 v76, v76, v104
  v_sub_f32 v77, v77, v104
  v_sub_f32 v78, v78, v104
  v_sub_f32 v79, v79, v104
  v_exp_f32 v64, v64
  v_exp_f32 v65, v65
  v_exp_f32 v66, v66
  v_exp_f32 v67, v67
  v_exp_f32 v68, v68
  v_exp_f32 v69, v69
  v_exp_f32 v70, v70
  v_exp_f32 v71, v71
  v_exp_f32 v72, v72
  v_exp_f32 v73, v73
  v_exp_f32 v74, v74
  v_exp_f32 v75, v75
  v_exp_f32 v76, v76
  v_exp_f32 v77, v77
  v_exp_f32 v78, v78
  v_exp_f32 v79, v79
  v_cvt_pk_bf16_f32 v96, v64, v65
  v_cvt_pk_bf16_f32 v97, v66, v67
  v_cvt_pk_bf16_f32 v98, v68, v69
  v_cvt_pk_bf16_f32 v99, v70, v71
  v_cvt_pk_bf16_f32 v100, v72, v73
  v_cvt_pk_bf16_f32 v101, v74, v75
  v_cvt_pk_bf16_f32 v102, v76, v77
  v_cvt_pk_bf16_f32 v103, v78, v79
  v_mfma_f32_32x32x16_bf16 v[224:239], v[120:123], v[96:99], v[224:239]
  s_nop 0
  v_mfma_f32_32x32x16_bf16 v[224:239], v[124:127], v[100:103], v[224:239]
  s_add_u32 s4, s4, 4096
  s_cmp_lt_u32 s4, s5
  s_cbranch_scc1 L_fb2
  s_nop 15
  s_branch L_fbret
L_end:
  s_endpgm
.section .rodata,"a"
.p2align 6
.amdhsa_kernel sequential_preLN__softmax_full_mha__dense_activation_gelu__prompt_kernel
  .amdhsa_next_free_vgpr 512
  .amdhsa_next_free_sgpr 102
  .amdhsa_accum_offset 256
  .amdhsa_group_segment_fixed_size 0
  .amdhsa_kernarg_size 88
  .amdhsa_user_sgpr_count 2
  .amdhsa_user_sgpr_kernarg_segment_ptr 1
  .amdhsa_system_sgpr_workgroup_id_x 1
.end_amdhsa_kernel
```
